```python
import torch

def _softmax(x, axis=-1):
    return torch.softmax(x, dim=axis)
def _gelu(x):
    return torch.nn.functional.gelu(x, approximate="tanh")
def _silu(x):
    return torch.nn.functional.silu(x)
def _sigmoid(x):
    return torch.sigmoid(x)
def _layernorm(x, axis=-1, eps=1e-5):
    m = x.mean(dim=axis, keepdim=True)
    v = x.var(dim=axis, keepdim=True, unbiased=False)
    return (x - m) / torch.sqrt(v + eps)
def _scatter_add(tgt, idx, src, axis=0):
    return tgt.clone().index_add_(axis, idx, src)
def _segment_sum(src, seg, n):
    out = torch.zeros((n,) + src.shape[1:], dtype=src.dtype)
    return out.index_add_(0, seg, src)
def _pad(x, pw):
    flat = tuple(v for pair in reversed(pw) for v in pair)
    return torch.nn.functional.pad(x, flat)

kernel_name = 'sequential_preLN__sliding_block__glu_gated_swiglu__prompt'

def setup_inputs():

    _w = (lambda a: (lambda t: t.to(torch.bfloat16) if t.is_floating_point() else t)(torch.as_tensor(a)))
    def _A_setup():
        B, S, D = 1, 2048, 640
        return {
            "x": _w((lambda *s: torch.randn(*s, dtype=torch.bfloat16) * 0.05)(B, S, D)),
            "wqkv": _w((lambda *s: torch.randn(*s, dtype=torch.bfloat16) * 0.05)(D, 3 * D)),
            "wo": _w((lambda *s: torch.randn(*s, dtype=torch.bfloat16) * 0.05)(D, D)),
        }
    _A_in = _A_setup()

    def _B_setup():
        B, S, D, F = 1, 2048, 640, 1536
        return {
            "x": _w((lambda *s: torch.randn(*s, dtype=torch.bfloat16) * 0.05)(B, S, D)),
            "w1": _w((lambda *s: torch.randn(*s, dtype=torch.bfloat16) * 0.8)(D, F) * (2.0 / D) ** 0.5),
            "w3": _w((lambda *s: torch.randn(*s, dtype=torch.bfloat16) * 0.8)(D, F) * (2.0 / D) ** 0.5),
            "w2": _w((lambda *s: torch.randn(*s, dtype=torch.bfloat16) * 0.8)(F, D) * (2.0 / F) ** 0.5),
        }
    _B_in = _B_setup()

    return {
        "A_x": _A_in["x"],
        "A_wqkv": _A_in["wqkv"],
        "A_wo": _A_in["wo"],
        "B_x": _B_in["x"],
        "B_w1": _B_in["w1"],
        "B_w3": _B_in["w3"],
        "B_w2": _B_in["w2"],
    }

def reference(A_x, A_wqkv, A_wo, B_x, B_w1, B_w3, B_w2):
    def _A_ref(x, wqkv, wo):
        B, S, D = x.shape
        H = 32; Dh = D // H; W = 256
        qkv = (lambda x, *d: x.permute(*d))((x @ wqkv).reshape(B, S, 3, H, Dh), 2, 0, 3, 1, 4)
        q, k, v = qkv[0], qkv[1], qkv[2]
        scores = torch.einsum("bhqd,bhkd->bhqk", q, k) * (Dh ** -0.5)
        idx = torch.arange(S)
        mask = (idx[:, None] - idx[None, :] >= 0) & (idx[:, None] - idx[None, :] < W)
        scores = torch.where(mask[None, None], scores, -1e9)
        p = _softmax(scores, axis=-1)
        o = torch.einsum("bhqk,bhkd->bhqd", p, v)
        return (lambda x, *d: x.permute(*d))(o, 0, 2, 1, 3).reshape(B, S, D) @ wo

    def _B_ref(x, w1, w3, w2):
        gate = torch.einsum("bsd,df->bsf", x, w1)
        up = torch.einsum("bsd,df->bsf", x, w3)
        h = _silu(gate) * up
        out = torch.einsum("bsf,fd->bsd", h, w2)
        return out

    x = A_x
    h = x + _A_ref(_layernorm(x, axis=-1), A_wqkv, A_wo)
    h2 = h + _B_ref(_layernorm(h, axis=-1), B_w1, B_w3, B_w2)
    return h2
```

```asm
; @launch grid=(256,1,1) block=(256,1,1) lds=163840
.amdgcn_target "amdgcn-amd-amdhsa--gfx950"
.text
.globl sequential_preLN__sliding_block__glu_gated_swiglu__prompt_kernel
.p2align 8
.type sequential_preLN__sliding_block__glu_gated_swiglu__prompt_kernel,@function
sequential_preLN__sliding_block__glu_gated_swiglu__prompt_kernel:
  s_cmp_ge_u32 s2, 256
  s_cbranch_scc1 L_end
  s_load_dwordx16 s[4:19], s[0:1], 0
  s_load_dwordx4 s[20:23], s[0:1], 64
L_pf:
  s_getpc_b64 s[96:97]
  s_lshr_b32 s55, s2, 3
  s_mul_i32 s55, s55, 3072
  s_min_u32 s55, s55, (L_codeend - L_pf - 3080)
  v_mul_u32_u24 v2, 12, v0
  v_add_u32 v2, s55, v2
  global_load_dwordx3 v[20:22], v2, s[96:97]
  v_lshrrev_b32 v1, 6, v0
  v_and_b32 v0, 63, v0
  v_readfirstlane_b32 s3, v1
  s_and_b32 s64, s2, 7
  s_and_b32 s50, s2, 3
  s_lshl_b32 s50, s50, 2
  s_bfe_u32 s55, s2, 0x20003
  s_add_u32 s50, s50, s55
  s_bfe_u32 s51, s2, 0x10002
  s_lshl_b32 s51, s51, 3
  s_lshr_b32 s56, s2, 5
  s_add_u32 s51, s51, s56
  s_and_b32 s55, s55, 1
  s_lshl_b32 s55, s55, 3
  s_lshr_b32 s2, s50, 1
  s_or_b32 s2, s2, s55
  s_lshl_b32 s55, s51, 4
  s_or_b32 s2, s2, s55
  s_mov_b32 s52, s50
  s_mov_b32 s53, s51
  s_lshl_b32 s56, s50, 3
  s_and_b32 s56, s56, 8
  s_and_b32 s57, s51, 7
  s_or_b32 s56, s56, s57
  s_cmp_eq_u32 s56, 15
  s_cselect_b32 s56, 8, 0
  s_xor_b32 s53, s51, s56
  v_and_b32 v7, 15, v0
  v_lshrrev_b32 v13, 4, v0
  v_lshlrev_b32 v14, 4, v0
  v_lshrrev_b32 v2, 3, v0
  v_lshl_add_u32 v2, v1, 5, v2
  v_mul_u32_u24 v2, 1280, v2
  v_and_b32 v3, 7, v0
  v_xor_b32 v3, v3, v13
  v_lshl_add_u32 v84, v3, 4, v2
  v_xor_b32 v3, 4, v3
  v_lshl_add_u32 v85, v3, 4, v2
  v_add_u32 v86, 18432, v84
  v_add_u32 v87, 27648, v85
  v_add_u32 v85, 9216, v85
  v_lshl_add_u32 v2, v1, 4, v13
  v_mul_u32_u24 v2, 3840, v2
  v_and_b32 v4, 1, v0
  v_lshl_add_u32 v2, v4, 4, v2
  v_lshrrev_b32 v3, 1, v7
  v_xor_b32 v3, v3, v13
  v_lshl_add_u32 v88, v3, 5, v2
  v_xor_b32 v3, 4, v3
  v_lshl_add_u32 v90, v3, 5, v2
  v_add_u32 v89, 14336, v88
  v_add_u32 v91, 43008, v90
  v_add_u32 v90, 28672, v90
  s_add_u32 s64, s52, s53
  s_mul_i32 s55, s64, 26
  s_lshr_b32 s55, s55, 8
  s_mul_i32 s55, s55, 10
  s_sub_u32 s64, s64, s55
  s_mul_i32 s65, s52, 163840
  s_lshl_b32 s66, s53, 8
  s_lshl_b32 s55, s64, 7
  s_add_u32 s65, s65, s55
  s_mul_i32 s55, s64, 245760
  s_add_u32 s66, s66, s55
  s_lshl_b32 s67, s3, 12
  s_mov_b32 s70, 245760
  s_movk_i32 s71, 128
  s_mov_b32 s26, 2621440
  s_mov_b32 s27, 0x20000
  s_mov_b32 s30, 2457600
  s_mov_b32 s31, 0x20000
  s_lshl_b32 s98, s50, 9
  s_add_u32 s98, s98, 131072
  s_lshl_b32 s54, s51, 3
  s_add_u32 s54, s54, s98
  s_lshl_b32 s55, s51, 13
  s_add_u32 s98, s98, s55
  s_mov_b32 s34, 268435456
  s_mov_b32 s35, 0x20000
  s_waitcnt lgkmcnt(0)
  s_mov_b64 s[24:25], s[4:5]
  s_mov_b64 s[28:29], s[6:7]
  s_mov_b64 s[32:33], s[22:23]
  s_load_dwordx2 s[48:49], s[22:23], 32768
  s_cmp_eq_u32 s53, 15
  s_cbranch_scc1 L_nodma
  s_add_u32 m0, s67, 0
  s_nop 0
  buffer_load_dwordx4 v84, s[24:27], s65 offen offset:0 lds
  buffer_load_dwordx4 v85, s[24:27], s65 offen offset:1024 lds
  buffer_load_dwordx4 v86, s[24:27], s65 offen offset:2048 lds
  buffer_load_dwordx4 v87, s[24:27], s65 offen offset:3072 lds
  s_add_u32 s64, s64, 1
  s_cmp_eq_u32 s64, 10
  s_cselect_b32 s55, -1152, s71
  s_cselect_b32 s69, -2211840, s70
  s_add_u32 s65, s65, s55
  s_add_u32 m0, s67, 16384
  s_nop 0
  buffer_load_dwordx4 v88, s[28:31], s66 offen offset:0 lds
  buffer_load_dwordx4 v89, s[28:31], s66 offen offset:1024 lds
  buffer_load_dwordx4 v90, s[28:31], s66 offen offset:2048 lds
  buffer_load_dwordx4 v91, s[28:31], s66 offen offset:3072 lds
  s_add_u32 s66, s66, s69
  s_add_u32 m0, s67, 32768
  s_nop 0
  buffer_load_dwordx4 v84, s[24:27], s65 offen offset:0 lds
  buffer_load_dwordx4 v85, s[24:27], s65 offen offset:1024 lds
  buffer_load_dwordx4 v86, s[24:27], s65 offen offset:2048 lds
  buffer_load_dwordx4 v87, s[24:27], s65 offen offset:3072 lds
  s_add_u32 s64, s64, 1
  s_cmp_eq_u32 s64, 10
  s_cselect_b32 s55, -1152, s71
  s_cselect_b32 s69, -2211840, s70
  s_add_u32 s65, s65, s55
L_nodma:
  v_lshlrev_b32 v12, 13, v7
  s_lshl_b32 s55, s2, 3
  s_add_u32 s55, s55, 262144
  s_sub_u32 s55, s55, s54
  v_writelane_b32 v12, s55, 16
  s_mov_b64 s[36:37], s[18:19]
  s_mov_b32 s38, 2621440
  s_mov_b32 s39, 0x20000
  s_mov_b64 s[40:41], s[12:13]
  s_mov_b32 s42, 1966080
  s_mov_b32 s43, 0x20000
  s_mov_b64 s[44:45], s[14:15]
  s_mov_b32 s46, 1966080
  s_mov_b32 s47, 0x20000
  s_mov_b64 s[72:73], s[8:9]
  s_mov_b32 s74, 819200
  s_mov_b32 s75, 0x20000
  s_mov_b64 s[76:77], s[16:17]
  s_mov_b32 s78, 1966080
  s_mov_b32 s79, 0x20000
  s_lshl_b32 s55, s50, 2
  s_add_u32 s55, s55, s3
  s_mul_i32 s55, s55, 40960
  s_mul_i32 s56, s51, 2560
  s_add_u32 s55, s55, s56
  s_add_u32 s55, s55, 9439232
  v_lshl_add_u32 v92, v0, 6, s55
  s_lshl_b32 s55, s50, 4
  s_add_u32 s55, s55, s51
  s_lshl_b32 s55, s55, 2
  s_add_u32 s55, s55, s3
  s_lshl_b32 s55, s55, 7
  s_add_u32 s55, s55, 23068672
  s_add_u32 s56, s55, 64
  s_lshl_b32 s57, s3, 7
  s_add_u32 s57, s57, s98
  s_add_u32 s58, s57, 64
  s_lshl_b32 s59, s2, 7
  s_lshl_b32 s60, s2, 3
  s_add_u32 s60, s60, 262144
  s_lshl_b32 s61, s50, 3
  s_add_u32 s61, s61, 32896
  v_lshl_add_u32 v3, v7, 21, s59
  v_cmp_gt_u32 vcc, 16, v0
  s_nop 1
  v_cndmask_b32 v92, v3, v92, vcc
  v_writelane_b32 v92, s55, 8
  v_writelane_b32 v92, s56, 9
  v_writelane_b32 v92, s57, 10
  v_writelane_b32 v92, s58, 11
  v_writelane_b32 v92, s59, 12
  v_writelane_b32 v92, s60, 13
  v_writelane_b32 v92, s61, 14
  s_mul_i32 s55, s3, 192
  s_movk_i32 s56, 2880
  v_add_u32 v2, s55, v0
  v_mul_u32_u24 v3, 5462, v2
  v_lshrrev_b32 v3, 16, v3
  v_lshlrev_b32 v2, 2, v2
  v_and_b32 v4, 8, v3
  v_xor_b32 v2, v2, v4
  v_lshlrev_b32 v2, 2, v2
  v_mad_u32_u24 v15, v3, s56, v2
  v_add_u32 v2, s55, v0
  v_add_u32 v2, 64, v2
  v_mul_u32_u24 v3, 5462, v2
  v_lshrrev_b32 v3, 16, v3
  v_lshlrev_b32 v2, 2, v2
  v_and_b32 v4, 8, v3
  v_xor_b32 v2, v2, v4
  v_lshlrev_b32 v2, 2, v2
  v_mad_u32_u24 v16, v3, s56, v2
  v_subrev_u32 v16, 1024, v16
  v_add_u32 v2, s55, v0
  v_add_u32 v2, 128, v2
  v_mul_u32_u24 v3, 5462, v2
  v_lshrrev_b32 v3, 16, v3
  v_lshlrev_b32 v2, 2, v2
  v_and_b32 v4, 8, v3
  v_xor_b32 v2, v2, v4
  v_lshlrev_b32 v2, 2, v2
  v_mad_u32_u24 v17, v3, s56, v2
  v_subrev_u32 v17, 2048, v17
  v_bfe_u32 v2, v0, 2, 2
  v_lshl_add_u32 v2, v13, 3, v2
  v_mul_u32_u24 v2, 192, v2
  s_mul_i32 s55, s3, 48
  s_add_u32 s55, s55, 114688
  v_add_u32 v2, s55, v2
  v_and_b32 v3, 3, v0
  v_lshl_add_u32 v18, v3, 3, v2
  v_and_b32 v3, 1, v0
  v_lshl_add_u32 v2, v3, 3, v2
  v_bfe_u32 v3, v0, 1, 1
  v_mul_u32_u24 v3, 12288, v3
  v_add3_u32 v19, v2, v3, 32
  v_and_b32 v3, 16, v0
  v_lshlrev_b32 v3, 1, v3
  v_xor_b32 v18, v18, v3
  v_xor_b32 v19, v19, v3
  s_waitcnt lgkmcnt(0)
  s_xor_b32 s49, s49, 1540483477
  v_mov_b32 v11, s49
  s_and_b32 s14, s51, 7
  s_lshr_b32 s15, s51, 3
  s_and_b32 s56, s51, 1
  s_lshl_b32 s56, s56, 2
  s_xor_b32 s56, s56, s50
  s_bfe_u32 s57, s51, 0x20001
  s_and_b32 s55, s50, 4
  s_or_b32 s57, s57, s55
  s_and_b32 s55, s51, 8
  s_or_b32 s57, s57, s55
  s_and_b32 s22, s56, 7
  s_mul_i32 s22, s22, 5
  s_lshr_b32 s22, s22, 2
  s_lshr_b32 s55, s56, 3
  s_mul_i32 s55, s55, 1
  s_add_u32 s22, s22, s55
  s_add_u32 s22, s22, s57
  s_mul_i32 s55, s22, 26
  s_lshr_b32 s55, s55, 8
  s_mul_i32 s55, s55, 10
  s_sub_u32 s22, s22, s55
  s_mul_i32 s17, s22, 196608
  s_mul_i32 s55, s57, 192
  s_add_u32 s17, s17, s55
  s_mul_i32 s23, s3, 3072
  s_add_u32 s23, s23, 65536
  s_lshl_b32 s55, s14, 2
  s_add_u32 s55, s55, s3
  s_mul_i32 s16, s55, 25600
  s_add_u32 s16, s16, 24117248
  s_mul_i32 s18, s55, 61440
  s_add_u32 s18, s18, 29360128
  s_cmp_eq_u32 s53, 15
  s_cbranch_scc1 L_spare
  v_lshrrev_b32 v2, 1, v7
  v_xor_b32 v2, v2, v13
  v_lshlrev_b32 v2, 4, v2
  v_lshl_add_u32 v186, v7, 7, v2
  v_add_u32 v186, s67, v186
  v_xor_b32 v187, 4096, v186
  v_xor_b32 v188, 8192, v186
  v_xor_b32 v189, 12288, v186
  v_xor_b32 v190, 64, v186
  v_xor_b32 v191, 64, v187
  v_xor_b32 v192, 64, v188
  v_xor_b32 v193, 64, v189
  v_bfe_u32 v2, v0, 2, 2
  v_and_b32 v3, 1, v13
  v_lshl_or_b32 v3, v3, 2, v2
  s_lshl_b32 s55, s3, 1
  v_xor_b32 v3, s55, v3
  v_lshl_add_u32 v2, v13, 3, v2
  v_lshlrev_b32 v2, 8, v2
  v_lshl_add_u32 v2, v3, 5, v2
  v_and_b32 v3, 3, v0
  v_lshl_add_u32 v194, v3, 3, v2
  v_xor_b32 v195, 32, v194
  v_mov_b32 v182, 0x3f803f80
  v_mov_b32 v183, 0x3f803f80
  v_mov_b32 v184, 0x3f803f80
  v_mov_b32 v185, 0x3f803f80
  s_lshl_b32 s55, s3, 7
  s_add_u32 s55, s55, 0
  v_lshl_add_u32 v2, v7, 2, s55
  v_lshlrev_b32 v3, 2, v0
  v_add_u32 v3, 1024, v3
  v_lshrrev_b32 v4, 2, v7
  v_cmp_eq_u32 vcc, v4, v13
  s_nop 1
  v_cndmask_b32 v93, v3, v2, vcc
  s_mov_b32 s88, 0x22222222
  s_mov_b32 s89, 0x22222222
  s_mov_b32 s90, 0x44444444
  s_mov_b32 s91, 0x44444444
  s_mov_b32 s92, 0x88888888
  s_mov_b32 s93, 0x88888888
  s_cmp_lt_u32 s53, 5
  s_cselect_b32 s94, 0x3ea52b5c, 1.0
  s_mul_i32 s56, s53, 52
  s_lshr_b32 s56, s56, 8
  s_mul_i32 s57, s56, 5
  s_sub_u32 s57, s53, s57
  s_mul_i32 s58, s52, 3
  s_add_u32 s56, s56, s58
  s_lshl_b32 s58, s56, 2
  s_add_u32 s58, s58, s3
  s_mul_i32 s80, s58, 10240
  s_lshl_b32 s58, s57, 8
  s_add_u32 s80, s80, s58
  v_mul_u32_u24 v3, 1280, v13
  v_lshl_add_u32 v234, v7, 4, v3
  s_mul_i32 s56, s56, 5120
  s_add_u32 s56, s56, 29360128
  s_lshl_b32 s57, s57, 2
  s_add_u32 s57, s57, s3
  s_lshl_b32 s57, s57, 1
  s_mul_i32 s58, s57, 52
  s_lshr_b32 s58, s58, 8
  s_mul_i32 s58, s58, 240640
  s_lshl_b32 s59, s57, 10
  s_add_u32 s58, s58, s59
  s_add_u32 s81, s58, s56
  s_add_u32 s57, s57, 1
  s_mul_i32 s58, s57, 52
  s_lshr_b32 s58, s58, 8
  s_mul_i32 s58, s58, 240640
  s_lshl_b32 s59, s57, 10
  s_add_u32 s58, s58, s59
  s_add_u32 s82, s58, s56
  s_lshl_b32 s83, s3, 11
  s_cmp_ge_u32 s53, 10
  s_cbranch_scc1 L_p1v
  v_mov_b32 v196, v2
  v_and_b32 v2, 1, v13
  v_lshlrev_b32 v2, 10, v2
  v_lshrrev_b32 v3, 1, v13
  v_lshl_add_u32 v2, v3, 9, v2
  v_lshl_add_u32 v200, v7, 4, v2
  s_lshl_b32 s56, s53, 13
  s_lshl_b32 s57, s3, 11
  s_add_u32 s56, s56, s57
  s_add_u32 s56, s56, 1048576
  v_xor_b32 v197, 128, v196
  v_xor_b32 v198, 256, v196
  v_xor_b32 v199, 384, v196
  s_lshl_b32 s57, s52, 2
  s_add_u32 s57, s57, s3
  s_xor_b32 s58, s57, 0
  s_mul_i32 s58, s58, 122880
  s_add_u32 s4, s58, s56
  s_xor_b32 s58, s57, 1
  s_mul_i32 s58, s58, 122880
  s_add_u32 s5, s58, s56
  s_xor_b32 s58, s57, 2
  s_mul_i32 s58, s58, 122880
  s_add_u32 s6, s58, s56
  s_xor_b32 s58, s57, 3
  s_mul_i32 s58, s58, 122880
  s_add_u32 s7, s58, s56
  s_add_u32 m0, s67, 49152
  s_nop 0
  buffer_load_dwordx4 v88, s[28:31], s66 offen offset:0 lds
  buffer_load_dwordx4 v89, s[28:31], s66 offen offset:1024 lds
  buffer_load_dwordx4 v90, s[28:31], s66 offen offset:2048 lds
  buffer_load_dwordx4 v91, s[28:31], s66 offen offset:3072 lds
  s_add_u32 s66, s66, s69
  s_add_u32 m0, s67, 65536
  s_nop 0
  buffer_load_dwordx4 v84, s[24:27], s65 offen offset:0 lds
  buffer_load_dwordx4 v85, s[24:27], s65 offen offset:1024 lds
  buffer_load_dwordx4 v86, s[24:27], s65 offen offset:2048 lds
  buffer_load_dwordx4 v87, s[24:27], s65 offen offset:3072 lds
  s_add_u32 s64, s64, 1
  s_cmp_eq_u32 s64, 10
  s_cselect_b32 s55, -1152, s71
  s_cselect_b32 s69, -2211840, s70
  s_add_u32 s65, s65, s55
  s_add_u32 m0, s67, 81920
  s_nop 0
  buffer_load_dwordx4 v88, s[28:31], s66 offen offset:0 lds
  buffer_load_dwordx4 v89, s[28:31], s66 offen offset:1024 lds
  buffer_load_dwordx4 v90, s[28:31], s66 offen offset:2048 lds
  buffer_load_dwordx4 v91, s[28:31], s66 offen offset:3072 lds
  s_add_u32 s66, s66, s69
  s_waitcnt vmcnt(16)
  s_barrier
  ds_read_b64_tr_b16 a[64:65], v194 offset:16384
  ds_read_b64_tr_b16 a[66:67], v194 offset:17408
  ds_read_b64_tr_b16 a[68:69], v195 offset:16384
  ds_read_b64_tr_b16 a[70:71], v195 offset:17408
  ds_read_b128 a[0:3], v186 offset:0
  ds_read_b128 a[4:7], v186 offset:2048
  ds_read_b128 a[8:11], v187 offset:0
  ds_read_b128 a[12:15], v187 offset:2048
  ds_read_b128 a[16:19], v188 offset:0
  ds_read_b128 a[20:23], v188 offset:2048
  ds_read_b128 a[24:27], v189 offset:0
  ds_read_b128 a[28:31], v189 offset:2048
  s_waitcnt lgkmcnt(10)
  v_mfma_f32_16x16x32_bf16 v[158:161], a[64:67], v[182:185], 0
  ds_read_b64_tr_b16 a[72:73], v194 offset:24576
  s_waitcnt lgkmcnt(9)
  v_mfma_f32_16x16x32_bf16 v[162:165], a[68:71], v[182:185], 0
  ds_read_b64_tr_b16 a[74:75], v194 offset:25600
  s_add_u32 m0, s67, 98304
  s_waitcnt lgkmcnt(9)
  v_mfma_f32_16x16x32_bf16 v[94:97], a[64:67], a[0:3], 0
  ds_read_b64_tr_b16 a[76:77], v195 offset:24576
  buffer_load_dwordx4 v84, s[24:27], s65 offen offset:0 lds
  v_mfma_f32_16x16x32_bf16 v[98:101], a[68:71], a[0:3], 0
  ds_read_b64_tr_b16 a[78:79], v195 offset:25600
  s_waitcnt lgkmcnt(10)
  v_mfma_f32_16x16x32_bf16 v[102:105], a[64:67], a[4:7], 0
  ds_read_b128 a[32:35], v190 offset:0
  v_mfma_f32_16x16x32_bf16 v[106:109], a[68:71], a[4:7], 0
  ds_read_b128 a[36:39], v190 offset:2048
  v_mfma_f32_16x16x32_bf16 v[166:169], v[182:185], a[0:3], 0
  ds_read_b128 a[40:43], v191 offset:0
  v_mfma_f32_16x16x32_bf16 v[174:177], a[0:3], a[0:3], 0
  ds_read_b128 a[44:47], v191 offset:2048
  v_mfma_f32_16x16x32_bf16 v[170:173], v[182:185], a[4:7], 0
  ds_read_b128 a[48:51], v192 offset:0
  buffer_load_dwordx4 v85, s[24:27], s65 offen offset:1024 lds
  v_mfma_f32_16x16x32_bf16 v[178:181], a[4:7], a[4:7], 0
  ds_read_b128 a[52:55], v192 offset:2048
  s_waitcnt lgkmcnt(15)
  v_mfma_f32_16x16x32_bf16 v[110:113], a[64:67], a[8:11], 0
  ds_read_b128 a[56:59], v193 offset:0
  v_mfma_f32_16x16x32_bf16 v[114:117], a[68:71], a[8:11], 0
  ds_read_b128 a[60:63], v193 offset:2048
  s_waitcnt lgkmcnt(15)
  v_mfma_f32_16x16x32_bf16 v[118:121], a[64:67], a[12:15], 0
  v_mfma_f32_16x16x32_bf16 v[122:125], a[68:71], a[12:15], 0
  buffer_load_dwordx4 v86, s[24:27], s65 offen offset:2048 lds
  v_mfma_f32_16x16x32_bf16 v[126:129], a[64:67], a[16:19], 0
  v_mfma_f32_16x16x32_bf16 v[130:133], a[68:71], a[16:19], 0
  s_waitcnt lgkmcnt(14)
  v_mfma_f32_16x16x32_bf16 v[134:137], a[64:67], a[20:23], 0
  v_mfma_f32_16x16x32_bf16 v[138:141], a[68:71], a[20:23], 0
  s_waitcnt lgkmcnt(13)
  v_mfma_f32_16x16x32_bf16 v[142:145], a[64:67], a[24:27], 0
  v_mfma_f32_16x16x32_bf16 v[146:149], a[68:71], a[24:27], 0
  buffer_load_dwordx4 v87, s[24:27], s65 offen offset:3072 lds
  s_add_u32 s64, s64, 1
  s_cmp_eq_u32 s64, 10
  s_cselect_b32 s55, -1152, s71
  s_cselect_b32 s69, -2211840, s70
  s_add_u32 s65, s65, s55
  s_waitcnt lgkmcnt(12)
  v_mfma_f32_16x16x32_bf16 v[150:153], a[64:67], a[28:31], 0
  v_mfma_f32_16x16x32_bf16 v[154:157], a[68:71], a[28:31], 0
  s_waitcnt vmcnt(12)
  s_waitcnt lgkmcnt(0)
  s_barrier
  v_mfma_f32_16x16x32_bf16 v[158:161], a[72:75], v[182:185], v[158:161]
  ds_read_b64_tr_b16 a[64:65], v194 offset:49152
  v_mfma_f32_16x16x32_bf16 v[162:165], a[76:79], v[182:185], v[162:165]
  ds_read_b64_tr_b16 a[66:67], v194 offset:50176
  s_add_u32 m0, s67, 114688
  v_mfma_f32_16x16x32_bf16 v[94:97], a[72:75], a[32:35], v[94:97]
  ds_read_b64_tr_b16 a[68:69], v195 offset:49152
  buffer_load_dwordx4 v88, s[28:31], s66 offen offset:0 lds
  v_mfma_f32_16x16x32_bf16 v[98:101], a[76:79], a[32:35], v[98:101]
  ds_read_b64_tr_b16 a[70:71], v195 offset:50176
  v_mfma_f32_16x16x32_bf16 v[102:105], a[72:75], a[36:39], v[102:105]
  ds_read_b128 a[0:3], v186 offset:32768
  v_mfma_f32_16x16x32_bf16 v[106:109], a[76:79], a[36:39], v[106:109]
  ds_read_b128 a[4:7], v186 offset:34816
  v_mfma_f32_16x16x32_bf16 v[166:169], v[182:185], a[32:35], v[166:169]
  ds_read_b128 a[8:11], v187 offset:32768
  v_mfma_f32_16x16x32_bf16 v[174:177], a[32:35], a[32:35], v[174:177]
  ds_read_b128 a[12:15], v187 offset:34816
  v_mfma_f32_16x16x32_bf16 v[170:173], v[182:185], a[36:39], v[170:173]
  ds_read_b128 a[16:19], v188 offset:32768
  buffer_load_dwordx4 v89, s[28:31], s66 offen offset:1024 lds
  v_mfma_f32_16x16x32_bf16 v[178:181], a[36:39], a[36:39], v[178:181]
  ds_read_b128 a[20:23], v188 offset:34816
  v_mfma_f32_16x16x32_bf16 v[110:113], a[72:75], a[40:43], v[110:113]
  ds_read_b128 a[24:27], v189 offset:32768
  v_mfma_f32_16x16x32_bf16 v[114:117], a[76:79], a[40:43], v[114:117]
  ds_read_b128 a[28:31], v189 offset:34816
  v_mfma_f32_16x16x32_bf16 v[118:121], a[72:75], a[44:47], v[118:121]
  v_mfma_f32_16x16x32_bf16 v[122:125], a[76:79], a[44:47], v[122:125]
  buffer_load_dwordx4 v90, s[28:31], s66 offen offset:2048 lds
  v_mfma_f32_16x16x32_bf16 v[126:129], a[72:75], a[48:51], v[126:129]
  v_mfma_f32_16x16x32_bf16 v[130:133], a[76:79], a[48:51], v[130:133]
  v_mfma_f32_16x16x32_bf16 v[134:137], a[72:75], a[52:55], v[134:137]
  v_mfma_f32_16x16x32_bf16 v[138:141], a[76:79], a[52:55], v[138:141]
  v_mfma_f32_16x16x32_bf16 v[142:145], a[72:75], a[56:59], v[142:145]
  v_mfma_f32_16x16x32_bf16 v[146:149], a[76:79], a[56:59], v[146:149]
  buffer_load_dwordx4 v91, s[28:31], s66 offen offset:3072 lds
  s_add_u32 s66, s66, s69
  v_mfma_f32_16x16x32_bf16 v[150:153], a[72:75], a[60:63], v[150:153]
  v_mfma_f32_16x16x32_bf16 v[154:157], a[76:79], a[60:63], v[154:157]
  s_waitcnt lgkmcnt(0)
  v_mfma_f32_16x16x32_bf16 v[158:161], a[64:67], v[182:185], v[158:161]
  ds_read_b64_tr_b16 a[72:73], v194 offset:57344
  v_mfma_f32_16x16x32_bf16 v[162:165], a[68:71], v[182:185], v[162:165]
  ds_read_b64_tr_b16 a[74:75], v194 offset:58368
  s_add_u32 m0, s67, 0
  v_mfma_f32_16x16x32_bf16 v[94:97], a[64:67], a[0:3], v[94:97]
  ds_read_b64_tr_b16 a[76:77], v195 offset:57344
  buffer_load_dwordx4 v84, s[24:27], s65 offen offset:0 lds
  v_mfma_f32_16x16x32_bf16 v[98:101], a[68:71], a[0:3], v[98:101]
  ds_read_b64_tr_b16 a[78:79], v195 offset:58368
  v_mfma_f32_16x16x32_bf16 v[102:105], a[64:67], a[4:7], v[102:105]
  ds_read_b128 a[32:35], v190 offset:32768
  v_mfma_f32_16x16x32_bf16 v[106:109], a[68:71], a[4:7], v[106:109]
  ds_read_b128 a[36:39], v190 offset:34816
  v_mfma_f32_16x16x32_bf16 v[166:169], v[182:185], a[0:3], v[166:169]
  ds_read_b128 a[40:43], v191 offset:32768
  buffer_load_dwordx4 v85, s[24:27], s65 offen offset:1024 lds
  v_mfma_f32_16x16x32_bf16 v[174:177], a[0:3], a[0:3], v[174:177]
  ds_read_b128 a[44:47], v191 offset:34816
  v_mfma_f32_16x16x32_bf16 v[170:173], v[182:185], a[4:7], v[170:173]
  ds_read_b128 a[48:51], v192 offset:32768
  v_mfma_f32_16x16x32_bf16 v[178:181], a[4:7], a[4:7], v[178:181]
  ds_read_b128 a[52:55], v192 offset:34816
  v_mfma_f32_16x16x32_bf16 v[110:113], a[64:67], a[8:11], v[110:113]
  ds_read_b128 a[56:59], v193 offset:32768
  v_mfma_f32_16x16x32_bf16 v[114:117], a[68:71], a[8:11], v[114:117]
  ds_read_b128 a[60:63], v193 offset:34816
  buffer_load_dwordx4 v86, s[24:27], s65 offen offset:2048 lds
  v_mfma_f32_16x16x32_bf16 v[118:121], a[64:67], a[12:15], v[118:121]
  v_xor_b32 v186, 0x10000, v186
  v_mfma_f32_16x16x32_bf16 v[122:125], a[68:71], a[12:15], v[122:125]
  v_xor_b32 v187, 0x10000, v187
  v_mfma_f32_16x16x32_bf16 v[126:129], a[64:67], a[16:19], v[126:129]
  v_xor_b32 v188, 0x10000, v188
  v_mfma_f32_16x16x32_bf16 v[130:133], a[68:71], a[16:19], v[130:133]
  buffer_load_dwordx4 v87, s[24:27], s65 offen offset:3072 lds
  s_add_u32 s64, s64, 1
  s_cmp_eq_u32 s64, 10
  s_cselect_b32 s55, -1152, s71
  s_cselect_b32 s69, -2211840, s70
  s_add_u32 s65, s65, s55
  v_xor_b32 v189, 0x10000, v189
  v_mfma_f32_16x16x32_bf16 v[134:137], a[64:67], a[20:23], v[134:137]
  v_xor_b32 v190, 0x10000, v190
  v_mfma_f32_16x16x32_bf16 v[138:141], a[68:71], a[20:23], v[138:141]
  v_xor_b32 v191, 0x10000, v191
  v_mfma_f32_16x16x32_bf16 v[142:145], a[64:67], a[24:27], v[142:145]
  v_xor_b32 v192, 0x10000, v192
  v_mfma_f32_16x16x32_bf16 v[146:149], a[68:71], a[24:27], v[146:149]
  s_mov_b64 exec, 0x47fe7fff
  buffer_load_dword v92, v92, s[32:35], 0 offen sc1
  s_mov_b64 exec, -1
  v_xor_b32 v193, 0x10000, v193
  v_mfma_f32_16x16x32_bf16 v[150:153], a[64:67], a[28:31], v[150:153]
  v_xor_b32 v194, 0x10000, v194
  v_mfma_f32_16x16x32_bf16 v[154:157], a[68:71], a[28:31], v[154:157]
  v_xor_b32 v195, 0x10000, v195
  s_waitcnt vmcnt(13)
  s_waitcnt lgkmcnt(0)
  s_barrier
  v_mfma_f32_16x16x32_bf16 v[158:161], a[72:75], v[182:185], v[158:161]
  ds_read_b64_tr_b16 a[64:65], v194 offset:16384
  v_mfma_f32_16x16x32_bf16 v[162:165], a[76:79], v[182:185], v[162:165]
  ds_read_b64_tr_b16 a[66:67], v194 offset:17408
  s_add_u32 m0, s67, 16384
  v_mfma_f32_16x16x32_bf16 v[94:97], a[72:75], a[32:35], v[94:97]
  ds_read_b64_tr_b16 a[68:69], v195 offset:16384
  buffer_load_dwordx4 v88, s[28:31], s66 offen offset:0 lds
  v_mfma_f32_16x16x32_bf16 v[98:101], a[76:79], a[32:35], v[98:101]
  ds_read_b64_tr_b16 a[70:71], v195 offset:17408
  v_mfma_f32_16x16x32_bf16 v[102:105], a[72:75], a[36:39], v[102:105]
  ds_read_b128 a[0:3], v186 offset:0
  v_mfma_f32_16x16x32_bf16 v[106:109], a[76:79], a[36:39], v[106:109]
  ds_read_b128 a[4:7], v186 offset:2048
  v_mfma_f32_16x16x32_bf16 v[166:169], v[182:185], a[32:35], v[166:169]
  ds_read_b128 a[8:11], v187 offset:0
  v_mfma_f32_16x16x32_bf16 v[174:177], a[32:35], a[32:35], v[174:177]
  ds_read_b128 a[12:15], v187 offset:2048
  v_mfma_f32_16x16x32_bf16 v[170:173], v[182:185], a[36:39], v[170:173]
  ds_read_b128 a[16:19], v188 offset:0
  buffer_load_dwordx4 v89, s[28:31], s66 offen offset:1024 lds
  v_mfma_f32_16x16x32_bf16 v[178:181], a[36:39], a[36:39], v[178:181]
  ds_read_b128 a[20:23], v188 offset:2048
  v_mfma_f32_16x16x32_bf16 v[110:113], a[72:75], a[40:43], v[110:113]
  ds_read_b128 a[24:27], v189 offset:0
  v_mfma_f32_16x16x32_bf16 v[114:117], a[76:79], a[40:43], v[114:117]
  ds_read_b128 a[28:31], v189 offset:2048
  v_mfma_f32_16x16x32_bf16 v[118:121], a[72:75], a[44:47], v[118:121]
  v_mfma_f32_16x16x32_bf16 v[122:125], a[76:79], a[44:47], v[122:125]
  buffer_load_dwordx4 v90, s[28:31], s66 offen offset:2048 lds
  v_mfma_f32_16x16x32_bf16 v[126:129], a[72:75], a[48:51], v[126:129]
  v_mfma_f32_16x16x32_bf16 v[130:133], a[76:79], a[48:51], v[130:133]
  v_mfma_f32_16x16x32_bf16 v[134:137], a[72:75], a[52:55], v[134:137]
  v_mfma_f32_16x16x32_bf16 v[138:141], a[76:79], a[52:55], v[138:141]
  v_mfma_f32_16x16x32_bf16 v[142:145], a[72:75], a[56:59], v[142:145]
  v_mfma_f32_16x16x32_bf16 v[146:149], a[76:79], a[56:59], v[146:149]
  buffer_load_dwordx4 v91, s[28:31], s66 offen offset:3072 lds
  s_add_u32 s66, s66, s69
  v_mfma_f32_16x16x32_bf16 v[150:153], a[72:75], a[60:63], v[150:153]
  v_mfma_f32_16x16x32_bf16 v[154:157], a[76:79], a[60:63], v[154:157]
  s_waitcnt lgkmcnt(0)
  v_mfma_f32_16x16x32_bf16 v[158:161], a[64:67], v[182:185], v[158:161]
  ds_read_b64_tr_b16 a[72:73], v194 offset:24576
  v_mfma_f32_16x16x32_bf16 v[162:165], a[68:71], v[182:185], v[162:165]
  ds_read_b64_tr_b16 a[74:75], v194 offset:25600
  s_add_u32 m0, s67, 32768
  v_mfma_f32_16x16x32_bf16 v[94:97], a[64:67], a[0:3], v[94:97]
  ds_read_b64_tr_b16 a[76:77], v195 offset:24576
  buffer_load_dwordx4 v84, s[24:27], s65 offen offset:0 lds
  v_mfma_f32_16x16x32_bf16 v[98:101], a[68:71], a[0:3], v[98:101]
  ds_read_b64_tr_b16 a[78:79], v195 offset:25600
  v_mfma_f32_16x16x32_bf16 v[102:105], a[64:67], a[4:7], v[102:105]
  ds_read_b128 a[32:35], v190 offset:0
  v_mfma_f32_16x16x32_bf16 v[106:109], a[68:71], a[4:7], v[106:109]
  ds_read_b128 a[36:39], v190 offset:2048
  v_mfma_f32_16x16x32_bf16 v[166:169], v[182:185], a[0:3], v[166:169]
  ds_read_b128 a[40:43], v191 offset:0
  v_mfma_f32_16x16x32_bf16 v[174:177], a[0:3], a[0:3], v[174:177]
  ds_read_b128 a[44:47], v191 offset:2048
  v_mfma_f32_16x16x32_bf16 v[170:173], v[182:185], a[4:7], v[170:173]
  ds_read_b128 a[48:51], v192 offset:0
  buffer_load_dwordx4 v85, s[24:27], s65 offen offset:1024 lds
  v_mfma_f32_16x16x32_bf16 v[178:181], a[4:7], a[4:7], v[178:181]
  ds_read_b128 a[52:55], v192 offset:2048
  v_mfma_f32_16x16x32_bf16 v[110:113], a[64:67], a[8:11], v[110:113]
  ds_read_b128 a[56:59], v193 offset:0
  v_mfma_f32_16x16x32_bf16 v[114:117], a[68:71], a[8:11], v[114:117]
  ds_read_b128 a[60:63], v193 offset:2048
  v_mfma_f32_16x16x32_bf16 v[118:121], a[64:67], a[12:15], v[118:121]
  v_mfma_f32_16x16x32_bf16 v[122:125], a[68:71], a[12:15], v[122:125]
  buffer_load_dwordx4 v86, s[24:27], s65 offen offset:2048 lds
  v_mfma_f32_16x16x32_bf16 v[126:129], a[64:67], a[16:19], v[126:129]
  v_mfma_f32_16x16x32_bf16 v[130:133], a[68:71], a[16:19], v[130:133]
  v_mfma_f32_16x16x32_bf16 v[134:137], a[64:67], a[20:23], v[134:137]
  v_mfma_f32_16x16x32_bf16 v[138:141], a[68:71], a[20:23], v[138:141]
  v_mfma_f32_16x16x32_bf16 v[142:145], a[64:67], a[24:27], v[142:145]
  v_mfma_f32_16x16x32_bf16 v[146:149], a[68:71], a[24:27], v[146:149]
  buffer_load_dwordx4 v87, s[24:27], s65 offen offset:3072 lds
  s_add_u32 s64, s64, 1
  s_cmp_eq_u32 s64, 10
  s_cselect_b32 s55, -1152, s71
  s_cselect_b32 s69, -2211840, s70
  s_add_u32 s65, s65, s55
  v_mfma_f32_16x16x32_bf16 v[150:153], a[64:67], a[28:31], v[150:153]
  v_mfma_f32_16x16x32_bf16 v[154:157], a[68:71], a[28:31], v[154:157]
  s_waitcnt vmcnt(13)
  s_waitcnt lgkmcnt(0)
  s_barrier
  v_mfma_f32_16x16x32_bf16 v[158:161], a[72:75], v[182:185], v[158:161]
  ds_read_b64_tr_b16 a[64:65], v194 offset:49152
  v_mfma_f32_16x16x32_bf16 v[162:165], a[76:79], v[182:185], v[162:165]
  ds_read_b64_tr_b16 a[66:67], v194 offset:50176
  s_add_u32 m0, s67, 49152
  v_mfma_f32_16x16x32_bf16 v[94:97], a[72:75], a[32:35], v[94:97]
  ds_read_b64_tr_b16 a[68:69], v195 offset:49152
  buffer_load_dwordx4 v88, s[28:31], s66 offen offset:0 lds
  v_mfma_f32_16x16x32_bf16 v[98:101], a[76:79], a[32:35], v[98:101]
  ds_read_b64_tr_b16 a[70:71], v195 offset:50176
  v_mfma_f32_16x16x32_bf16 v[102:105], a[72:75], a[36:39], v[102:105]
  ds_read_b128 a[0:3], v186 offset:32768
  v_mfma_f32_16x16x32_bf16 v[106:109], a[76:79], a[36:39], v[106:109]
  ds_read_b128 a[4:7], v186 offset:34816
  v_mfma_f32_16x16x32_bf16 v[166:169], v[182:185], a[32:35], v[166:169]
  ds_read_b128 a[8:11], v187 offset:32768
  v_mfma_f32_16x16x32_bf16 v[174:177], a[32:35], a[32:35], v[174:177]
  ds_read_b128 a[12:15], v187 offset:34816
  v_mfma_f32_16x16x32_bf16 v[170:173], v[182:185], a[36:39], v[170:173]
  ds_read_b128 a[16:19], v188 offset:32768
  buffer_load_dwordx4 v89, s[28:31], s66 offen offset:1024 lds
  v_mfma_f32_16x16x32_bf16 v[178:181], a[36:39], a[36:39], v[178:181]
  ds_read_b128 a[20:23], v188 offset:34816
  v_mfma_f32_16x16x32_bf16 v[110:113], a[72:75], a[40:43], v[110:113]
  ds_read_b128 a[24:27], v189 offset:32768
  v_mfma_f32_16x16x32_bf16 v[114:117], a[76:79], a[40:43], v[114:117]
  ds_read_b128 a[28:31], v189 offset:34816
  v_mfma_f32_16x16x32_bf16 v[118:121], a[72:75], a[44:47], v[118:121]
  v_mfma_f32_16x16x32_bf16 v[122:125], a[76:79], a[44:47], v[122:125]
  buffer_load_dwordx4 v90, s[28:31], s66 offen offset:2048 lds
  v_mfma_f32_16x16x32_bf16 v[126:129], a[72:75], a[48:51], v[126:129]
  v_mfma_f32_16x16x32_bf16 v[130:133], a[76:79], a[48:51], v[130:133]
  v_mfma_f32_16x16x32_bf16 v[134:137], a[72:75], a[52:55], v[134:137]
  v_mfma_f32_16x16x32_bf16 v[138:141], a[76:79], a[52:55], v[138:141]
  v_mfma_f32_16x16x32_bf16 v[142:145], a[72:75], a[56:59], v[142:145]
  v_mfma_f32_16x16x32_bf16 v[146:149], a[76:79], a[56:59], v[146:149]
  buffer_load_dwordx4 v91, s[28:31], s66 offen offset:3072 lds
  s_add_u32 s66, s66, s69
  v_mfma_f32_16x16x32_bf16 v[150:153], a[72:75], a[60:63], v[150:153]
  v_mfma_f32_16x16x32_bf16 v[154:157], a[76:79], a[60:63], v[154:157]
  s_waitcnt lgkmcnt(0)
  v_mfma_f32_16x16x32_bf16 v[158:161], a[64:67], v[182:185], v[158:161]
  ds_read_b64_tr_b16 a[72:73], v194 offset:57344
  v_mfma_f32_16x16x32_bf16 v[162:165], a[68:71], v[182:185], v[162:165]
  ds_read_b64_tr_b16 a[74:75], v194 offset:58368
  s_add_u32 m0, s67, 65536
  v_mfma_f32_16x16x32_bf16 v[94:97], a[64:67], a[0:3], v[94:97]
  ds_read_b64_tr_b16 a[76:77], v195 offset:57344
  buffer_load_dwordx4 v84, s[24:27], s65 offen offset:0 lds
  v_mfma_f32_16x16x32_bf16 v[98:101], a[68:71], a[0:3], v[98:101]
  ds_read_b64_tr_b16 a[78:79], v195 offset:58368
  v_mfma_f32_16x16x32_bf16 v[102:105], a[64:67], a[4:7], v[102:105]
  ds_read_b128 a[32:35], v190 offset:32768
  v_mfma_f32_16x16x32_bf16 v[106:109], a[68:71], a[4:7], v[106:109]
  ds_read_b128 a[36:39], v190 offset:34816
  v_mfma_f32_16x16x32_bf16 v[166:169], v[182:185], a[0:3], v[166:169]
  ds_read_b128 a[40:43], v191 offset:32768
  v_mfma_f32_16x16x32_bf16 v[174:177], a[0:3], a[0:3], v[174:177]
  ds_read_b128 a[44:47], v191 offset:34816
  v_mfma_f32_16x16x32_bf16 v[170:173], v[182:185], a[4:7], v[170:173]
  ds_read_b128 a[48:51], v192 offset:32768
  buffer_load_dwordx4 v85, s[24:27], s65 offen offset:1024 lds
  v_mfma_f32_16x16x32_bf16 v[178:181], a[4:7], a[4:7], v[178:181]
  ds_read_b128 a[52:55], v192 offset:34816
  v_mfma_f32_16x16x32_bf16 v[110:113], a[64:67], a[8:11], v[110:113]
  ds_read_b128 a[56:59], v193 offset:32768
  v_mfma_f32_16x16x32_bf16 v[114:117], a[68:71], a[8:11], v[114:117]
  ds_read_b128 a[60:63], v193 offset:34816
  v_mfma_f32_16x16x32_bf16 v[118:121], a[64:67], a[12:15], v[118:121]
  v_xor_b32 v186, 0x10000, v186
  v_mfma_f32_16x16x32_bf16 v[122:125], a[68:71], a[12:15], v[122:125]
  buffer_load_dwordx4 v86, s[24:27], s65 offen offset:2048 lds
  v_xor_b32 v187, 0x10000, v187
  v_mfma_f32_16x16x32_bf16 v[126:129], a[64:67], a[16:19], v[126:129]
  v_xor_b32 v188, 0x10000, v188
  v_mfma_f32_16x16x32_bf16 v[130:133], a[68:71], a[16:19], v[130:133]
  v_xor_b32 v189, 0x10000, v189
  v_mfma_f32_16x16x32_bf16 v[134:137], a[64:67], a[20:23], v[134:137]
  v_xor_b32 v190, 0x10000, v190
  v_mfma_f32_16x16x32_bf16 v[138:141], a[68:71], a[20:23], v[138:141]
  v_xor_b32 v191, 0x10000, v191
  v_mfma_f32_16x16x32_bf16 v[142:145], a[64:67], a[24:27], v[142:145]
  v_xor_b32 v192, 0x10000, v192
  v_mfma_f32_16x16x32_bf16 v[146:149], a[68:71], a[24:27], v[146:149]
  buffer_load_dwordx4 v87, s[24:27], s65 offen offset:3072 lds
  s_add_u32 s64, s64, 1
  s_cmp_eq_u32 s64, 10
  s_cselect_b32 s55, -1152, s71
  s_cselect_b32 s69, -2211840, s70
  s_add_u32 s65, s65, s55
  v_xor_b32 v193, 0x10000, v193
  v_mfma_f32_16x16x32_bf16 v[150:153], a[64:67], a[28:31], v[150:153]
  v_xor_b32 v194, 0x10000, v194
  v_mfma_f32_16x16x32_bf16 v[154:157], a[68:71], a[28:31], v[154:157]
  v_xor_b32 v195, 0x10000, v195
  s_waitcnt vmcnt(12)
  s_waitcnt lgkmcnt(0)
  s_barrier
  v_mfma_f32_16x16x32_bf16 v[158:161], a[72:75], v[182:185], v[158:161]
  ds_read_b64_tr_b16 a[64:65], v194 offset:16384
  v_mfma_f32_16x16x32_bf16 v[162:165], a[76:79], v[182:185], v[162:165]
  ds_read_b64_tr_b16 a[66:67], v194 offset:17408
  s_add_u32 m0, s67, 81920
  v_mfma_f32_16x16x32_bf16 v[94:97], a[72:75], a[32:35], v[94:97]
  ds_read_b64_tr_b16 a[68:69], v195 offset:16384
  buffer_load_dwordx4 v88, s[28:31], s66 offen offset:0 lds
  v_mfma_f32_16x16x32_bf16 v[98:101], a[76:79], a[32:35], v[98:101]
  ds_read_b64_tr_b16 a[70:71], v195 offset:17408
  v_mfma_f32_16x16x32_bf16 v[102:105], a[72:75], a[36:39], v[102:105]
  ds_read_b128 a[0:3], v186 offset:0
  v_mfma_f32_16x16x32_bf16 v[106:109], a[76:79], a[36:39], v[106:109]
  ds_read_b128 a[4:7], v186 offset:2048
  v_mfma_f32_16x16x32_bf16 v[166:169], v[182:185], a[32:35], v[166:169]
  ds_read_b128 a[8:11], v187 offset:0
  v_mfma_f32_16x16x32_bf16 v[174:177], a[32:35], a[32:35], v[174:177]
  ds_read_b128 a[12:15], v187 offset:2048
  v_mfma_f32_16x16x32_bf16 v[170:173], v[182:185], a[36:39], v[170:173]
  ds_read_b128 a[16:19], v188 offset:0
  buffer_load_dwordx4 v89, s[28:31], s66 offen offset:1024 lds
  v_mfma_f32_16x16x32_bf16 v[178:181], a[36:39], a[36:39], v[178:181]
  ds_read_b128 a[20:23], v188 offset:2048
  v_mfma_f32_16x16x32_bf16 v[110:113], a[72:75], a[40:43], v[110:113]
  ds_read_b128 a[24:27], v189 offset:0
  v_mfma_f32_16x16x32_bf16 v[114:117], a[76:79], a[40:43], v[114:117]
  ds_read_b128 a[28:31], v189 offset:2048
  v_mfma_f32_16x16x32_bf16 v[118:121], a[72:75], a[44:47], v[118:121]
  v_mfma_f32_16x16x32_bf16 v[122:125], a[76:79], a[44:47], v[122:125]
  buffer_load_dwordx4 v90, s[28:31], s66 offen offset:2048 lds
  v_mfma_f32_16x16x32_bf16 v[126:129], a[72:75], a[48:51], v[126:129]
  v_mfma_f32_16x16x32_bf16 v[130:133], a[76:79], a[48:51], v[130:133]
  v_mfma_f32_16x16x32_bf16 v[134:137], a[72:75], a[52:55], v[134:137]
  v_mfma_f32_16x16x32_bf16 v[138:141], a[76:79], a[52:55], v[138:141]
  v_mfma_f32_16x16x32_bf16 v[142:145], a[72:75], a[56:59], v[142:145]
  v_mfma_f32_16x16x32_bf16 v[146:149], a[76:79], a[56:59], v[146:149]
  buffer_load_dwordx4 v91, s[28:31], s66 offen offset:3072 lds
  s_add_u32 s66, s66, s69
  v_mfma_f32_16x16x32_bf16 v[150:153], a[72:75], a[60:63], v[150:153]
  v_mfma_f32_16x16x32_bf16 v[154:157], a[76:79], a[60:63], v[154:157]
  s_waitcnt lgkmcnt(0)
  v_mfma_f32_16x16x32_bf16 v[158:161], a[64:67], v[182:185], v[158:161]
  ds_read_b64_tr_b16 a[72:73], v194 offset:24576
  v_mfma_f32_16x16x32_bf16 v[162:165], a[68:71], v[182:185], v[162:165]
  ds_read_b64_tr_b16 a[74:75], v194 offset:25600
  s_add_u32 m0, s67, 98304
  v_mfma_f32_16x16x32_bf16 v[94:97], a[64:67], a[0:3], v[94:97]
  ds_read_b64_tr_b16 a[76:77], v195 offset:24576
  buffer_load_dwordx4 v84, s[24:27], s65 offen offset:0 lds
  v_mfma_f32_16x16x32_bf16 v[98:101], a[68:71], a[0:3], v[98:101]
  ds_read_b64_tr_b16 a[78:79], v195 offset:25600
  v_mfma_f32_16x16x32_bf16 v[102:105], a[64:67], a[4:7], v[102:105]
  ds_read_b128 a[32:35], v190 offset:0
  v_mfma_f32_16x16x32_bf16 v[106:109], a[68:71], a[4:7], v[106:109]
  ds_read_b128 a[36:39], v190 offset:2048
  v_mfma_f32_16x16x32_bf16 v[166:169], v[182:185], a[0:3], v[166:169]
  ds_read_b128 a[40:43], v191 offset:0
  v_mfma_f32_16x16x32_bf16 v[174:177], a[0:3], a[0:3], v[174:177]
  ds_read_b128 a[44:47], v191 offset:2048
  v_mfma_f32_16x16x32_bf16 v[170:173], v[182:185], a[4:7], v[170:173]
  ds_read_b128 a[48:51], v192 offset:0
  buffer_load_dwordx4 v85, s[24:27], s65 offen offset:1024 lds
  v_mfma_f32_16x16x32_bf16 v[178:181], a[4:7], a[4:7], v[178:181]
  ds_read_b128 a[52:55], v192 offset:2048
  v_mfma_f32_16x16x32_bf16 v[110:113], a[64:67], a[8:11], v[110:113]
  ds_read_b128 a[56:59], v193 offset:0
  v_mfma_f32_16x16x32_bf16 v[114:117], a[68:71], a[8:11], v[114:117]
  ds_read_b128 a[60:63], v193 offset:2048
  v_mfma_f32_16x16x32_bf16 v[118:121], a[64:67], a[12:15], v[118:121]
  v_mfma_f32_16x16x32_bf16 v[122:125], a[68:71], a[12:15], v[122:125]
  buffer_load_dwordx4 v86, s[24:27], s65 offen offset:2048 lds
  v_mfma_f32_16x16x32_bf16 v[126:129], a[64:67], a[16:19], v[126:129]
  v_mfma_f32_16x16x32_bf16 v[130:133], a[68:71], a[16:19], v[130:133]
  v_mfma_f32_16x16x32_bf16 v[134:137], a[64:67], a[20:23], v[134:137]
  v_mfma_f32_16x16x32_bf16 v[138:141], a[68:71], a[20:23], v[138:141]
  v_mfma_f32_16x16x32_bf16 v[142:145], a[64:67], a[24:27], v[142:145]
  v_mfma_f32_16x16x32_bf16 v[146:149], a[68:71], a[24:27], v[146:149]
  buffer_load_dwordx4 v87, s[24:27], s65 offen offset:3072 lds
  s_add_u32 s64, s64, 1
  s_cmp_eq_u32 s64, 10
  s_cselect_b32 s55, -1152, s71
  s_cselect_b32 s69, -2211840, s70
  s_add_u32 s65, s65, s55
  v_mfma_f32_16x16x32_bf16 v[150:153], a[64:67], a[28:31], v[150:153]
  v_mfma_f32_16x16x32_bf16 v[154:157], a[68:71], a[28:31], v[154:157]
  s_waitcnt vmcnt(12)
  s_waitcnt lgkmcnt(0)
  s_barrier
  v_mfma_f32_16x16x32_bf16 v[158:161], a[72:75], v[182:185], v[158:161]
  ds_read_b64_tr_b16 a[64:65], v194 offset:49152
  s_add_u32 m0, s67, 114688
  s_nop 0
  buffer_load_dwordx4 v88, s[28:31], s66 offen offset:0 lds
  v_mfma_f32_16x16x32_bf16 v[162:165], a[76:79], v[182:185], v[162:165]
  ds_read_b64_tr_b16 a[66:67], v194 offset:50176
  v_mfma_f32_16x16x32_bf16 v[94:97], a[72:75], a[32:35], v[94:97]
  ds_read_b64_tr_b16 a[68:69], v195 offset:49152
  buffer_load_dwordx4 v89, s[28:31], s66 offen offset:1024 lds
  v_mfma_f32_16x16x32_bf16 v[98:101], a[76:79], a[32:35], v[98:101]
  ds_read_b64_tr_b16 a[70:71], v195 offset:50176
  v_mfma_f32_16x16x32_bf16 v[102:105], a[72:75], a[36:39], v[102:105]
  ds_read_b128 a[0:3], v186 offset:32768
  buffer_load_dwordx4 v90, s[28:31], s66 offen offset:2048 lds
  v_mfma_f32_16x16x32_bf16 v[106:109], a[76:79], a[36:39], v[106:109]
  ds_read_b128 a[4:7], v186 offset:34816
  v_mfma_f32_16x16x32_bf16 v[166:169], v[182:185], a[32:35], v[166:169]
  ds_read_b128 a[8:11], v187 offset:32768
  buffer_load_dwordx4 v91, s[28:31], s66 offen offset:3072 lds
  s_add_u32 s66, s66, s69
  v_mfma_f32_16x16x32_bf16 v[174:177], a[32:35], a[32:35], v[174:177]
  ds_read_b128 a[12:15], v187 offset:34816
  s_add_u32 m0, s67, 0
  v_mfma_f32_16x16x32_bf16 v[170:173], v[182:185], a[36:39], v[170:173]
  ds_read_b128 a[16:19], v188 offset:32768
  buffer_load_dwordx4 v84, s[24:27], s65 offen offset:0 lds
  v_mfma_f32_16x16x32_bf16 v[178:181], a[36:39], a[36:39], v[178:181]
  ds_read_b128 a[20:23], v188 offset:34816
  v_mfma_f32_16x16x32_bf16 v[110:113], a[72:75], a[40:43], v[110:113]
  ds_read_b128 a[24:27], v189 offset:32768
  buffer_load_dwordx4 v85, s[24:27], s65 offen offset:1024 lds
  v_mfma_f32_16x16x32_bf16 v[114:117], a[76:79], a[40:43], v[114:117]
  ds_read_b128 a[28:31], v189 offset:34816
  buffer_load_dwordx4 v86, s[24:27], s65 offen offset:2048 lds
  v_mfma_f32_16x16x32_bf16 v[118:121], a[72:75], a[44:47], v[118:121]
  v_mfma_f32_16x16x32_bf16 v[122:125], a[76:79], a[44:47], v[122:125]
  buffer_load_dwordx4 v87, s[24:27], s65 offen offset:3072 lds
  s_add_u32 s64, s64, 1
  s_cmp_eq_u32 s64, 10
  s_cselect_b32 s55, -1152, s71
  s_cselect_b32 s69, -2211840, s70
  s_add_u32 s65, s65, s55
  v_mfma_f32_16x16x32_bf16 v[126:129], a[72:75], a[48:51], v[126:129]
  s_add_u32 m0, s67, 16384
  v_mfma_f32_16x16x32_bf16 v[130:133], a[76:79], a[48:51], v[130:133]
  buffer_load_dwordx4 v88, s[28:31], s66 offen offset:0 lds
  v_mfma_f32_16x16x32_bf16 v[134:137], a[72:75], a[52:55], v[134:137]
  v_mfma_f32_16x16x32_bf16 v[138:141], a[76:79], a[52:55], v[138:141]
  buffer_load_dwordx4 v89, s[28:31], s66 offen offset:1024 lds
  v_mfma_f32_16x16x32_bf16 v[142:145], a[72:75], a[56:59], v[142:145]
  v_mfma_f32_16x16x32_bf16 v[146:149], a[76:79], a[56:59], v[146:149]
  buffer_load_dwordx4 v90, s[28:31], s66 offen offset:2048 lds
  v_mfma_f32_16x16x32_bf16 v[150:153], a[72:75], a[60:63], v[150:153]
  v_mfma_f32_16x16x32_bf16 v[154:157], a[76:79], a[60:63], v[154:157]
  buffer_load_dwordx4 v91, s[28:31], s66 offen offset:3072 lds
  s_add_u32 s66, s66, s69
  s_waitcnt lgkmcnt(0)
  v_mfma_f32_16x16x32_bf16 v[158:161], a[64:67], v[182:185], v[158:161]
  ds_read_b64_tr_b16 a[72:73], v194 offset:57344
  v_mfma_f32_16x16x32_bf16 v[162:165], a[68:71], v[182:185], v[162:165]
  ds_read_b64_tr_b16 a[74:75], v194 offset:58368
  v_mfma_f32_16x16x32_bf16 v[94:97], a[64:67], a[0:3], v[94:97]
  ds_read_b64_tr_b16 a[76:77], v195 offset:57344
  v_mfma_f32_16x16x32_bf16 v[98:101], a[68:71], a[0:3], v[98:101]
  ds_read_b64_tr_b16 a[78:79], v195 offset:58368
  v_mfma_f32_16x16x32_bf16 v[102:105], a[64:67], a[4:7], v[102:105]
  ds_read_b128 a[32:35], v190 offset:32768
  v_mfma_f32_16x16x32_bf16 v[106:109], a[68:71], a[4:7], v[106:109]
  ds_read_b128 a[36:39], v190 offset:34816
  v_mfma_f32_16x16x32_bf16 v[166:169], v[182:185], a[0:3], v[166:169]
  ds_read_b128 a[40:43], v191 offset:32768
  v_mfma_f32_16x16x32_bf16 v[174:177], a[0:3], a[0:3], v[174:177]
  ds_read_b128 a[44:47], v191 offset:34816
  v_mfma_f32_16x16x32_bf16 v[170:173], v[182:185], a[4:7], v[170:173]
  ds_read_b128 a[48:51], v192 offset:32768
  v_mfma_f32_16x16x32_bf16 v[178:181], a[4:7], a[4:7], v[178:181]
  ds_read_b128 a[52:55], v192 offset:34816
  v_mfma_f32_16x16x32_bf16 v[110:113], a[64:67], a[8:11], v[110:113]
  ds_read_b128 a[56:59], v193 offset:32768
  v_mfma_f32_16x16x32_bf16 v[114:117], a[68:71], a[8:11], v[114:117]
  ds_read_b128 a[60:63], v193 offset:34816
  v_mfma_f32_16x16x32_bf16 v[118:121], a[64:67], a[12:15], v[118:121]
  v_xor_b32 v186, 0x10000, v186
  v_mfma_f32_16x16x32_bf16 v[122:125], a[68:71], a[12:15], v[122:125]
  v_xor_b32 v187, 0x10000, v187
  v_mfma_f32_16x16x32_bf16 v[126:129], a[64:67], a[16:19], v[126:129]
  v_xor_b32 v188, 0x10000, v188
  v_mfma_f32_16x16x32_bf16 v[130:133], a[68:71], a[16:19], v[130:133]
  v_xor_b32 v189, 0x10000, v189
  v_mfma_f32_16x16x32_bf16 v[134:137], a[64:67], a[20:23], v[134:137]
  v_xor_b32 v190, 0x10000, v190
  v_mfma_f32_16x16x32_bf16 v[138:141], a[68:71], a[20:23], v[138:141]
  v_xor_b32 v191, 0x10000, v191
  v_mfma_f32_16x16x32_bf16 v[142:145], a[64:67], a[24:27], v[142:145]
  v_xor_b32 v192, 0x10000, v192
  v_mfma_f32_16x16x32_bf16 v[146:149], a[68:71], a[24:27], v[146:149]
  v_xor_b32 v193, 0x10000, v193
  v_mfma_f32_16x16x32_bf16 v[150:153], a[64:67], a[28:31], v[150:153]
  v_xor_b32 v194, 0x10000, v194
  v_mfma_f32_16x16x32_bf16 v[154:157], a[68:71], a[28:31], v[154:157]
  v_xor_b32 v195, 0x10000, v195
  s_waitcnt vmcnt(16)
  s_waitcnt lgkmcnt(0)
  s_barrier
  v_mfma_f32_16x16x32_bf16 v[158:161], a[72:75], v[182:185], v[158:161]
  ds_read_b64_tr_b16 a[64:65], v194 offset:16384
  s_add_u32 m0, s67, 32768
  v_mfma_f32_16x16x32_bf16 v[162:165], a[76:79], v[182:185], v[162:165]
  ds_read_b64_tr_b16 a[66:67], v194 offset:17408
  buffer_load_dwordx4 v84, s[24:27], s65 offen offset:0 lds
  v_mfma_f32_16x16x32_bf16 v[94:97], a[72:75], a[32:35], v[94:97]
  ds_read_b64_tr_b16 a[68:69], v195 offset:16384
  v_mfma_f32_16x16x32_bf16 v[98:101], a[76:79], a[32:35], v[98:101]
  ds_read_b64_tr_b16 a[70:71], v195 offset:17408
  v_mfma_f32_16x16x32_bf16 v[102:105], a[72:75], a[36:39], v[102:105]
  ds_read_b128 a[0:3], v186 offset:0
  buffer_load_dwordx4 v85, s[24:27], s65 offen offset:1024 lds
  v_mfma_f32_16x16x32_bf16 v[106:109], a[76:79], a[36:39], v[106:109]
  ds_read_b128 a[4:7], v186 offset:2048
  v_mfma_f32_16x16x32_bf16 v[166:169], v[182:185], a[32:35], v[166:169]
  ds_read_b128 a[8:11], v187 offset:0
  buffer_load_dwordx4 v86, s[24:27], s65 offen offset:2048 lds
  v_mfma_f32_16x16x32_bf16 v[174:177], a[32:35], a[32:35], v[174:177]
  ds_read_b128 a[12:15], v187 offset:2048
  v_mfma_f32_16x16x32_bf16 v[170:173], v[182:185], a[36:39], v[170:173]
  ds_read_b128 a[16:19], v188 offset:0
  v_mfma_f32_16x16x32_bf16 v[178:181], a[36:39], a[36:39], v[178:181]
  ds_read_b128 a[20:23], v188 offset:2048
  buffer_load_dwordx4 v87, s[24:27], s65 offen offset:3072 lds
  v_mfma_f32_16x16x32_bf16 v[110:113], a[72:75], a[40:43], v[110:113]
  ds_read_b128 a[24:27], v189 offset:0
  v_mfma_f32_16x16x32_bf16 v[114:117], a[76:79], a[40:43], v[114:117]
  ds_read_b128 a[28:31], v189 offset:2048
  s_add_u32 m0, s67, 49152
  v_mfma_f32_16x16x32_bf16 v[118:121], a[72:75], a[44:47], v[118:121]
  buffer_load_dwordx4 v88, s[28:31], s66 offen offset:0 lds
  v_mfma_f32_16x16x32_bf16 v[122:125], a[76:79], a[44:47], v[122:125]
  v_mfma_f32_16x16x32_bf16 v[126:129], a[72:75], a[48:51], v[126:129]
  v_mfma_f32_16x16x32_bf16 v[130:133], a[76:79], a[48:51], v[130:133]
  buffer_load_dwordx4 v89, s[28:31], s66 offen offset:1024 lds
  v_mfma_f32_16x16x32_bf16 v[134:137], a[72:75], a[52:55], v[134:137]
  v_mfma_f32_16x16x32_bf16 v[138:141], a[76:79], a[52:55], v[138:141]
  buffer_load_dwordx4 v90, s[28:31], s66 offen offset:2048 lds
  v_mfma_f32_16x16x32_bf16 v[142:145], a[72:75], a[56:59], v[142:145]
  v_mfma_f32_16x16x32_bf16 v[146:149], a[76:79], a[56:59], v[146:149]
  v_mfma_f32_16x16x32_bf16 v[150:153], a[72:75], a[60:63], v[150:153]
  buffer_load_dwordx4 v91, s[28:31], s66 offen offset:3072 lds
  v_mfma_f32_16x16x32_bf16 v[154:157], a[76:79], a[60:63], v[154:157]
  s_waitcnt lgkmcnt(0)
  v_mfma_f32_16x16x32_bf16 v[158:161], a[64:67], v[182:185], v[158:161]
  ds_read_b64_tr_b16 a[72:73], v194 offset:24576
  s_add_u32 m0, s23, 73728
  v_mfma_f32_16x16x32_bf16 v[162:165], a[68:71], v[182:185], v[162:165]
  ds_read_b64_tr_b16 a[74:75], v194 offset:25600
  buffer_load_dwordx4 v15, s[40:43], s17 offen offset:0 lds
  v_mfma_f32_16x16x32_bf16 v[94:97], a[64:67], a[0:3], v[94:97]
  ds_read_b64_tr_b16 a[76:77], v195 offset:24576
  v_mfma_f32_16x16x32_bf16 v[98:101], a[68:71], a[0:3], v[98:101]
  ds_read_b64_tr_b16 a[78:79], v195 offset:25600
  v_mfma_f32_16x16x32_bf16 v[102:105], a[64:67], a[4:7], v[102:105]
  ds_read_b128 a[32:35], v190 offset:0
  buffer_load_dwordx4 v16, s[40:43], s17 offen offset:1024 lds
  v_mfma_f32_16x16x32_bf16 v[106:109], a[68:71], a[4:7], v[106:109]
  ds_read_b128 a[36:39], v190 offset:2048
  v_mfma_f32_16x16x32_bf16 v[166:169], v[182:185], a[0:3], v[166:169]
  ds_read_b128 a[40:43], v191 offset:0
  buffer_load_dwordx4 v17, s[40:43], s17 offen offset:2048 lds
  v_mfma_f32_16x16x32_bf16 v[174:177], a[0:3], a[0:3], v[174:177]
  ds_read_b128 a[44:47], v191 offset:2048
  v_mfma_f32_16x16x32_bf16 v[170:173], v[182:185], a[4:7], v[170:173]
  ds_read_b128 a[48:51], v192 offset:0
  s_add_u32 m0, s23, 86016
  v_mfma_f32_16x16x32_bf16 v[178:181], a[4:7], a[4:7], v[178:181]
  ds_read_b128 a[52:55], v192 offset:2048
  buffer_load_dwordx4 v15, s[44:47], s17 offen offset:0 lds
  v_mfma_f32_16x16x32_bf16 v[110:113], a[64:67], a[8:11], v[110:113]
  ds_read_b128 a[56:59], v193 offset:0
  v_mfma_f32_16x16x32_bf16 v[114:117], a[68:71], a[8:11], v[114:117]
  ds_read_b128 a[60:63], v193 offset:2048
  v_mfma_f32_16x16x32_bf16 v[118:121], a[64:67], a[12:15], v[118:121]
  buffer_load_dwordx4 v16, s[44:47], s17 offen offset:1024 lds
  v_mfma_f32_16x16x32_bf16 v[122:125], a[68:71], a[12:15], v[122:125]
  v_mfma_f32_16x16x32_bf16 v[126:129], a[64:67], a[16:19], v[126:129]
  v_mfma_f32_16x16x32_bf16 v[130:133], a[68:71], a[16:19], v[130:133]
  buffer_load_dwordx4 v17, s[44:47], s17 offen offset:2048 lds
  s_cmp_eq_u32 s22, 9
  s_cselect_b32 s99, 0xffe20000, 0
  s_add_u32 s17, s17, 196608
  s_add_u32 s17, s17, s99
  v_mfma_f32_16x16x32_bf16 v[134:137], a[64:67], a[20:23], v[134:137]
  s_add_u32 m0, s83, 131072
  v_mfma_f32_16x16x32_bf16 v[138:141], a[68:71], a[20:23], v[138:141]
  buffer_load_dwordx4 v234, s[76:79], s80 offen lds
  s_add_u32 s80, s80, 5120
  v_mfma_f32_16x16x32_bf16 v[142:145], a[64:67], a[24:27], v[142:145]
  v_mfma_f32_16x16x32_bf16 v[146:149], a[68:71], a[24:27], v[146:149]
  s_add_u32 m0, s83, 132096
  v_mfma_f32_16x16x32_bf16 v[150:153], a[64:67], a[28:31], v[150:153]
  buffer_load_dwordx4 v234, s[76:79], s80 offen lds
  v_mfma_f32_16x16x32_bf16 v[154:157], a[68:71], a[28:31], v[154:157]
  s_waitcnt vmcnt(24)
  s_waitcnt lgkmcnt(0)
  s_barrier
  v_mfma_f32_16x16x32_bf16 v[158:161], a[72:75], v[182:185], v[158:161]
  ds_read_b64_tr_b16 a[64:65], v194 offset:49152
  v_mfma_f32_16x16x32_bf16 v[162:165], a[76:79], v[182:185], v[162:165]
  ds_read_b64_tr_b16 a[66:67], v194 offset:50176
  v_mfma_f32_16x16x32_bf16 v[94:97], a[72:75], a[32:35], v[94:97]
  ds_read_b64_tr_b16 a[68:69], v195 offset:49152
  v_mfma_f32_16x16x32_bf16 v[98:101], a[76:79], a[32:35], v[98:101]
  ds_read_b64_tr_b16 a[70:71], v195 offset:50176
  v_mfma_f32_16x16x32_bf16 v[102:105], a[72:75], a[36:39], v[102:105]
  ds_read_b128 a[0:3], v186 offset:32768
  v_mfma_f32_16x16x32_bf16 v[106:109], a[76:79], a[36:39], v[106:109]
  ds_read_b128 a[4:7], v186 offset:34816
  v_mfma_f32_16x16x32_bf16 v[166:169], v[182:185], a[32:35], v[166:169]
  ds_read_b128 a[8:11], v187 offset:32768
  v_mfma_f32_16x16x32_bf16 v[174:177], a[32:35], a[32:35], v[174:177]
  ds_read_b128 a[12:15], v187 offset:34816
  v_mfma_f32_16x16x32_bf16 v[170:173], v[182:185], a[36:39], v[170:173]
  ds_read_b128 a[16:19], v188 offset:32768
  v_mfma_f32_16x16x32_bf16 v[178:181], a[36:39], a[36:39], v[178:181]
  ds_read_b128 a[20:23], v188 offset:34816
  v_mfma_f32_16x16x32_bf16 v[110:113], a[72:75], a[40:43], v[110:113]
  ds_read_b128 a[24:27], v189 offset:32768
  v_mfma_f32_16x16x32_bf16 v[114:117], a[76:79], a[40:43], v[114:117]
  ds_read_b128 a[28:31], v189 offset:34816
  v_mfma_f32_16x16x32_bf16 v[118:121], a[72:75], a[44:47], v[118:121]
  v_mfma_f32_16x16x32_bf16 v[122:125], a[76:79], a[44:47], v[122:125]
  v_mfma_f32_16x16x32_bf16 v[126:129], a[72:75], a[48:51], v[126:129]
  v_mfma_f32_16x16x32_bf16 v[130:133], a[76:79], a[48:51], v[130:133]
  v_mfma_f32_16x16x32_bf16 v[134:137], a[72:75], a[52:55], v[134:137]
  v_mfma_f32_16x16x32_bf16 v[138:141], a[76:79], a[52:55], v[138:141]
  v_mfma_f32_16x16x32_bf16 v[142:145], a[72:75], a[56:59], v[142:145]
  v_mfma_f32_16x16x32_bf16 v[146:149], a[76:79], a[56:59], v[146:149]
  v_mfma_f32_16x16x32_bf16 v[150:153], a[72:75], a[60:63], v[150:153]
  v_mfma_f32_16x16x32_bf16 v[154:157], a[76:79], a[60:63], v[154:157]
  s_waitcnt lgkmcnt(0)
  v_mfma_f32_16x16x32_bf16 v[158:161], a[64:67], v[182:185], v[158:161]
  ds_read_b64_tr_b16 a[72:73], v194 offset:57344
  v_mfma_f32_16x16x32_bf16 v[162:165], a[68:71], v[182:185], v[162:165]
  ds_read_b64_tr_b16 a[74:75], v194 offset:58368
  v_mfma_f32_16x16x32_bf16 v[94:97], a[64:67], a[0:3], v[94:97]
  ds_read_b64_tr_b16 a[76:77], v195 offset:57344
  v_mfma_f32_16x16x32_bf16 v[98:101], a[68:71], a[0:3], v[98:101]
  ds_read_b64_tr_b16 a[78:79], v195 offset:58368
  v_mfma_f32_16x16x32_bf16 v[102:105], a[64:67], a[4:7], v[102:105]
  ds_read_b128 a[32:35], v190 offset:32768
  v_mfma_f32_16x16x32_bf16 v[106:109], a[68:71], a[4:7], v[106:109]
  ds_read_b128 a[36:39], v190 offset:34816
  v_mfma_f32_16x16x32_bf16 v[166:169], v[182:185], a[0:3], v[166:169]
  ds_read_b128 a[40:43], v191 offset:32768
  v_mfma_f32_16x16x32_bf16 v[174:177], a[0:3], a[0:3], v[174:177]
  ds_read_b128 a[44:47], v191 offset:34816
  v_mfma_f32_16x16x32_bf16 v[170:173], v[182:185], a[4:7], v[170:173]
  ds_read_b128 a[48:51], v192 offset:32768
  v_mfma_f32_16x16x32_bf16 v[178:181], a[4:7], a[4:7], v[178:181]
  ds_read_b128 a[52:55], v192 offset:34816
  v_mfma_f32_16x16x32_bf16 v[110:113], a[64:67], a[8:11], v[110:113]
  ds_read_b128 a[56:59], v193 offset:32768
  v_mfma_f32_16x16x32_bf16 v[114:117], a[68:71], a[8:11], v[114:117]
  ds_read_b128 a[60:63], v193 offset:34816
  v_mfma_f32_16x16x32_bf16 v[118:121], a[64:67], a[12:15], v[118:121]
  v_xor_b32 v186, 0x10000, v186
  v_mfma_f32_16x16x32_bf16 v[122:125], a[68:71], a[12:15], v[122:125]
  v_xor_b32 v187, 0x10000, v187
  v_mfma_f32_16x16x32_bf16 v[126:129], a[64:67], a[16:19], v[126:129]
  v_xor_b32 v188, 0x10000, v188
  v_mfma_f32_16x16x32_bf16 v[130:133], a[68:71], a[16:19], v[130:133]
  v_xor_b32 v189, 0x10000, v189
  v_mfma_f32_16x16x32_bf16 v[134:137], a[64:67], a[20:23], v[134:137]
  v_xor_b32 v190, 0x10000, v190
  v_mfma_f32_16x16x32_bf16 v[138:141], a[68:71], a[20:23], v[138:141]
  v_xor_b32 v191, 0x10000, v191
  v_mfma_f32_16x16x32_bf16 v[142:145], a[64:67], a[24:27], v[142:145]
  v_xor_b32 v192, 0x10000, v192
  v_mfma_f32_16x16x32_bf16 v[146:149], a[68:71], a[24:27], v[146:149]
  v_xor_b32 v193, 0x10000, v193
  v_mfma_f32_16x16x32_bf16 v[150:153], a[64:67], a[28:31], v[150:153]
  v_xor_b32 v194, 0x10000, v194
  v_mfma_f32_16x16x32_bf16 v[154:157], a[68:71], a[28:31], v[154:157]
  v_xor_b32 v195, 0x10000, v195
  s_waitcnt vmcnt(16)
  s_waitcnt lgkmcnt(0)
  s_barrier
  v_mfma_f32_16x16x32_bf16 v[158:161], a[72:75], v[182:185], v[158:161]
  ds_read_b64_tr_b16 a[64:65], v194 offset:16384
  v_mfma_f32_16x16x32_bf16 v[162:165], a[76:79], v[182:185], v[162:165]
  ds_read_b64_tr_b16 a[66:67], v194 offset:17408
  v_mfma_f32_16x16x32_bf16 v[94:97], a[72:75], a[32:35], v[94:97]
  ds_read_b64_tr_b16 a[68:69], v195 offset:16384
  v_mfma_f32_16x16x32_bf16 v[98:101], a[76:79], a[32:35], v[98:101]
  ds_read_b64_tr_b16 a[70:71], v195 offset:17408
  v_mfma_f32_16x16x32_bf16 v[102:105], a[72:75], a[36:39], v[102:105]
  ds_read_b128 a[0:3], v186 offset:0
  v_mfma_f32_16x16x32_bf16 v[106:109], a[76:79], a[36:39], v[106:109]
  ds_read_b128 a[4:7], v186 offset:2048
  v_mfma_f32_16x16x32_bf16 v[166:169], v[182:185], a[32:35], v[166:169]
  ds_read_b128 a[8:11], v187 offset:0
  v_mfma_f32_16x16x32_bf16 v[174:177], a[32:35], a[32:35], v[174:177]
  ds_read_b128 a[12:15], v187 offset:2048
  v_mfma_f32_16x16x32_bf16 v[170:173], v[182:185], a[36:39], v[170:173]
  ds_read_b128 a[16:19], v188 offset:0
  v_mfma_f32_16x16x32_bf16 v[178:181], a[36:39], a[36:39], v[178:181]
  ds_read_b128 a[20:23], v188 offset:2048
  v_mfma_f32_16x16x32_bf16 v[110:113], a[72:75], a[40:43], v[110:113]
  ds_read_b128 a[24:27], v189 offset:0
  v_mfma_f32_16x16x32_bf16 v[114:117], a[76:79], a[40:43], v[114:117]
  ds_read_b128 a[28:31], v189 offset:2048
  v_mfma_f32_16x16x32_bf16 v[118:121], a[72:75], a[44:47], v[118:121]
  v_mfma_f32_16x16x32_bf16 v[122:125], a[76:79], a[44:47], v[122:125]
  v_mfma_f32_16x16x32_bf16 v[126:129], a[72:75], a[48:51], v[126:129]
  v_mfma_f32_16x16x32_bf16 v[130:133], a[76:79], a[48:51], v[130:133]
  v_mfma_f32_16x16x32_bf16 v[134:137], a[72:75], a[52:55], v[134:137]
  v_mfma_f32_16x16x32_bf16 v[138:141], a[76:79], a[52:55], v[138:141]
  v_mfma_f32_16x16x32_bf16 v[142:145], a[72:75], a[56:59], v[142:145]
  v_mfma_f32_16x16x32_bf16 v[146:149], a[76:79], a[56:59], v[146:149]
  v_mfma_f32_16x16x32_bf16 v[150:153], a[72:75], a[60:63], v[150:153]
  v_mfma_f32_16x16x32_bf16 v[154:157], a[76:79], a[60:63], v[154:157]
  s_waitcnt lgkmcnt(0)
  v_mfma_f32_16x16x32_bf16 v[158:161], a[64:67], v[182:185], v[158:161]
  ds_read_b64_tr_b16 a[72:73], v194 offset:24576
  v_mfma_f32_16x16x32_bf16 v[162:165], a[68:71], v[182:185], v[162:165]
  ds_read_b64_tr_b16 a[74:75], v194 offset:25600
  v_mfma_f32_16x16x32_bf16 v[94:97], a[64:67], a[0:3], v[94:97]
  ds_read_b64_tr_b16 a[76:77], v195 offset:24576
  v_mfma_f32_16x16x32_bf16 v[98:101], a[68:71], a[0:3], v[98:101]
  ds_read_b64_tr_b16 a[78:79], v195 offset:25600
  v_mfma_f32_16x16x32_bf16 v[102:105], a[64:67], a[4:7], v[102:105]
  ds_read_b128 a[32:35], v190 offset:0
  v_mfma_f32_16x16x32_bf16 v[106:109], a[68:71], a[4:7], v[106:109]
  ds_read_b128 a[36:39], v190 offset:2048
  v_mfma_f32_16x16x32_bf16 v[166:169], v[182:185], a[0:3], v[166:169]
  ds_read_b128 a[40:43], v191 offset:0
  v_mfma_f32_16x16x32_bf16 v[174:177], a[0:3], a[0:3], v[174:177]
  ds_read_b128 a[44:47], v191 offset:2048
  v_mfma_f32_16x16x32_bf16 v[170:173], v[182:185], a[4:7], v[170:173]
  ds_read_b128 a[48:51], v192 offset:0
  v_mfma_f32_16x16x32_bf16 v[178:181], a[4:7], a[4:7], v[178:181]
  ds_read_b128 a[52:55], v192 offset:2048
  v_mfma_f32_16x16x32_bf16 v[110:113], a[64:67], a[8:11], v[110:113]
  ds_read_b128 a[56:59], v193 offset:0
  v_mfma_f32_16x16x32_bf16 v[114:117], a[68:71], a[8:11], v[114:117]
  ds_read_b128 a[60:63], v193 offset:2048
  v_mfma_f32_16x16x32_bf16 v[118:121], a[64:67], a[12:15], v[118:121]
  v_mfma_f32_16x16x32_bf16 v[122:125], a[68:71], a[12:15], v[122:125]
  v_mfma_f32_16x16x32_bf16 v[126:129], a[64:67], a[16:19], v[126:129]
  v_mfma_f32_16x16x32_bf16 v[130:133], a[68:71], a[16:19], v[130:133]
  v_mfma_f32_16x16x32_bf16 v[134:137], a[64:67], a[20:23], v[134:137]
  v_mfma_f32_16x16x32_bf16 v[138:141], a[68:71], a[20:23], v[138:141]
  v_mfma_f32_16x16x32_bf16 v[142:145], a[64:67], a[24:27], v[142:145]
  v_mfma_f32_16x16x32_bf16 v[146:149], a[68:71], a[24:27], v[146:149]
  v_mfma_f32_16x16x32_bf16 v[150:153], a[64:67], a[28:31], v[150:153]
  v_mfma_f32_16x16x32_bf16 v[154:157], a[68:71], a[28:31], v[154:157]
  s_waitcnt vmcnt(8)
  s_waitcnt lgkmcnt(0)
  s_barrier
  v_mfma_f32_16x16x32_bf16 v[158:161], a[72:75], v[182:185], v[158:161]
  ds_read_b64_tr_b16 a[64:65], v194 offset:49152
  v_mfma_f32_16x16x32_bf16 v[162:165], a[76:79], v[182:185], v[162:165]
  ds_read_b64_tr_b16 a[66:67], v194 offset:50176
  v_mfma_f32_16x16x32_bf16 v[94:97], a[72:75], a[32:35], v[94:97]
  ds_read_b64_tr_b16 a[68:69], v195 offset:49152
  v_mfma_f32_16x16x32_bf16 v[98:101], a[76:79], a[32:35], v[98:101]
  ds_read_b64_tr_b16 a[70:71], v195 offset:50176
  v_mfma_f32_16x16x32_bf16 v[102:105], a[72:75], a[36:39], v[102:105]
  ds_read_b128 a[0:3], v186 offset:32768
  v_mfma_f32_16x16x32_bf16 v[106:109], a[76:79], a[36:39], v[106:109]
  ds_read_b128 a[4:7], v186 offset:34816
  v_mfma_f32_16x16x32_bf16 v[166:169], v[182:185], a[32:35], v[166:169]
  ds_read_b128 a[8:11], v187 offset:32768
  v_mfma_f32_16x16x32_bf16 v[174:177], a[32:35], a[32:35], v[174:177]
  ds_read_b128 a[12:15], v187 offset:34816
  v_mfma_f32_16x16x32_bf16 v[170:173], v[182:185], a[36:39], v[170:173]
  ds_read_b128 a[16:19], v188 offset:32768
  v_mfma_f32_16x16x32_bf16 v[178:181], a[36:39], a[36:39], v[178:181]
  ds_read_b128 a[20:23], v188 offset:34816
  v_mfma_f32_16x16x32_bf16 v[110:113], a[72:75], a[40:43], v[110:113]
  ds_read_b128 a[24:27], v189 offset:32768
  v_mfma_f32_16x16x32_bf16 v[114:117], a[76:79], a[40:43], v[114:117]
  ds_read_b128 a[28:31], v189 offset:34816
  v_mfma_f32_16x16x32_bf16 v[118:121], a[72:75], a[44:47], v[118:121]
  v_mfma_f32_16x16x32_bf16 v[122:125], a[76:79], a[44:47], v[122:125]
  v_mfma_f32_16x16x32_bf16 v[126:129], a[72:75], a[48:51], v[126:129]
  v_mfma_f32_16x16x32_bf16 v[130:133], a[76:79], a[48:51], v[130:133]
  v_mfma_f32_16x16x32_bf16 v[134:137], a[72:75], a[52:55], v[134:137]
  v_mfma_f32_16x16x32_bf16 v[138:141], a[76:79], a[52:55], v[138:141]
  v_mfma_f32_16x16x32_bf16 v[142:145], a[72:75], a[56:59], v[142:145]
  v_mfma_f32_16x16x32_bf16 v[146:149], a[76:79], a[56:59], v[146:149]
  v_mfma_f32_16x16x32_bf16 v[150:153], a[72:75], a[60:63], v[150:153]
  v_mfma_f32_16x16x32_bf16 v[154:157], a[76:79], a[60:63], v[154:157]
  s_waitcnt lgkmcnt(0)
  v_mfma_f32_16x16x32_bf16 v[158:161], a[64:67], v[182:185], v[158:161]
  ds_read_b64_tr_b16 a[72:73], v194 offset:57344
  v_mfma_f32_16x16x32_bf16 v[162:165], a[68:71], v[182:185], v[162:165]
  ds_read_b64_tr_b16 a[74:75], v194 offset:58368
  v_mfma_f32_16x16x32_bf16 v[94:97], a[64:67], a[0:3], v[94:97]
  ds_read_b64_tr_b16 a[76:77], v195 offset:57344
  v_mfma_f32_16x16x32_bf16 v[98:101], a[68:71], a[0:3], v[98:101]
  ds_read_b64_tr_b16 a[78:79], v195 offset:58368
  v_mfma_f32_16x16x32_bf16 v[102:105], a[64:67], a[4:7], v[102:105]
  ds_read_b128 a[32:35], v190 offset:32768
  v_mfma_f32_16x16x32_bf16 v[106:109], a[68:71], a[4:7], v[106:109]
  ds_read_b128 a[36:39], v190 offset:34816
  v_mfma_f32_16x16x32_bf16 v[166:169], v[182:185], a[0:3], v[166:169]
  ds_read_b128 a[40:43], v191 offset:32768
  v_mfma_f32_16x16x32_bf16 v[174:177], a[0:3], a[0:3], v[174:177]
  ds_read_b128 a[44:47], v191 offset:34816
  v_mfma_f32_16x16x32_bf16 v[170:173], v[182:185], a[4:7], v[170:173]
  ds_read_b128 a[48:51], v192 offset:32768
  v_mfma_f32_16x16x32_bf16 v[178:181], a[4:7], a[4:7], v[178:181]
  ds_read_b128 a[52:55], v192 offset:34816
  v_mfma_f32_16x16x32_bf16 v[110:113], a[64:67], a[8:11], v[110:113]
  ds_read_b128 a[56:59], v193 offset:32768
  v_mfma_f32_16x16x32_bf16 v[114:117], a[68:71], a[8:11], v[114:117]
  ds_read_b128 a[60:63], v193 offset:34816
  v_mfma_f32_16x16x32_bf16 v[118:121], a[64:67], a[12:15], v[118:121]
  v_mfma_f32_16x16x32_bf16 v[122:125], a[68:71], a[12:15], v[122:125]
  v_mfma_f32_16x16x32_bf16 v[126:129], a[64:67], a[16:19], v[126:129]
  v_mfma_f32_16x16x32_bf16 v[130:133], a[68:71], a[16:19], v[130:133]
  v_mfma_f32_16x16x32_bf16 v[134:137], a[64:67], a[20:23], v[134:137]
  v_mfma_f32_16x16x32_bf16 v[138:141], a[68:71], a[20:23], v[138:141]
  v_mfma_f32_16x16x32_bf16 v[142:145], a[64:67], a[24:27], v[142:145]
  v_mfma_f32_16x16x32_bf16 v[146:149], a[68:71], a[24:27], v[146:149]
  v_mfma_f32_16x16x32_bf16 v[150:153], a[64:67], a[28:31], v[150:153]
  v_mfma_f32_16x16x32_bf16 v[154:157], a[68:71], a[28:31], v[154:157]
  s_waitcnt lgkmcnt(7)
  v_mfma_f32_16x16x32_bf16 v[166:169], v[182:185], a[32:35], v[166:169]
  v_mfma_f32_16x16x32_bf16 v[174:177], a[32:35], a[32:35], v[174:177]
  s_waitcnt lgkmcnt(6)
  v_mfma_f32_16x16x32_bf16 v[170:173], v[182:185], a[36:39], v[170:173]
  v_mfma_f32_16x16x32_bf16 v[178:181], a[36:39], a[36:39], v[178:181]
  v_mfma_f32_16x16x32_bf16 v[158:161], a[72:75], v[182:185], v[158:161]
  v_mfma_f32_16x16x32_bf16 v[162:165], a[76:79], v[182:185], v[162:165]
  s_nop 2
  v_cndmask_b32 v174, v174, v175, s[88:89]
  v_cndmask_b32 v174, v174, v176, s[90:91]
  v_cndmask_b32 v174, v174, v177, s[92:93]
  v_mfma_f32_16x16x32_bf16 v[94:97], a[72:75], a[32:35], v[94:97]
  v_cndmask_b32 v178, v178, v179, s[88:89]
  v_cndmask_b32 v178, v178, v180, s[90:91]
  v_cndmask_b32 v178, v178, v181, s[92:93]
  v_mfma_f32_16x16x32_bf16 v[98:101], a[76:79], a[32:35], v[98:101]
  v_mul_f32 v166, 0xbacccccd, v166
  v_mul_f32 v170, 0xbacccccd, v170
  v_mul_f32 v174, 0x3acccccd, v174
  v_mfma_f32_16x16x32_bf16 v[102:105], a[72:75], a[36:39], v[102:105]
  v_mul_f32 v178, 0x3acccccd, v178
  v_fma_f32 v174, -v166, v166, v174
  v_fma_f32 v178, -v170, v170, v178
  v_mfma_f32_16x16x32_bf16 v[106:109], a[76:79], a[36:39], v[106:109]
  v_add_f32 v174, 0x3727c5ac, v174
  v_add_f32 v178, 0x3727c5ac, v178
  v_rsq_f32 v174, v174
  s_waitcnt lgkmcnt(5)
  v_mfma_f32_16x16x32_bf16 v[110:113], a[72:75], a[40:43], v[110:113]
  v_rsq_f32 v178, v178
  v_mul_f32 v174, s94, v174
  v_mul_f32 v178, s94, v178
  v_mfma_f32_16x16x32_bf16 v[114:117], a[76:79], a[40:43], v[114:117]
  ds_write2_b32 v93, v166, v174 offset0:0 offset1:128
  ds_write2_b32 v93, v170, v178 offset0:16 offset1:144
  s_waitcnt lgkmcnt(6)
  v_mfma_f32_16x16x32_bf16 v[118:121], a[72:75], a[44:47], v[118:121]
  v_mfma_f32_16x16x32_bf16 v[122:125], a[76:79], a[44:47], v[122:125]
  s_waitcnt lgkmcnt(0)
  s_barrier
  ds_read2_b32 v[20:21], v196 offset0:0 offset1:128
  ds_read2_b32 v[22:23], v196 offset0:16 offset1:144
  ds_read2_b32 v[24:25], v197 offset0:0 offset1:128
  v_mfma_f32_16x16x32_bf16 v[126:129], a[72:75], a[48:51], v[126:129]
  ds_read2_b32 v[26:27], v197 offset0:16 offset1:144
  ds_read2_b32 v[28:29], v198 offset0:0 offset1:128
  ds_read2_b32 v[30:31], v198 offset0:16 offset1:144
  v_mfma_f32_16x16x32_bf16 v[130:133], a[76:79], a[48:51], v[130:133]
  ds_read2_b32 v[32:33], v199 offset0:0 offset1:128
  ds_read2_b32 v[34:35], v199 offset0:16 offset1:144
  v_mfma_f32_16x16x32_bf16 v[134:137], a[72:75], a[52:55], v[134:137]
  v_mfma_f32_16x16x32_bf16 v[138:141], a[76:79], a[52:55], v[138:141]
  v_mfma_f32_16x16x32_bf16 v[142:145], a[72:75], a[56:59], v[142:145]
  v_mfma_f32_16x16x32_bf16 v[146:149], a[76:79], a[56:59], v[146:149]
  v_mfma_f32_16x16x32_bf16 v[150:153], a[72:75], a[60:63], v[150:153]
  v_mfma_f32_16x16x32_bf16 v[154:157], a[76:79], a[60:63], v[154:157]
  s_waitcnt lgkmcnt(7)
  v_pk_fma_f32 v[94:95], v[158:159], v[20:21], v[94:95] op_sel_hi:[1,0,1]
  v_pk_fma_f32 v[96:97], v[160:161], v[20:21], v[96:97] op_sel_hi:[1,0,1]
  v_pk_fma_f32 v[98:99], v[162:163], v[20:21], v[98:99] op_sel_hi:[1,0,1]
  v_pk_fma_f32 v[100:101], v[164:165], v[20:21], v[100:101] op_sel_hi:[1,0,1]
  v_pk_mul_f32 v[94:95], v[94:95], v[20:21] op_sel:[0,1]
  v_pk_mul_f32 v[96:97], v[96:97], v[20:21] op_sel:[0,1]
  v_pk_mul_f32 v[98:99], v[98:99], v[20:21] op_sel:[0,1]
  v_pk_mul_f32 v[100:101], v[100:101], v[20:21] op_sel:[0,1]
  v_cvt_pk_bf16_f32 v202, v94, v95
  v_cvt_pk_bf16_f32 v203, v96, v97
  v_cvt_pk_bf16_f32 v204, v98, v99
  v_cvt_pk_bf16_f32 v205, v100, v101
  s_waitcnt lgkmcnt(6)
  v_pk_fma_f32 v[102:103], v[158:159], v[22:23], v[102:103] op_sel_hi:[1,0,1]
  v_pk_fma_f32 v[104:105], v[160:161], v[22:23], v[104:105] op_sel_hi:[1,0,1]
  v_pk_fma_f32 v[106:107], v[162:163], v[22:23], v[106:107] op_sel_hi:[1,0,1]
  v_pk_fma_f32 v[108:109], v[164:165], v[22:23], v[108:109] op_sel_hi:[1,0,1]
  v_pk_mul_f32 v[102:103], v[102:103], v[22:23] op_sel:[0,1]
  v_pk_mul_f32 v[104:105], v[104:105], v[22:23] op_sel:[0,1]
  v_pk_mul_f32 v[106:107], v[106:107], v[22:23] op_sel:[0,1]
  v_pk_mul_f32 v[108:109], v[108:109], v[22:23] op_sel:[0,1]
  v_cvt_pk_bf16_f32 v206, v102, v103
  v_cvt_pk_bf16_f32 v207, v104, v105
  v_cvt_pk_bf16_f32 v208, v106, v107
  v_cvt_pk_bf16_f32 v209, v108, v109
  v_permlane16_swap_b32 v202, v204
  v_permlane16_swap_b32 v203, v205
  buffer_store_dwordx4 v[202:205], v200, s[32:35], s4 offen offset:0 sc1
  s_waitcnt lgkmcnt(5)
  v_pk_fma_f32 v[110:111], v[158:159], v[24:25], v[110:111] op_sel_hi:[1,0,1]
  v_pk_fma_f32 v[112:113], v[160:161], v[24:25], v[112:113] op_sel_hi:[1,0,1]
  v_pk_fma_f32 v[114:115], v[162:163], v[24:25], v[114:115] op_sel_hi:[1,0,1]
  v_pk_fma_f32 v[116:117], v[164:165], v[24:25], v[116:117] op_sel_hi:[1,0,1]
  v_pk_mul_f32 v[110:111], v[110:111], v[24:25] op_sel:[0,1]
  v_pk_mul_f32 v[112:113], v[112:113], v[24:25] op_sel:[0,1]
  v_pk_mul_f32 v[114:115], v[114:115], v[24:25] op_sel:[0,1]
  v_pk_mul_f32 v[116:117], v[116:117], v[24:25] op_sel:[0,1]
  v_cvt_pk_bf16_f32 v210, v110, v111
  v_cvt_pk_bf16_f32 v211, v112, v113
  v_cvt_pk_bf16_f32 v212, v114, v115
  v_cvt_pk_bf16_f32 v213, v116, v117
  v_permlane16_swap_b32 v206, v208
  v_permlane16_swap_b32 v207, v209
  buffer_store_dwordx4 v[206:209], v200, s[32:35], s4 offen offset:256 sc1
  s_waitcnt lgkmcnt(4)
  v_pk_fma_f32 v[118:119], v[158:159], v[26:27], v[118:119] op_sel_hi:[1,0,1]
  v_pk_fma_f32 v[120:121], v[160:161], v[26:27], v[120:121] op_sel_hi:[1,0,1]
  v_pk_fma_f32 v[122:123], v[162:163], v[26:27], v[122:123] op_sel_hi:[1,0,1]
  v_pk_fma_f32 v[124:125], v[164:165], v[26:27], v[124:125] op_sel_hi:[1,0,1]
  v_pk_mul_f32 v[118:119], v[118:119], v[26:27] op_sel:[0,1]
  v_pk_mul_f32 v[120:121], v[120:121], v[26:27] op_sel:[0,1]
  v_pk_mul_f32 v[122:123], v[122:123], v[26:27] op_sel:[0,1]
  v_pk_mul_f32 v[124:125], v[124:125], v[26:27] op_sel:[0,1]
  v_cvt_pk_bf16_f32 v214, v118, v119
  v_cvt_pk_bf16_f32 v215, v120, v121
  v_cvt_pk_bf16_f32 v216, v122, v123
  v_cvt_pk_bf16_f32 v217, v124, v125
  v_permlane16_swap_b32 v210, v212
  v_permlane16_swap_b32 v211, v213
  buffer_store_dwordx4 v[210:213], v200, s[32:35], s5 offen offset:0 sc1
  s_waitcnt lgkmcnt(3)
  v_pk_fma_f32 v[126:127], v[158:159], v[28:29], v[126:127] op_sel_hi:[1,0,1]
  v_pk_fma_f32 v[128:129], v[160:161], v[28:29], v[128:129] op_sel_hi:[1,0,1]
  v_pk_fma_f32 v[130:131], v[162:163], v[28:29], v[130:131] op_sel_hi:[1,0,1]
  v_pk_fma_f32 v[132:133], v[164:165], v[28:29], v[132:133] op_sel_hi:[1,0,1]
  v_pk_mul_f32 v[126:127], v[126:127], v[28:29] op_sel:[0,1]
  v_pk_mul_f32 v[128:129], v[128:129], v[28:29] op_sel:[0,1]
  v_pk_mul_f32 v[130:131], v[130:131], v[28:29] op_sel:[0,1]
  v_pk_mul_f32 v[132:133], v[132:133], v[28:29] op_sel:[0,1]
  v_cvt_pk_bf16_f32 v218, v126, v127
  v_cvt_pk_bf16_f32 v219, v128, v129
  v_cvt_pk_bf16_f32 v220, v130, v131
  v_cvt_pk_bf16_f32 v221, v132, v133
  v_permlane16_swap_b32 v214, v216
  v_permlane16_swap_b32 v215, v217
  buffer_store_dwordx4 v[214:217], v200, s[32:35], s5 offen offset:256 sc1
  s_waitcnt lgkmcnt(2)
  v_pk_fma_f32 v[134:135], v[158:159], v[30:31], v[134:135] op_sel_hi:[1,0,1]
  v_pk_fma_f32 v[136:137], v[160:161], v[30:31], v[136:137] op_sel_hi:[1,0,1]
  v_pk_fma_f32 v[138:139], v[162:163], v[30:31], v[138:139] op_sel_hi:[1,0,1]
  v_pk_fma_f32 v[140:141], v[164:165], v[30:31], v[140:141] op_sel_hi:[1,0,1]
  v_pk_mul_f32 v[134:135], v[134:135], v[30:31] op_sel:[0,1]
  v_pk_mul_f32 v[136:137], v[136:137], v[30:31] op_sel:[0,1]
  v_pk_mul_f32 v[138:139], v[138:139], v[30:31] op_sel:[0,1]
  v_pk_mul_f32 v[140:141], v[140:141], v[30:31] op_sel:[0,1]
  v_cvt_pk_bf16_f32 v222, v134, v135
  v_cvt_pk_bf16_f32 v223, v136, v137
  v_cvt_pk_bf16_f32 v224, v138, v139
  v_cvt_pk_bf16_f32 v225, v140, v141
  v_permlane16_swap_b32 v218, v220
  v_permlane16_swap_b32 v219, v221
  buffer_store_dwordx4 v[218:221], v200, s[32:35], s6 offen offset:0 sc1
  s_waitcnt lgkmcnt(1)
  v_pk_fma_f32 v[142:143], v[158:159], v[32:33], v[142:143] op_sel_hi:[1,0,1]
  v_pk_fma_f32 v[144:145], v[160:161], v[32:33], v[144:145] op_sel_hi:[1,0,1]
  v_pk_fma_f32 v[146:147], v[162:163], v[32:33], v[146:147] op_sel_hi:[1,0,1]
  v_pk_fma_f32 v[148:149], v[164:165], v[32:33], v[148:149] op_sel_hi:[1,0,1]
  v_pk_mul_f32 v[142:143], v[142:143], v[32:33] op_sel:[0,1]
  v_pk_mul_f32 v[144:145], v[144:145], v[32:33] op_sel:[0,1]
  v_pk_mul_f32 v[146:147], v[146:147], v[32:33] op_sel:[0,1]
  v_pk_mul_f32 v[148:149], v[148:149], v[32:33] op_sel:[0,1]
  v_cvt_pk_bf16_f32 v226, v142, v143
  v_cvt_pk_bf16_f32 v227, v144, v145
  v_cvt_pk_bf16_f32 v228, v146, v147
  v_cvt_pk_bf16_f32 v229, v148, v149
  v_permlane16_swap_b32 v222, v224
  v_permlane16_swap_b32 v223, v225
  buffer_store_dwordx4 v[222:225], v200, s[32:35], s6 offen offset:256 sc1
  s_waitcnt lgkmcnt(0)
  v_pk_fma_f32 v[150:151], v[158:159], v[34:35], v[150:151] op_sel_hi:[1,0,1]
  v_pk_fma_f32 v[152:153], v[160:161], v[34:35], v[152:153] op_sel_hi:[1,0,1]
  v_pk_fma_f32 v[154:155], v[162:163], v[34:35], v[154:155] op_sel_hi:[1,0,1]
  v_pk_fma_f32 v[156:157], v[164:165], v[34:35], v[156:157] op_sel_hi:[1,0,1]
  v_pk_mul_f32 v[150:151], v[150:151], v[34:35] op_sel:[0,1]
  v_pk_mul_f32 v[152:153], v[152:153], v[34:35] op_sel:[0,1]
  v_pk_mul_f32 v[154:155], v[154:155], v[34:35] op_sel:[0,1]
  v_pk_mul_f32 v[156:157], v[156:157], v[34:35] op_sel:[0,1]
  v_cvt_pk_bf16_f32 v230, v150, v151
  v_cvt_pk_bf16_f32 v231, v152, v153
  v_cvt_pk_bf16_f32 v232, v154, v155
  v_cvt_pk_bf16_f32 v233, v156, v157
  v_permlane16_swap_b32 v226, v228
  v_permlane16_swap_b32 v227, v229
  buffer_store_dwordx4 v[226:229], v200, s[32:35], s7 offen offset:0 sc1
  v_permlane16_swap_b32 v230, v232
  v_permlane16_swap_b32 v231, v233
  buffer_store_dwordx4 v[230:233], v200, s[32:35], s7 offen offset:256 sc1
  s_branch L_p1done
L_spare:
  s_lshl_b32 s81, s50, 2
  s_add_u32 s81, s81, s3
  s_lshl_b32 s81, s81, 11
  s_add_u32 s81, s81, 25165824
  s_add_u32 s82, s81, 1024
  s_lshl_b32 s55, s3, 10
  v_add_u32 v80, s55, v14
  s_mul_i32 s56, s50, 51200
  s_mul_i32 s57, s50, 122880
  s_add_u32 m0, s55, 0
  s_nop 0
  buffer_load_dwordx4 v80, s[72:75], s56 offen lds
  s_add_u32 s56, s56, 4096
  s_add_u32 m0, s55, 4096
  s_nop 0
  buffer_load_dwordx4 v80, s[72:75], s56 offen lds
  s_add_u32 s56, s56, 4096
  s_add_u32 m0, s55, 8192
  s_nop 0
  buffer_load_dwordx4 v80, s[72:75], s56 offen lds
  s_add_u32 s56, s56, 4096
  s_add_u32 m0, s55, 12288
  s_nop 0
  buffer_load_dwordx4 v80, s[72:75], s56 offen lds
  s_add_u32 s56, s56, 4096
  s_add_u32 m0, s55, 16384
  s_nop 0
  buffer_load_dwordx4 v80, s[72:75], s56 offen lds
  s_add_u32 s56, s56, 4096
  s_add_u32 m0, s55, 20480
  s_nop 0
  buffer_load_dwordx4 v80, s[72:75], s56 offen lds
  s_add_u32 s56, s56, 4096
  s_add_u32 m0, s55, 24576
  s_nop 0
  buffer_load_dwordx4 v80, s[72:75], s56 offen lds
  s_add_u32 s56, s56, 4096
  s_add_u32 m0, s55, 28672
  s_nop 0
  buffer_load_dwordx4 v80, s[72:75], s56 offen lds
  s_add_u32 s56, s56, 4096
  s_add_u32 m0, s55, 32768
  s_nop 0
  buffer_load_dwordx4 v80, s[72:75], s56 offen lds
  s_add_u32 s56, s56, 4096
  s_add_u32 m0, s55, 36864
  s_nop 0
  buffer_load_dwordx4 v80, s[72:75], s56 offen lds
  s_add_u32 s56, s56, 4096
  s_add_u32 m0, s55, 40960
  s_nop 0
  buffer_load_dwordx4 v80, s[72:75], s56 offen lds
  s_add_u32 s56, s56, 4096
  s_add_u32 m0, s55, 45056
  s_nop 0
  buffer_load_dwordx4 v80, s[72:75], s56 offen lds
  s_add_u32 s56, s56, 4096
  s_add_u32 m0, s55, 49152
  s_nop 0
  buffer_load_dwordx4 v80, s[72:75], s56 offen lds
  s_add_u32 s56, s56, 4096
  v_bfe_u32 v2, v0, 2, 2
  v_and_b32 v3, 3, v0
  v_mul_u32_u24 v4, 1280, v2
  v_lshl_add_u32 v4, v3, 3, v4
  s_lshl_b32 s58, s3, 7
  v_lshl_add_u32 v81, v13, 5, v4
  v_add_u32 v81, s58, v81
  s_lshl_b32 s58, s3, 2
  s_mov_b32 s59, 97280
  v_add_u32 v5, s58, v13
  v_mul_u32_u24 v6, 52, v5
  v_lshrrev_b32 v6, 8, v6
  v_lshlrev_b32 v5, 10, v5
  v_mad_u32_u24 v5, v6, s59, v5
  v_lshl_add_u32 v2, v7, 4, v5
  v_add_u32 v5, s58, v13
  v_add_u32 v5, 16, v5
  v_mul_u32_u24 v6, 52, v5
  v_lshrrev_b32 v6, 8, v6
  v_lshlrev_b32 v5, 10, v5
  v_mad_u32_u24 v5, v6, s59, v5
  v_lshl_add_u32 v3, v7, 4, v5
  v_add_u32 v5, s58, v13
  v_add_u32 v5, 32, v5
  v_mul_u32_u24 v6, 52, v5
  v_lshrrev_b32 v6, 8, v6
  v_lshlrev_b32 v5, 10, v5
  v_mad_u32_u24 v5, v6, s59, v5
  v_lshl_add_u32 v4, v7, 4, v5
  s_mul_i32 s58, s50, 5
  s_add_u32 s59, s58, 0
  s_lshr_b32 s60, s59, 2
  s_mul_i32 s60, s60, 4096
  s_lshl_b32 s59, s59, 8
  s_add_u32 s59, s59, s60
  s_add_u32 s84, s59, 24117248
  s_add_u32 s59, s58, 1
  s_lshr_b32 s60, s59, 2
  s_mul_i32 s60, s60, 4096
  s_lshl_b32 s59, s59, 8
  s_add_u32 s59, s59, s60
  s_add_u32 s85, s59, 24117248
  s_add_u32 s59, s58, 2
  s_lshr_b32 s60, s59, 2
  s_mul_i32 s60, s60, 4096
  s_lshl_b32 s59, s59, 8
  s_add_u32 s59, s59, s60
  s_add_u32 s86, s59, 24117248
  s_add_u32 s59, s58, 3
  s_lshr_b32 s60, s59, 2
  s_mul_i32 s60, s60, 4096
  s_lshl_b32 s59, s59, 8
  s_add_u32 s59, s59, s60
  s_add_u32 s87, s59, 24117248
  s_add_u32 s59, s58, 4
  s_lshr_b32 s60, s59, 2
  s_mul_i32 s60, s60, 4096
  s_lshl_b32 s59, s59, 8
  s_add_u32 s59, s59, s60
  s_add_u32 s88, s59, 24117248
  s_add_u32 m0, s55, 53248
  s_nop 0
  buffer_load_dwordx4 v80, s[76:79], s57 offen lds
  s_add_u32 s57, s57, 4096
  s_add_u32 m0, s55, 57344
  s_nop 0
  buffer_load_dwordx4 v80, s[76:79], s57 offen lds
  s_add_u32 s57, s57, 4096
  s_add_u32 m0, s55, 61440
  s_nop 0
  buffer_load_dwordx4 v80, s[76:79], s57 offen lds
  s_add_u32 s57, s57, 4096
  s_add_u32 m0, s55, 65536
  s_nop 0
  buffer_load_dwordx4 v80, s[76:79], s57 offen lds
  s_add_u32 s57, s57, 4096
  s_add_u32 m0, s55, 69632
  s_nop 0
  buffer_load_dwordx4 v80, s[76:79], s57 offen lds
  s_add_u32 s57, s57, 4096
  s_add_u32 m0, s55, 73728
  s_nop 0
  buffer_load_dwordx4 v80, s[76:79], s57 offen lds
  s_add_u32 s57, s57, 4096
  s_add_u32 m0, s55, 77824
  s_nop 0
  buffer_load_dwordx4 v80, s[76:79], s57 offen lds
  s_add_u32 s57, s57, 4096
  s_add_u32 m0, s55, 81920
  s_nop 0
  buffer_load_dwordx4 v80, s[76:79], s57 offen lds
  s_add_u32 s57, s57, 4096
  s_add_u32 m0, s55, 86016
  s_nop 0
  buffer_load_dwordx4 v80, s[76:79], s57 offen lds
  s_add_u32 s57, s57, 4096
  s_add_u32 m0, s55, 90112
  s_nop 0
  buffer_load_dwordx4 v80, s[76:79], s57 offen lds
  s_add_u32 s57, s57, 4096
  s_add_u32 m0, s55, 94208
  s_nop 0
  buffer_load_dwordx4 v80, s[76:79], s57 offen lds
  s_add_u32 s57, s57, 4096
  s_add_u32 m0, s55, 98304
  s_nop 0
  buffer_load_dwordx4 v80, s[76:79], s57 offen lds
  s_add_u32 s57, s57, 4096
  s_add_u32 m0, s55, 102400
  s_nop 0
  buffer_load_dwordx4 v80, s[76:79], s57 offen lds
  s_add_u32 s57, s57, 4096
  s_add_u32 m0, s55, 106496
  s_nop 0
  buffer_load_dwordx4 v80, s[76:79], s57 offen lds
  s_add_u32 s57, s57, 4096
  s_add_u32 m0, s55, 110592
  s_nop 0
  buffer_load_dwordx4 v80, s[76:79], s57 offen lds
  s_add_u32 s57, s57, 4096
  s_add_u32 m0, s55, 114688
  s_nop 0
  buffer_load_dwordx4 v80, s[76:79], s57 offen lds
  s_add_u32 s57, s57, 4096
  s_add_u32 m0, s55, 118784
  s_nop 0
  buffer_load_dwordx4 v80, s[76:79], s57 offen lds
  s_add_u32 s57, s57, 4096
  s_add_u32 m0, s55, 122880
  s_nop 0
  buffer_load_dwordx4 v80, s[76:79], s57 offen lds
  s_add_u32 s57, s57, 4096
  s_add_u32 m0, s55, 126976
  s_nop 0
  buffer_load_dwordx4 v80, s[76:79], s57 offen lds
  s_add_u32 s57, s57, 4096
  s_add_u32 m0, s55, 131072
  s_nop 0
  buffer_load_dwordx4 v80, s[76:79], s57 offen lds
  s_add_u32 s57, s57, 4096
  s_add_u32 m0, s23, 73728
  s_nop 0
  buffer_load_dwordx4 v15, s[40:43], s17 offen offset:0 lds
  buffer_load_dwordx4 v16, s[40:43], s17 offen offset:1024 lds
  buffer_load_dwordx4 v17, s[40:43], s17 offen offset:2048 lds
  s_add_u32 m0, s23, 86016
  s_nop 0
  buffer_load_dwordx4 v15, s[44:47], s17 offen offset:0 lds
  buffer_load_dwordx4 v16, s[44:47], s17 offen offset:1024 lds
  buffer_load_dwordx4 v17, s[44:47], s17 offen offset:2048 lds
  s_cmp_eq_u32 s22, 9
  s_cselect_b32 s99, 0xffe20000, 0
  s_add_u32 s17, s17, 196608
  s_add_u32 s17, s17, s99
  s_add_u32 m0, s23, 0
  s_mov_b64 exec, 0x47fe7fff
  buffer_load_dword v92, v92, s[32:35], 0 offen sc1
  s_mov_b64 exec, -1
  s_waitcnt vmcnt(27)
  s_barrier
  ds_read_b64_tr_b16 v[20:21], v81 offset:0
  ds_read_b64_tr_b16 v[22:23], v81 offset:10240
  ds_read_b64_tr_b16 v[24:25], v81 offset:5120
  ds_read_b64_tr_b16 v[26:27], v81 offset:15360
  ds_read_b64_tr_b16 v[28:29], v81 offset:25600
  ds_read_b64_tr_b16 v[30:31], v81 offset:35840
  ds_read_b64_tr_b16 v[32:33], v81 offset:30720
  ds_read_b64_tr_b16 v[34:35], v81 offset:40960
  ds_read_b64_tr_b16 v[36:37], v81 offset:20480
  ds_read_b64_tr_b16 v[38:39], v81 offset:46080
  ds_read_b64_tr_b16 v[40:41], v81 offset:512
  ds_read_b64_tr_b16 v[42:43], v81 offset:10752
  ds_read_b64_tr_b16 v[44:45], v81 offset:5632
  ds_read_b64_tr_b16 v[46:47], v81 offset:15872
  ds_read_b64_tr_b16 v[48:49], v81 offset:26112
  ds_read_b64_tr_b16 v[50:51], v81 offset:36352
  ds_read_b64_tr_b16 v[52:53], v81 offset:31232
  ds_read_b64_tr_b16 v[54:55], v81 offset:41472
  ds_read_b64_tr_b16 v[56:57], v81 offset:20992
  ds_read_b64_tr_b16 v[58:59], v81 offset:46592
  ds_read_b64_tr_b16 v[60:61], v81 offset:1024
  ds_read_b64_tr_b16 v[62:63], v81 offset:11264
  ds_read_b64_tr_b16 v[64:65], v81 offset:6144
  ds_read_b64_tr_b16 v[66:67], v81 offset:16384
  ds_read_b64_tr_b16 v[68:69], v81 offset:26624
  ds_read_b64_tr_b16 v[70:71], v81 offset:36864
  ds_read_b64_tr_b16 v[72:73], v81 offset:31744
  ds_read_b64_tr_b16 v[74:75], v81 offset:41984
  ds_read_b64_tr_b16 v[76:77], v81 offset:21504
  ds_read_b64_tr_b16 v[78:79], v81 offset:47104
  s_waitcnt lgkmcnt(15)
  buffer_store_dwordx4 v[20:23], v2, s[32:35], s84 offen sc1
  buffer_store_dwordx4 v[24:27], v2, s[32:35], s85 offen sc1
  buffer_store_dwordx4 v[28:31], v2, s[32:35], s86 offen sc1
  buffer_store_dwordx4 v[32:35], v2, s[32:35], s87 offen sc1
  buffer_store_dwordx4 v[36:39], v2, s[32:35], s88 offen sc1
  buffer_store_dwordx4 v[40:43], v3, s[32:35], s84 offen sc1
  buffer_store_dwordx4 v[44:47], v3, s[32:35], s85 offen sc1
  s_waitcnt lgkmcnt(14)
  buffer_store_dwordx4 v[48:51], v3, s[32:35], s86 offen sc1
  s_waitcnt lgkmcnt(12)
  buffer_store_dwordx4 v[52:55], v3, s[32:35], s87 offen sc1
  s_waitcnt lgkmcnt(10)
  buffer_store_dwordx4 v[56:59], v3, s[32:35], s88 offen sc1
  s_cmp_ge_u32 s3, 2
  s_cbranch_scc1 L_sp1
  s_waitcnt lgkmcnt(8)
  buffer_store_dwordx4 v[60:63], v4, s[32:35], s84 offen sc1
  s_waitcnt lgkmcnt(6)
  buffer_store_dwordx4 v[64:67], v4, s[32:35], s85 offen sc1
  s_waitcnt lgkmcnt(4)
  buffer_store_dwordx4 v[68:71], v4, s[32:35], s86 offen sc1
  s_waitcnt lgkmcnt(2)
  buffer_store_dwordx4 v[72:75], v4, s[32:35], s87 offen sc1
  s_waitcnt lgkmcnt(0)
  buffer_store_dwordx4 v[76:79], v4, s[32:35], s88 offen sc1
L_sp1:
  s_lshl_b32 s56, s50, 3
  s_add_u32 s56, s56, 32896
  s_waitcnt vmcnt(0)
  s_barrier
  s_cmp_lg_u32 s3, 0
  s_cbranch_scc1 L_nf_1
  s_add_u32 s96, s48, 1
  v_mov_b32 v10, s96
  s_mov_b64 exec, 1
  buffer_store_dwordx2 v[10:11], off, s[32:35], s56 sc1
  s_mov_b64 exec, -1
L_nf_1:
  s_waitcnt vmcnt(0)
  s_branch L_p1done
L_p1v:
  v_lshl_add_u32 v196, v13, 4, s55
  s_sub_u32 s55, s53, 10
  s_lshl_b32 s55, s55, 7
  s_lshl_b32 s56, s3, 5
  s_add_u32 s55, s55, s56
  s_movk_i32 s56, 1920
  v_add_u32 v4, s55, v7
  v_mul_u32_u24 v5, 1639, v4
  v_lshrrev_b32 v5, 16, v5
  v_lshlrev_b32 v4, 4, v4
  v_mad_u32_u24 v4, v5, s56, v4
  v_mul_u32_u24 v5, 640, v13
  v_add_u32 v200, v4, v5
  v_add_u32 v4, s55, v7
  v_add_u32 v4, 16, v4
  v_mul_u32_u24 v5, 1639, v4
  v_lshrrev_b32 v5, 16, v5
  v_lshlrev_b32 v4, 4, v4
  v_mad_u32_u24 v4, v5, s56, v4
  v_mul_u32_u24 v5, 640, v13
  v_add_u32 v201, v4, v5
  s_mov_b32 s56, 1130496
  v_xor_b32 v197, 128, v196
  v_xor_b32 v198, 256, v196
  v_xor_b32 v199, 384, v196
  s_lshl_b32 s57, s52, 2
  s_add_u32 s57, s57, s3
  s_xor_b32 s58, s57, 0
  s_mul_i32 s58, s58, 122880
  s_add_u32 s4, s58, s56
  s_xor_b32 s58, s57, 1
  s_mul_i32 s58, s58, 122880
  s_add_u32 s5, s58, s56
  s_xor_b32 s58, s57, 2
  s_mul_i32 s58, s58, 122880
  s_add_u32 s6, s58, s56
  s_xor_b32 s58, s57, 3
  s_mul_i32 s58, s58, 122880
  s_add_u32 s7, s58, s56
  s_add_u32 m0, s67, 49152
  s_nop 0
  buffer_load_dwordx4 v88, s[28:31], s66 offen offset:0 lds
  buffer_load_dwordx4 v89, s[28:31], s66 offen offset:1024 lds
  buffer_load_dwordx4 v90, s[28:31], s66 offen offset:2048 lds
  buffer_load_dwordx4 v91, s[28:31], s66 offen offset:3072 lds
  s_add_u32 s66, s66, s69
  s_add_u32 m0, s67, 65536
  s_nop 0
  buffer_load_dwordx4 v84, s[24:27], s65 offen offset:0 lds
  buffer_load_dwordx4 v85, s[24:27], s65 offen offset:1024 lds
  buffer_load_dwordx4 v86, s[24:27], s65 offen offset:2048 lds
  buffer_load_dwordx4 v87, s[24:27], s65 offen offset:3072 lds
  s_add_u32 s64, s64, 1
  s_cmp_eq_u32 s64, 10
  s_cselect_b32 s55, -1152, s71
  s_cselect_b32 s69, -2211840, s70
  s_add_u32 s65, s65, s55
  s_add_u32 m0, s67, 81920
  s_nop 0
  buffer_load_dwordx4 v88, s[28:31], s66 offen offset:0 lds
  buffer_load_dwordx4 v89, s[28:31], s66 offen offset:1024 lds
  buffer_load_dwordx4 v90, s[28:31], s66 offen offset:2048 lds
  buffer_load_dwordx4 v91, s[28:31], s66 offen offset:3072 lds
  s_add_u32 s66, s66, s69
  s_waitcnt vmcnt(16)
  s_barrier
  ds_read_b64_tr_b16 a[64:65], v194 offset:16384
  ds_read_b64_tr_b16 a[66:67], v194 offset:17408
  ds_read_b64_tr_b16 a[68:69], v195 offset:16384
  ds_read_b64_tr_b16 a[70:71], v195 offset:17408
  ds_read_b128 a[0:3], v186 offset:0
  ds_read_b128 a[4:7], v186 offset:2048
  ds_read_b128 a[8:11], v187 offset:0
  ds_read_b128 a[12:15], v187 offset:2048
  ds_read_b128 a[16:19], v188 offset:0
  ds_read_b128 a[20:23], v188 offset:2048
  ds_read_b128 a[24:27], v189 offset:0
  ds_read_b128 a[28:31], v189 offset:2048
  s_waitcnt lgkmcnt(10)
  v_mfma_f32_16x16x32_bf16 v[158:161], v[182:185], a[64:67], 0
  ds_read_b64_tr_b16 a[72:73], v194 offset:24576
  s_waitcnt lgkmcnt(9)
  v_mfma_f32_16x16x32_bf16 v[162:165], v[182:185], a[68:71], 0
  ds_read_b64_tr_b16 a[74:75], v194 offset:25600
  s_add_u32 m0, s67, 98304
  s_waitcnt lgkmcnt(9)
  v_mfma_f32_16x16x32_bf16 v[94:97], a[0:3], a[64:67], 0
  ds_read_b64_tr_b16 a[76:77], v195 offset:24576
  buffer_load_dwordx4 v84, s[24:27], s65 offen offset:0 lds
  v_mfma_f32_16x16x32_bf16 v[98:101], a[0:3], a[68:71], 0
  ds_read_b64_tr_b16 a[78:79], v195 offset:25600
  s_waitcnt lgkmcnt(10)
  v_mfma_f32_16x16x32_bf16 v[102:105], a[4:7], a[64:67], 0
  ds_read_b128 a[32:35], v190 offset:0
  v_mfma_f32_16x16x32_bf16 v[106:109], a[4:7], a[68:71], 0
  ds_read_b128 a[36:39], v190 offset:2048
  v_mfma_f32_16x16x32_bf16 v[166:169], v[182:185], a[0:3], 0
  ds_read_b128 a[40:43], v191 offset:0
  v_mfma_f32_16x16x32_bf16 v[174:177], a[0:3], a[0:3], 0
  ds_read_b128 a[44:47], v191 offset:2048
  v_mfma_f32_16x16x32_bf16 v[170:173], v[182:185], a[4:7], 0
  ds_read_b128 a[48:51], v192 offset:0
  buffer_load_dwordx4 v85, s[24:27], s65 offen offset:1024 lds
  v_mfma_f32_16x16x32_bf16 v[178:181], a[4:7], a[4:7], 0
  ds_read_b128 a[52:55], v192 offset:2048
  s_waitcnt lgkmcnt(15)
  v_mfma_f32_16x16x32_bf16 v[110:113], a[8:11], a[64:67], 0
  ds_read_b128 a[56:59], v193 offset:0
  v_mfma_f32_16x16x32_bf16 v[114:117], a[8:11], a[68:71], 0
  ds_read_b128 a[60:63], v193 offset:2048
  s_waitcnt lgkmcnt(15)
  v_mfma_f32_16x16x32_bf16 v[118:121], a[12:15], a[64:67], 0
  v_mfma_f32_16x16x32_bf16 v[122:125], a[12:15], a[68:71], 0
  buffer_load_dwordx4 v86, s[24:27], s65 offen offset:2048 lds
  v_mfma_f32_16x16x32_bf16 v[126:129], a[16:19], a[64:67], 0
  v_mfma_f32_16x16x32_bf16 v[130:133], a[16:19], a[68:71], 0
  s_waitcnt lgkmcnt(14)
  v_mfma_f32_16x16x32_bf16 v[134:137], a[20:23], a[64:67], 0
  v_mfma_f32_16x16x32_bf16 v[138:141], a[20:23], a[68:71], 0
  s_waitcnt lgkmcnt(13)
  v_mfma_f32_16x16x32_bf16 v[142:145], a[24:27], a[64:67], 0
  v_mfma_f32_16x16x32_bf16 v[146:149], a[24:27], a[68:71], 0
  buffer_load_dwordx4 v87, s[24:27], s65 offen offset:3072 lds
  s_add_u32 s64, s64, 1
  s_cmp_eq_u32 s64, 10
  s_cselect_b32 s55, -1152, s71
  s_cselect_b32 s69, -2211840, s70
  s_add_u32 s65, s65, s55
  s_waitcnt lgkmcnt(12)
  v_mfma_f32_16x16x32_bf16 v[150:153], a[28:31], a[64:67], 0
  v_mfma_f32_16x16x32_bf16 v[154:157], a[28:31], a[68:71], 0
  s_waitcnt vmcnt(12)
  s_waitcnt lgkmcnt(0)
  s_barrier
  v_mfma_f32_16x16x32_bf16 v[158:161], v[182:185], a[72:75], v[158:161]
  ds_read_b64_tr_b16 a[64:65], v194 offset:49152
  v_mfma_f32_16x16x32_bf16 v[162:165], v[182:185], a[76:79], v[162:165]
  ds_read_b64_tr_b16 a[66:67], v194 offset:50176
  s_add_u32 m0, s67, 114688
  v_mfma_f32_16x16x32_bf16 v[94:97], a[32:35], a[72:75], v[94:97]
  ds_read_b64_tr_b16 a[68:69], v195 offset:49152
  buffer_load_dwordx4 v88, s[28:31], s66 offen offset:0 lds
  v_mfma_f32_16x16x32_bf16 v[98:101], a[32:35], a[76:79], v[98:101]
  ds_read_b64_tr_b16 a[70:71], v195 offset:50176
  v_mfma_f32_16x16x32_bf16 v[102:105], a[36:39], a[72:75], v[102:105]
  ds_read_b128 a[0:3], v186 offset:32768
  v_mfma_f32_16x16x32_bf16 v[106:109], a[36:39], a[76:79], v[106:109]
  ds_read_b128 a[4:7], v186 offset:34816
  v_mfma_f32_16x16x32_bf16 v[166:169], v[182:185], a[32:35], v[166:169]
  ds_read_b128 a[8:11], v187 offset:32768
  v_mfma_f32_16x16x32_bf16 v[174:177], a[32:35], a[32:35], v[174:177]
  ds_read_b128 a[12:15], v187 offset:34816
  v_mfma_f32_16x16x32_bf16 v[170:173], v[182:185], a[36:39], v[170:173]
  ds_read_b128 a[16:19], v188 offset:32768
  buffer_load_dwordx4 v89, s[28:31], s66 offen offset:1024 lds
  v_mfma_f32_16x16x32_bf16 v[178:181], a[36:39], a[36:39], v[178:181]
  ds_read_b128 a[20:23], v188 offset:34816
  v_mfma_f32_16x16x32_bf16 v[110:113], a[40:43], a[72:75], v[110:113]
  ds_read_b128 a[24:27], v189 offset:32768
  v_mfma_f32_16x16x32_bf16 v[114:117], a[40:43], a[76:79], v[114:117]
  ds_read_b128 a[28:31], v189 offset:34816
  v_mfma_f32_16x16x32_bf16 v[118:121], a[44:47], a[72:75], v[118:121]
  v_mfma_f32_16x16x32_bf16 v[122:125], a[44:47], a[76:79], v[122:125]
  buffer_load_dwordx4 v90, s[28:31], s66 offen offset:2048 lds
  v_mfma_f32_16x16x32_bf16 v[126:129], a[48:51], a[72:75], v[126:129]
  v_mfma_f32_16x16x32_bf16 v[130:133], a[48:51], a[76:79], v[130:133]
  v_mfma_f32_16x16x32_bf16 v[134:137], a[52:55], a[72:75], v[134:137]
  v_mfma_f32_16x16x32_bf16 v[138:141], a[52:55], a[76:79], v[138:141]
  v_mfma_f32_16x16x32_bf16 v[142:145], a[56:59], a[72:75], v[142:145]
  v_mfma_f32_16x16x32_bf16 v[146:149], a[56:59], a[76:79], v[146:149]
  buffer_load_dwordx4 v91, s[28:31], s66 offen offset:3072 lds
  s_add_u32 s66, s66, s69
  v_mfma_f32_16x16x32_bf16 v[150:153], a[60:63], a[72:75], v[150:153]
  v_mfma_f32_16x16x32_bf16 v[154:157], a[60:63], a[76:79], v[154:157]
  s_waitcnt lgkmcnt(0)
  v_mfma_f32_16x16x32_bf16 v[158:161], v[182:185], a[64:67], v[158:161]
  ds_read_b64_tr_b16 a[72:73], v194 offset:57344
  v_mfma_f32_16x16x32_bf16 v[162:165], v[182:185], a[68:71], v[162:165]
  ds_read_b64_tr_b16 a[74:75], v194 offset:58368
  s_add_u32 m0, s67, 0
  v_mfma_f32_16x16x32_bf16 v[94:97], a[0:3], a[64:67], v[94:97]
  ds_read_b64_tr_b16 a[76:77], v195 offset:57344
  buffer_load_dwordx4 v84, s[24:27], s65 offen offset:0 lds
  v_mfma_f32_16x16x32_bf16 v[98:101], a[0:3], a[68:71], v[98:101]
  ds_read_b64_tr_b16 a[78:79], v195 offset:58368
  v_mfma_f32_16x16x32_bf16 v[102:105], a[4:7], a[64:67], v[102:105]
  ds_read_b128 a[32:35], v190 offset:32768
  v_mfma_f32_16x16x32_bf16 v[106:109], a[4:7], a[68:71], v[106:109]
  ds_read_b128 a[36:39], v190 offset:34816
  v_mfma_f32_16x16x32_bf16 v[166:169], v[182:185], a[0:3], v[166:169]
  ds_read_b128 a[40:43], v191 offset:32768
  buffer_load_dwordx4 v85, s[24:27], s65 offen offset:1024 lds
  v_mfma_f32_16x16x32_bf16 v[174:177], a[0:3], a[0:3], v[174:177]
  ds_read_b128 a[44:47], v191 offset:34816
  v_mfma_f32_16x16x32_bf16 v[170:173], v[182:185], a[4:7], v[170:173]
  ds_read_b128 a[48:51], v192 offset:32768
  v_mfma_f32_16x16x32_bf16 v[178:181], a[4:7], a[4:7], v[178:181]
  ds_read_b128 a[52:55], v192 offset:34816
  v_mfma_f32_16x16x32_bf16 v[110:113], a[8:11], a[64:67], v[110:113]
  ds_read_b128 a[56:59], v193 offset:32768
  v_mfma_f32_16x16x32_bf16 v[114:117], a[8:11], a[68:71], v[114:117]
  ds_read_b128 a[60:63], v193 offset:34816
  buffer_load_dwordx4 v86, s[24:27], s65 offen offset:2048 lds
  v_mfma_f32_16x16x32_bf16 v[118:121], a[12:15], a[64:67], v[118:121]
  v_xor_b32 v186, 0x10000, v186
  v_mfma_f32_16x16x32_bf16 v[122:125], a[12:15], a[68:71], v[122:125]
  v_xor_b32 v187, 0x10000, v187
  v_mfma_f32_16x16x32_bf16 v[126:129], a[16:19], a[64:67], v[126:129]
  v_xor_b32 v188, 0x10000, v188
  v_mfma_f32_16x16x32_bf16 v[130:133], a[16:19], a[68:71], v[130:133]
  buffer_load_dwordx4 v87, s[24:27], s65 offen offset:3072 lds
  s_add_u32 s64, s64, 1
  s_cmp_eq_u32 s64, 10
  s_cselect_b32 s55, -1152, s71
  s_cselect_b32 s69, -2211840, s70
  s_add_u32 s65, s65, s55
  v_xor_b32 v189, 0x10000, v189
  v_mfma_f32_16x16x32_bf16 v[134:137], a[20:23], a[64:67], v[134:137]
  v_xor_b32 v190, 0x10000, v190
  v_mfma_f32_16x16x32_bf16 v[138:141], a[20:23], a[68:71], v[138:141]
  v_xor_b32 v191, 0x10000, v191
  v_mfma_f32_16x16x32_bf16 v[142:145], a[24:27], a[64:67], v[142:145]
  v_xor_b32 v192, 0x10000, v192
  v_mfma_f32_16x16x32_bf16 v[146:149], a[24:27], a[68:71], v[146:149]
  s_mov_b64 exec, 0x47fe7fff
  buffer_load_dword v92, v92, s[32:35], 0 offen sc1
  s_mov_b64 exec, -1
  v_xor_b32 v193, 0x10000, v193
  v_mfma_f32_16x16x32_bf16 v[150:153], a[28:31], a[64:67], v[150:153]
  v_xor_b32 v194, 0x10000, v194
  v_mfma_f32_16x16x32_bf16 v[154:157], a[28:31], a[68:71], v[154:157]
  v_xor_b32 v195, 0x10000, v195
  s_waitcnt vmcnt(13)
  s_waitcnt lgkmcnt(0)
  s_barrier
  v_mfma_f32_16x16x32_bf16 v[158:161], v[182:185], a[72:75], v[158:161]
  ds_read_b64_tr_b16 a[64:65], v194 offset:16384
  v_mfma_f32_16x16x32_bf16 v[162:165], v[182:185], a[76:79], v[162:165]
  ds_read_b64_tr_b16 a[66:67], v194 offset:17408
  s_add_u32 m0, s67, 16384
  v_mfma_f32_16x16x32_bf16 v[94:97], a[32:35], a[72:75], v[94:97]
  ds_read_b64_tr_b16 a[68:69], v195 offset:16384
  buffer_load_dwordx4 v88, s[28:31], s66 offen offset:0 lds
  v_mfma_f32_16x16x32_bf16 v[98:101], a[32:35], a[76:79], v[98:101]
  ds_read_b64_tr_b16 a[70:71], v195 offset:17408
  v_mfma_f32_16x16x32_bf16 v[102:105], a[36:39], a[72:75], v[102:105]
  ds_read_b128 a[0:3], v186 offset:0
  v_mfma_f32_16x16x32_bf16 v[106:109], a[36:39], a[76:79], v[106:109]
  ds_read_b128 a[4:7], v186 offset:2048
  v_mfma_f32_16x16x32_bf16 v[166:169], v[182:185], a[32:35], v[166:169]
  ds_read_b128 a[8:11], v187 offset:0
  v_mfma_f32_16x16x32_bf16 v[174:177], a[32:35], a[32:35], v[174:177]
  ds_read_b128 a[12:15], v187 offset:2048
  v_mfma_f32_16x16x32_bf16 v[170:173], v[182:185], a[36:39], v[170:173]
  ds_read_b128 a[16:19], v188 offset:0
  buffer_load_dwordx4 v89, s[28:31], s66 offen offset:1024 lds
  v_mfma_f32_16x16x32_bf16 v[178:181], a[36:39], a[36:39], v[178:181]
  ds_read_b128 a[20:23], v188 offset:2048
  v_mfma_f32_16x16x32_bf16 v[110:113], a[40:43], a[72:75], v[110:113]
  ds_read_b128 a[24:27], v189 offset:0
  v_mfma_f32_16x16x32_bf16 v[114:117], a[40:43], a[76:79], v[114:117]
  ds_read_b128 a[28:31], v189 offset:2048
  v_mfma_f32_16x16x32_bf16 v[118:121], a[44:47], a[72:75], v[118:121]
  v_mfma_f32_16x16x32_bf16 v[122:125], a[44:47], a[76:79], v[122:125]
  buffer_load_dwordx4 v90, s[28:31], s66 offen offset:2048 lds
  v_mfma_f32_16x16x32_bf16 v[126:129], a[48:51], a[72:75], v[126:129]
  v_mfma_f32_16x16x32_bf16 v[130:133], a[48:51], a[76:79], v[130:133]
  v_mfma_f32_16x16x32_bf16 v[134:137], a[52:55], a[72:75], v[134:137]
  v_mfma_f32_16x16x32_bf16 v[138:141], a[52:55], a[76:79], v[138:141]
  v_mfma_f32_16x16x32_bf16 v[142:145], a[56:59], a[72:75], v[142:145]
  v_mfma_f32_16x16x32_bf16 v[146:149], a[56:59], a[76:79], v[146:149]
  buffer_load_dwordx4 v91, s[28:31], s66 offen offset:3072 lds
  s_add_u32 s66, s66, s69
  v_mfma_f32_16x16x32_bf16 v[150:153], a[60:63], a[72:75], v[150:153]
  v_mfma_f32_16x16x32_bf16 v[154:157], a[60:63], a[76:79], v[154:157]
  s_waitcnt lgkmcnt(0)
  v_mfma_f32_16x16x32_bf16 v[158:161], v[182:185], a[64:67], v[158:161]
  ds_read_b64_tr_b16 a[72:73], v194 offset:24576
  v_mfma_f32_16x16x32_bf16 v[162:165], v[182:185], a[68:71], v[162:165]
  ds_read_b64_tr_b16 a[74:75], v194 offset:25600
  s_add_u32 m0, s67, 32768
  v_mfma_f32_16x16x32_bf16 v[94:97], a[0:3], a[64:67], v[94:97]
  ds_read_b64_tr_b16 a[76:77], v195 offset:24576
  buffer_load_dwordx4 v84, s[24:27], s65 offen offset:0 lds
  v_mfma_f32_16x16x32_bf16 v[98:101], a[0:3], a[68:71], v[98:101]
  ds_read_b64_tr_b16 a[78:79], v195 offset:25600
  v_mfma_f32_16x16x32_bf16 v[102:105], a[4:7], a[64:67], v[102:105]
  ds_read_b128 a[32:35], v190 offset:0
  v_mfma_f32_16x16x32_bf16 v[106:109], a[4:7], a[68:71], v[106:109]
  ds_read_b128 a[36:39], v190 offset:2048
  v_mfma_f32_16x16x32_bf16 v[166:169], v[182:185], a[0:3], v[166:169]
  ds_read_b128 a[40:43], v191 offset:0
  v_mfma_f32_16x16x32_bf16 v[174:177], a[0:3], a[0:3], v[174:177]
  ds_read_b128 a[44:47], v191 offset:2048
  v_mfma_f32_16x16x32_bf16 v[170:173], v[182:185], a[4:7], v[170:173]
  ds_read_b128 a[48:51], v192 offset:0
  buffer_load_dwordx4 v85, s[24:27], s65 offen offset:1024 lds
  v_mfma_f32_16x16x32_bf16 v[178:181], a[4:7], a[4:7], v[178:181]
  ds_read_b128 a[52:55], v192 offset:2048
  v_mfma_f32_16x16x32_bf16 v[110:113], a[8:11], a[64:67], v[110:113]
  ds_read_b128 a[56:59], v193 offset:0
  v_mfma_f32_16x16x32_bf16 v[114:117], a[8:11], a[68:71], v[114:117]
  ds_read_b128 a[60:63], v193 offset:2048
  v_mfma_f32_16x16x32_bf16 v[118:121], a[12:15], a[64:67], v[118:121]
  v_mfma_f32_16x16x32_bf16 v[122:125], a[12:15], a[68:71], v[122:125]
  buffer_load_dwordx4 v86, s[24:27], s65 offen offset:2048 lds
  v_mfma_f32_16x16x32_bf16 v[126:129], a[16:19], a[64:67], v[126:129]
  v_mfma_f32_16x16x32_bf16 v[130:133], a[16:19], a[68:71], v[130:133]
  v_mfma_f32_16x16x32_bf16 v[134:137], a[20:23], a[64:67], v[134:137]
  v_mfma_f32_16x16x32_bf16 v[138:141], a[20:23], a[68:71], v[138:141]
  v_mfma_f32_16x16x32_bf16 v[142:145], a[24:27], a[64:67], v[142:145]
  v_mfma_f32_16x16x32_bf16 v[146:149], a[24:27], a[68:71], v[146:149]
  buffer_load_dwordx4 v87, s[24:27], s65 offen offset:3072 lds
  s_add_u32 s64, s64, 1
  s_cmp_eq_u32 s64, 10
  s_cselect_b32 s55, -1152, s71
  s_cselect_b32 s69, -2211840, s70
  s_add_u32 s65, s65, s55
  v_mfma_f32_16x16x32_bf16 v[150:153], a[28:31], a[64:67], v[150:153]
  v_mfma_f32_16x16x32_bf16 v[154:157], a[28:31], a[68:71], v[154:157]
  s_waitcnt vmcnt(13)
  s_waitcnt lgkmcnt(0)
  s_barrier
  v_mfma_f32_16x16x32_bf16 v[158:161], v[182:185], a[72:75], v[158:161]
  ds_read_b64_tr_b16 a[64:65], v194 offset:49152
  v_mfma_f32_16x16x32_bf16 v[162:165], v[182:185], a[76:79], v[162:165]
  ds_read_b64_tr_b16 a[66:67], v194 offset:50176
  s_add_u32 m0, s67, 49152
  v_mfma_f32_16x16x32_bf16 v[94:97], a[32:35], a[72:75], v[94:97]
  ds_read_b64_tr_b16 a[68:69], v195 offset:49152
  buffer_load_dwordx4 v88, s[28:31], s66 offen offset:0 lds
  v_mfma_f32_16x16x32_bf16 v[98:101], a[32:35], a[76:79], v[98:101]
  ds_read_b64_tr_b16 a[70:71], v195 offset:50176
  v_mfma_f32_16x16x32_bf16 v[102:105], a[36:39], a[72:75], v[102:105]
  ds_read_b128 a[0:3], v186 offset:32768
  v_mfma_f32_16x16x32_bf16 v[106:109], a[36:39], a[76:79], v[106:109]
  ds_read_b128 a[4:7], v186 offset:34816
  v_mfma_f32_16x16x32_bf16 v[166:169], v[182:185], a[32:35], v[166:169]
  ds_read_b128 a[8:11], v187 offset:32768
  v_mfma_f32_16x16x32_bf16 v[174:177], a[32:35], a[32:35], v[174:177]
  ds_read_b128 a[12:15], v187 offset:34816
  v_mfma_f32_16x16x32_bf16 v[170:173], v[182:185], a[36:39], v[170:173]
  ds_read_b128 a[16:19], v188 offset:32768
  buffer_load_dwordx4 v89, s[28:31], s66 offen offset:1024 lds
  v_mfma_f32_16x16x32_bf16 v[178:181], a[36:39], a[36:39], v[178:181]
  ds_read_b128 a[20:23], v188 offset:34816
  v_mfma_f32_16x16x32_bf16 v[110:113], a[40:43], a[72:75], v[110:113]
  ds_read_b128 a[24:27], v189 offset:32768
  v_mfma_f32_16x16x32_bf16 v[114:117], a[40:43], a[76:79], v[114:117]
  ds_read_b128 a[28:31], v189 offset:34816
  v_mfma_f32_16x16x32_bf16 v[118:121], a[44:47], a[72:75], v[118:121]
  v_mfma_f32_16x16x32_bf16 v[122:125], a[44:47], a[76:79], v[122:125]
  buffer_load_dwordx4 v90, s[28:31], s66 offen offset:2048 lds
  v_mfma_f32_16x16x32_bf16 v[126:129], a[48:51], a[72:75], v[126:129]
  v_mfma_f32_16x16x32_bf16 v[130:133], a[48:51], a[76:79], v[130:133]
  v_mfma_f32_16x16x32_bf16 v[134:137], a[52:55], a[72:75], v[134:137]
  v_mfma_f32_16x16x32_bf16 v[138:141], a[52:55], a[76:79], v[138:141]
  v_mfma_f32_16x16x32_bf16 v[142:145], a[56:59], a[72:75], v[142:145]
  v_mfma_f32_16x16x32_bf16 v[146:149], a[56:59], a[76:79], v[146:149]
  buffer_load_dwordx4 v91, s[28:31], s66 offen offset:3072 lds
  s_add_u32 s66, s66, s69
  v_mfma_f32_16x16x32_bf16 v[150:153], a[60:63], a[72:75], v[150:153]
  v_mfma_f32_16x16x32_bf16 v[154:157], a[60:63], a[76:79], v[154:157]
  s_waitcnt lgkmcnt(0)
  v_mfma_f32_16x16x32_bf16 v[158:161], v[182:185], a[64:67], v[158:161]
  ds_read_b64_tr_b16 a[72:73], v194 offset:57344
  v_mfma_f32_16x16x32_bf16 v[162:165], v[182:185], a[68:71], v[162:165]
  ds_read_b64_tr_b16 a[74:75], v194 offset:58368
  s_add_u32 m0, s67, 65536
  v_mfma_f32_16x16x32_bf16 v[94:97], a[0:3], a[64:67], v[94:97]
  ds_read_b64_tr_b16 a[76:77], v195 offset:57344
  buffer_load_dwordx4 v84, s[24:27], s65 offen offset:0 lds
  v_mfma_f32_16x16x32_bf16 v[98:101], a[0:3], a[68:71], v[98:101]
  ds_read_b64_tr_b16 a[78:79], v195 offset:58368
  v_mfma_f32_16x16x32_bf16 v[102:105], a[4:7], a[64:67], v[102:105]
  ds_read_b128 a[32:35], v190 offset:32768
  v_mfma_f32_16x16x32_bf16 v[106:109], a[4:7], a[68:71], v[106:109]
  ds_read_b128 a[36:39], v190 offset:34816
  v_mfma_f32_16x16x32_bf16 v[166:169], v[182:185], a[0:3], v[166:169]
  ds_read_b128 a[40:43], v191 offset:32768
  v_mfma_f32_16x16x32_bf16 v[174:177], a[0:3], a[0:3], v[174:177]
  ds_read_b128 a[44:47], v191 offset:34816
  v_mfma_f32_16x16x32_bf16 v[170:173], v[182:185], a[4:7], v[170:173]
  ds_read_b128 a[48:51], v192 offset:32768
  buffer_load_dwordx4 v85, s[24:27], s65 offen offset:1024 lds
  v_mfma_f32_16x16x32_bf16 v[178:181], a[4:7], a[4:7], v[178:181]
  ds_read_b128 a[52:55], v192 offset:34816
  v_mfma_f32_16x16x32_bf16 v[110:113], a[8:11], a[64:67], v[110:113]
  ds_read_b128 a[56:59], v193 offset:32768
  v_mfma_f32_16x16x32_bf16 v[114:117], a[8:11], a[68:71], v[114:117]
  ds_read_b128 a[60:63], v193 offset:34816
  v_mfma_f32_16x16x32_bf16 v[118:121], a[12:15], a[64:67], v[118:121]
  v_xor_b32 v186, 0x10000, v186
  v_mfma_f32_16x16x32_bf16 v[122:125], a[12:15], a[68:71], v[122:125]
  buffer_load_dwordx4 v86, s[24:27], s65 offen offset:2048 lds
  v_xor_b32 v187, 0x10000, v187
  v_mfma_f32_16x16x32_bf16 v[126:129], a[16:19], a[64:67], v[126:129]
  v_xor_b32 v188, 0x10000, v188
  v_mfma_f32_16x16x32_bf16 v[130:133], a[16:19], a[68:71], v[130:133]
  v_xor_b32 v189, 0x10000, v189
  v_mfma_f32_16x16x32_bf16 v[134:137], a[20:23], a[64:67], v[134:137]
  v_xor_b32 v190, 0x10000, v190
  v_mfma_f32_16x16x32_bf16 v[138:141], a[20:23], a[68:71], v[138:141]
  v_xor_b32 v191, 0x10000, v191
  v_mfma_f32_16x16x32_bf16 v[142:145], a[24:27], a[64:67], v[142:145]
  v_xor_b32 v192, 0x10000, v192
  v_mfma_f32_16x16x32_bf16 v[146:149], a[24:27], a[68:71], v[146:149]
  buffer_load_dwordx4 v87, s[24:27], s65 offen offset:3072 lds
  s_add_u32 s64, s64, 1
  s_cmp_eq_u32 s64, 10
  s_cselect_b32 s55, -1152, s71
  s_cselect_b32 s69, -2211840, s70
  s_add_u32 s65, s65, s55
  v_xor_b32 v193, 0x10000, v193
  v_mfma_f32_16x16x32_bf16 v[150:153], a[28:31], a[64:67], v[150:153]
  v_xor_b32 v194, 0x10000, v194
  v_mfma_f32_16x16x32_bf16 v[154:157], a[28:31], a[68:71], v[154:157]
  v_xor_b32 v195, 0x10000, v195
  s_waitcnt vmcnt(12)
  s_waitcnt lgkmcnt(0)
  s_barrier
  v_mfma_f32_16x16x32_bf16 v[158:161], v[182:185], a[72:75], v[158:161]
  ds_read_b64_tr_b16 a[64:65], v194 offset:16384
  v_mfma_f32_16x16x32_bf16 v[162:165], v[182:185], a[76:79], v[162:165]
  ds_read_b64_tr_b16 a[66:67], v194 offset:17408
  s_add_u32 m0, s67, 81920
  v_mfma_f32_16x16x32_bf16 v[94:97], a[32:35], a[72:75], v[94:97]
  ds_read_b64_tr_b16 a[68:69], v195 offset:16384
  buffer_load_dwordx4 v88, s[28:31], s66 offen offset:0 lds
  v_mfma_f32_16x16x32_bf16 v[98:101], a[32:35], a[76:79], v[98:101]
  ds_read_b64_tr_b16 a[70:71], v195 offset:17408
  v_mfma_f32_16x16x32_bf16 v[102:105], a[36:39], a[72:75], v[102:105]
  ds_read_b128 a[0:3], v186 offset:0
  v_mfma_f32_16x16x32_bf16 v[106:109], a[36:39], a[76:79], v[106:109]
  ds_read_b128 a[4:7], v186 offset:2048
  v_mfma_f32_16x16x32_bf16 v[166:169], v[182:185], a[32:35], v[166:169]
  ds_read_b128 a[8:11], v187 offset:0
  v_mfma_f32_16x16x32_bf16 v[174:177], a[32:35], a[32:35], v[174:177]
  ds_read_b128 a[12:15], v187 offset:2048
  v_mfma_f32_16x16x32_bf16 v[170:173], v[182:185], a[36:39], v[170:173]
  ds_read_b128 a[16:19], v188 offset:0
  buffer_load_dwordx4 v89, s[28:31], s66 offen offset:1024 lds
  v_mfma_f32_16x16x32_bf16 v[178:181], a[36:39], a[36:39], v[178:181]
  ds_read_b128 a[20:23], v188 offset:2048
  v_mfma_f32_16x16x32_bf16 v[110:113], a[40:43], a[72:75], v[110:113]
  ds_read_b128 a[24:27], v189 offset:0
  v_mfma_f32_16x16x32_bf16 v[114:117], a[40:43], a[76:79], v[114:117]
  ds_read_b128 a[28:31], v189 offset:2048
  v_mfma_f32_16x16x32_bf16 v[118:121], a[44:47], a[72:75], v[118:121]
  v_mfma_f32_16x16x32_bf16 v[122:125], a[44:47], a[76:79], v[122:125]
  buffer_load_dwordx4 v90, s[28:31], s66 offen offset:2048 lds
  v_mfma_f32_16x16x32_bf16 v[126:129], a[48:51], a[72:75], v[126:129]
  v_mfma_f32_16x16x32_bf16 v[130:133], a[48:51], a[76:79], v[130:133]
  v_mfma_f32_16x16x32_bf16 v[134:137], a[52:55], a[72:75], v[134:137]
  v_mfma_f32_16x16x32_bf16 v[138:141], a[52:55], a[76:79], v[138:141]
  v_mfma_f32_16x16x32_bf16 v[142:145], a[56:59], a[72:75], v[142:145]
  v_mfma_f32_16x16x32_bf16 v[146:149], a[56:59], a[76:79], v[146:149]
  buffer_load_dwordx4 v91, s[28:31], s66 offen offset:3072 lds
  s_add_u32 s66, s66, s69
  v_mfma_f32_16x16x32_bf16 v[150:153], a[60:63], a[72:75], v[150:153]
  v_mfma_f32_16x16x32_bf16 v[154:157], a[60:63], a[76:79], v[154:157]
  s_waitcnt lgkmcnt(0)
  v_mfma_f32_16x16x32_bf16 v[158:161], v[182:185], a[64:67], v[158:161]
  ds_read_b64_tr_b16 a[72:73], v194 offset:24576
  v_mfma_f32_16x16x32_bf16 v[162:165], v[182:185], a[68:71], v[162:165]
  ds_read_b64_tr_b16 a[74:75], v194 offset:25600
  s_add_u32 m0, s67, 98304
  v_mfma_f32_16x16x32_bf16 v[94:97], a[0:3], a[64:67], v[94:97]
  ds_read_b64_tr_b16 a[76:77], v195 offset:24576
  buffer_load_dwordx4 v84, s[24:27], s65 offen offset:0 lds
  v_mfma_f32_16x16x32_bf16 v[98:101], a[0:3], a[68:71], v[98:101]
  ds_read_b64_tr_b16 a[78:79], v195 offset:25600
  v_mfma_f32_16x16x32_bf16 v[102:105], a[4:7], a[64:67], v[102:105]
  ds_read_b128 a[32:35], v190 offset:0
  v_mfma_f32_16x16x32_bf16 v[106:109], a[4:7], a[68:71], v[106:109]
  ds_read_b128 a[36:39], v190 offset:2048
  v_mfma_f32_16x16x32_bf16 v[166:169], v[182:185], a[0:3], v[166:169]
  ds_read_b128 a[40:43], v191 offset:0
  v_mfma_f32_16x16x32_bf16 v[174:177], a[0:3], a[0:3], v[174:177]
  ds_read_b128 a[44:47], v191 offset:2048
  v_mfma_f32_16x16x32_bf16 v[170:173], v[182:185], a[4:7], v[170:173]
  ds_read_b128 a[48:51], v192 offset:0
  buffer_load_dwordx4 v85, s[24:27], s65 offen offset:1024 lds
  v_mfma_f32_16x16x32_bf16 v[178:181], a[4:7], a[4:7], v[178:181]
  ds_read_b128 a[52:55], v192 offset:2048
  v_mfma_f32_16x16x32_bf16 v[110:113], a[8:11], a[64:67], v[110:113]
  ds_read_b128 a[56:59], v193 offset:0
  v_mfma_f32_16x16x32_bf16 v[114:117], a[8:11], a[68:71], v[114:117]
  ds_read_b128 a[60:63], v193 offset:2048
  v_mfma_f32_16x16x32_bf16 v[118:121], a[12:15], a[64:67], v[118:121]
  v_mfma_f32_16x16x32_bf16 v[122:125], a[12:15], a[68:71], v[122:125]
  buffer_load_dwordx4 v86, s[24:27], s65 offen offset:2048 lds
  v_mfma_f32_16x16x32_bf16 v[126:129], a[16:19], a[64:67], v[126:129]
  v_mfma_f32_16x16x32_bf16 v[130:133], a[16:19], a[68:71], v[130:133]
  v_mfma_f32_16x16x32_bf16 v[134:137], a[20:23], a[64:67], v[134:137]
  v_mfma_f32_16x16x32_bf16 v[138:141], a[20:23], a[68:71], v[138:141]
  v_mfma_f32_16x16x32_bf16 v[142:145], a[24:27], a[64:67], v[142:145]
  v_mfma_f32_16x16x32_bf16 v[146:149], a[24:27], a[68:71], v[146:149]
  buffer_load_dwordx4 v87, s[24:27], s65 offen offset:3072 lds
  s_add_u32 s64, s64, 1
  s_cmp_eq_u32 s64, 10
  s_cselect_b32 s55, -1152, s71
  s_cselect_b32 s69, -2211840, s70
  s_add_u32 s65, s65, s55
  v_mfma_f32_16x16x32_bf16 v[150:153], a[28:31], a[64:67], v[150:153]
  v_mfma_f32_16x16x32_bf16 v[154:157], a[28:31], a[68:71], v[154:157]
  s_waitcnt vmcnt(12)
  s_waitcnt lgkmcnt(0)
  s_barrier
  v_mfma_f32_16x16x32_bf16 v[158:161], v[182:185], a[72:75], v[158:161]
  ds_read_b64_tr_b16 a[64:65], v194 offset:49152
  s_add_u32 m0, s67, 114688
  s_nop 0
  buffer_load_dwordx4 v88, s[28:31], s66 offen offset:0 lds
  v_mfma_f32_16x16x32_bf16 v[162:165], v[182:185], a[76:79], v[162:165]
  ds_read_b64_tr_b16 a[66:67], v194 offset:50176
  v_mfma_f32_16x16x32_bf16 v[94:97], a[32:35], a[72:75], v[94:97]
  ds_read_b64_tr_b16 a[68:69], v195 offset:49152
  buffer_load_dwordx4 v89, s[28:31], s66 offen offset:1024 lds
  v_mfma_f32_16x16x32_bf16 v[98:101], a[32:35], a[76:79], v[98:101]
  ds_read_b64_tr_b16 a[70:71], v195 offset:50176
  v_mfma_f32_16x16x32_bf16 v[102:105], a[36:39], a[72:75], v[102:105]
  ds_read_b128 a[0:3], v186 offset:32768
  buffer_load_dwordx4 v90, s[28:31], s66 offen offset:2048 lds
  v_mfma_f32_16x16x32_bf16 v[106:109], a[36:39], a[76:79], v[106:109]
  ds_read_b128 a[4:7], v186 offset:34816
  v_mfma_f32_16x16x32_bf16 v[166:169], v[182:185], a[32:35], v[166:169]
  ds_read_b128 a[8:11], v187 offset:32768
  buffer_load_dwordx4 v91, s[28:31], s66 offen offset:3072 lds
  s_add_u32 s66, s66, s69
  v_mfma_f32_16x16x32_bf16 v[174:177], a[32:35], a[32:35], v[174:177]
  ds_read_b128 a[12:15], v187 offset:34816
  s_add_u32 m0, s67, 0
  v_mfma_f32_16x16x32_bf16 v[170:173], v[182:185], a[36:39], v[170:173]
  ds_read_b128 a[16:19], v188 offset:32768
  buffer_load_dwordx4 v84, s[24:27], s65 offen offset:0 lds
  v_mfma_f32_16x16x32_bf16 v[178:181], a[36:39], a[36:39], v[178:181]
  ds_read_b128 a[20:23], v188 offset:34816
  v_mfma_f32_16x16x32_bf16 v[110:113], a[40:43], a[72:75], v[110:113]
  ds_read_b128 a[24:27], v189 offset:32768
  buffer_load_dwordx4 v85, s[24:27], s65 offen offset:1024 lds
  v_mfma_f32_16x16x32_bf16 v[114:117], a[40:43], a[76:79], v[114:117]
  ds_read_b128 a[28:31], v189 offset:34816
  buffer_load_dwordx4 v86, s[24:27], s65 offen offset:2048 lds
  v_mfma_f32_16x16x32_bf16 v[118:121], a[44:47], a[72:75], v[118:121]
  v_mfma_f32_16x16x32_bf16 v[122:125], a[44:47], a[76:79], v[122:125]
  buffer_load_dwordx4 v87, s[24:27], s65 offen offset:3072 lds
  s_add_u32 s64, s64, 1
  s_cmp_eq_u32 s64, 10
  s_cselect_b32 s55, -1152, s71
  s_cselect_b32 s69, -2211840, s70
  s_add_u32 s65, s65, s55
  v_mfma_f32_16x16x32_bf16 v[126:129], a[48:51], a[72:75], v[126:129]
  s_add_u32 m0, s67, 16384
  v_mfma_f32_16x16x32_bf16 v[130:133], a[48:51], a[76:79], v[130:133]
  buffer_load_dwordx4 v88, s[28:31], s66 offen offset:0 lds
  v_mfma_f32_16x16x32_bf16 v[134:137], a[52:55], a[72:75], v[134:137]
  v_mfma_f32_16x16x32_bf16 v[138:141], a[52:55], a[76:79], v[138:141]
  buffer_load_dwordx4 v89, s[28:31], s66 offen offset:1024 lds
  v_mfma_f32_16x16x32_bf16 v[142:145], a[56:59], a[72:75], v[142:145]
  v_mfma_f32_16x16x32_bf16 v[146:149], a[56:59], a[76:79], v[146:149]
  buffer_load_dwordx4 v90, s[28:31], s66 offen offset:2048 lds
  v_mfma_f32_16x16x32_bf16 v[150:153], a[60:63], a[72:75], v[150:153]
  v_mfma_f32_16x16x32_bf16 v[154:157], a[60:63], a[76:79], v[154:157]
  buffer_load_dwordx4 v91, s[28:31], s66 offen offset:3072 lds
  s_add_u32 s66, s66, s69
  s_waitcnt lgkmcnt(0)
  v_mfma_f32_16x16x32_bf16 v[158:161], v[182:185], a[64:67], v[158:161]
  ds_read_b64_tr_b16 a[72:73], v194 offset:57344
  v_mfma_f32_16x16x32_bf16 v[162:165], v[182:185], a[68:71], v[162:165]
  ds_read_b64_tr_b16 a[74:75], v194 offset:58368
  v_mfma_f32_16x16x32_bf16 v[94:97], a[0:3], a[64:67], v[94:97]
  ds_read_b64_tr_b16 a[76:77], v195 offset:57344
  v_mfma_f32_16x16x32_bf16 v[98:101], a[0:3], a[68:71], v[98:101]
  ds_read_b64_tr_b16 a[78:79], v195 offset:58368
  v_mfma_f32_16x16x32_bf16 v[102:105], a[4:7], a[64:67], v[102:105]
  ds_read_b128 a[32:35], v190 offset:32768
  v_mfma_f32_16x16x32_bf16 v[106:109], a[4:7], a[68:71], v[106:109]
  ds_read_b128 a[36:39], v190 offset:34816
  v_mfma_f32_16x16x32_bf16 v[166:169], v[182:185], a[0:3], v[166:169]
  ds_read_b128 a[40:43], v191 offset:32768
  v_mfma_f32_16x16x32_bf16 v[174:177], a[0:3], a[0:3], v[174:177]
  ds_read_b128 a[44:47], v191 offset:34816
  v_mfma_f32_16x16x32_bf16 v[170:173], v[182:185], a[4:7], v[170:173]
  ds_read_b128 a[48:51], v192 offset:32768
  v_mfma_f32_16x16x32_bf16 v[178:181], a[4:7], a[4:7], v[178:181]
  ds_read_b128 a[52:55], v192 offset:34816
  v_mfma_f32_16x16x32_bf16 v[110:113], a[8:11], a[64:67], v[110:113]
  ds_read_b128 a[56:59], v193 offset:32768
  v_mfma_f32_16x16x32_bf16 v[114:117], a[8:11], a[68:71], v[114:117]
  ds_read_b128 a[60:63], v193 offset:34816
  v_mfma_f32_16x16x32_bf16 v[118:121], a[12:15], a[64:67], v[118:121]
  v_xor_b32 v186, 0x10000, v186
  v_mfma_f32_16x16x32_bf16 v[122:125], a[12:15], a[68:71], v[122:125]
  v_xor_b32 v187, 0x10000, v187
  v_mfma_f32_16x16x32_bf16 v[126:129], a[16:19], a[64:67], v[126:129]
  v_xor_b32 v188, 0x10000, v188
  v_mfma_f32_16x16x32_bf16 v[130:133], a[16:19], a[68:71], v[130:133]
  v_xor_b32 v189, 0x10000, v189
  v_mfma_f32_16x16x32_bf16 v[134:137], a[20:23], a[64:67], v[134:137]
  v_xor_b32 v190, 0x10000, v190
  v_mfma_f32_16x16x32_bf16 v[138:141], a[20:23], a[68:71], v[138:141]
  v_xor_b32 v191, 0x10000, v191
  v_mfma_f32_16x16x32_bf16 v[142:145], a[24:27], a[64:67], v[142:145]
  v_xor_b32 v192, 0x10000, v192
  v_mfma_f32_16x16x32_bf16 v[146:149], a[24:27], a[68:71], v[146:149]
  v_xor_b32 v193, 0x10000, v193
  v_mfma_f32_16x16x32_bf16 v[150:153], a[28:31], a[64:67], v[150:153]
  v_xor_b32 v194, 0x10000, v194
  v_mfma_f32_16x16x32_bf16 v[154:157], a[28:31], a[68:71], v[154:157]
  v_xor_b32 v195, 0x10000, v195
  s_waitcnt vmcnt(16)
  s_waitcnt lgkmcnt(0)
  s_barrier
  v_mfma_f32_16x16x32_bf16 v[158:161], v[182:185], a[72:75], v[158:161]
  ds_read_b64_tr_b16 a[64:65], v194 offset:16384
  s_add_u32 m0, s67, 32768
  v_mfma_f32_16x16x32_bf16 v[162:165], v[182:185], a[76:79], v[162:165]
  ds_read_b64_tr_b16 a[66:67], v194 offset:17408
  buffer_load_dwordx4 v84, s[24:27], s65 offen offset:0 lds
  v_mfma_f32_16x16x32_bf16 v[94:97], a[32:35], a[72:75], v[94:97]
  ds_read_b64_tr_b16 a[68:69], v195 offset:16384
  v_mfma_f32_16x16x32_bf16 v[98:101], a[32:35], a[76:79], v[98:101]
  ds_read_b64_tr_b16 a[70:71], v195 offset:17408
  v_mfma_f32_16x16x32_bf16 v[102:105], a[36:39], a[72:75], v[102:105]
  ds_read_b128 a[0:3], v186 offset:0
  buffer_load_dwordx4 v85, s[24:27], s65 offen offset:1024 lds
  v_mfma_f32_16x16x32_bf16 v[106:109], a[36:39], a[76:79], v[106:109]
  ds_read_b128 a[4:7], v186 offset:2048
  v_mfma_f32_16x16x32_bf16 v[166:169], v[182:185], a[32:35], v[166:169]
  ds_read_b128 a[8:11], v187 offset:0
  buffer_load_dwordx4 v86, s[24:27], s65 offen offset:2048 lds
  v_mfma_f32_16x16x32_bf16 v[174:177], a[32:35], a[32:35], v[174:177]
  ds_read_b128 a[12:15], v187 offset:2048
  v_mfma_f32_16x16x32_bf16 v[170:173], v[182:185], a[36:39], v[170:173]
  ds_read_b128 a[16:19], v188 offset:0
  v_mfma_f32_16x16x32_bf16 v[178:181], a[36:39], a[36:39], v[178:181]
  ds_read_b128 a[20:23], v188 offset:2048
  buffer_load_dwordx4 v87, s[24:27], s65 offen offset:3072 lds
  v_mfma_f32_16x16x32_bf16 v[110:113], a[40:43], a[72:75], v[110:113]
  ds_read_b128 a[24:27], v189 offset:0
  v_mfma_f32_16x16x32_bf16 v[114:117], a[40:43], a[76:79], v[114:117]
  ds_read_b128 a[28:31], v189 offset:2048
  s_add_u32 m0, s67, 49152
  v_mfma_f32_16x16x32_bf16 v[118:121], a[44:47], a[72:75], v[118:121]
  buffer_load_dwordx4 v88, s[28:31], s66 offen offset:0 lds
  v_mfma_f32_16x16x32_bf16 v[122:125], a[44:47], a[76:79], v[122:125]
  v_mfma_f32_16x16x32_bf16 v[126:129], a[48:51], a[72:75], v[126:129]
  v_mfma_f32_16x16x32_bf16 v[130:133], a[48:51], a[76:79], v[130:133]
  buffer_load_dwordx4 v89, s[28:31], s66 offen offset:1024 lds
  v_mfma_f32_16x16x32_bf16 v[134:137], a[52:55], a[72:75], v[134:137]
  v_mfma_f32_16x16x32_bf16 v[138:141], a[52:55], a[76:79], v[138:141]
  buffer_load_dwordx4 v90, s[28:31], s66 offen offset:2048 lds
  v_mfma_f32_16x16x32_bf16 v[142:145], a[56:59], a[72:75], v[142:145]
  v_mfma_f32_16x16x32_bf16 v[146:149], a[56:59], a[76:79], v[146:149]
  v_mfma_f32_16x16x32_bf16 v[150:153], a[60:63], a[72:75], v[150:153]
  buffer_load_dwordx4 v91, s[28:31], s66 offen offset:3072 lds
  v_mfma_f32_16x16x32_bf16 v[154:157], a[60:63], a[76:79], v[154:157]
  s_waitcnt lgkmcnt(0)
  v_mfma_f32_16x16x32_bf16 v[158:161], v[182:185], a[64:67], v[158:161]
  ds_read_b64_tr_b16 a[72:73], v194 offset:24576
  s_add_u32 m0, s23, 73728
  v_mfma_f32_16x16x32_bf16 v[162:165], v[182:185], a[68:71], v[162:165]
  ds_read_b64_tr_b16 a[74:75], v194 offset:25600
  buffer_load_dwordx4 v15, s[40:43], s17 offen offset:0 lds
  v_mfma_f32_16x16x32_bf16 v[94:97], a[0:3], a[64:67], v[94:97]
  ds_read_b64_tr_b16 a[76:77], v195 offset:24576
  v_mfma_f32_16x16x32_bf16 v[98:101], a[0:3], a[68:71], v[98:101]
  ds_read_b64_tr_b16 a[78:79], v195 offset:25600
  v_mfma_f32_16x16x32_bf16 v[102:105], a[4:7], a[64:67], v[102:105]
  ds_read_b128 a[32:35], v190 offset:0
  buffer_load_dwordx4 v16, s[40:43], s17 offen offset:1024 lds
  v_mfma_f32_16x16x32_bf16 v[106:109], a[4:7], a[68:71], v[106:109]
  ds_read_b128 a[36:39], v190 offset:2048
  v_mfma_f32_16x16x32_bf16 v[166:169], v[182:185], a[0:3], v[166:169]
  ds_read_b128 a[40:43], v191 offset:0
  buffer_load_dwordx4 v17, s[40:43], s17 offen offset:2048 lds
  v_mfma_f32_16x16x32_bf16 v[174:177], a[0:3], a[0:3], v[174:177]
  ds_read_b128 a[44:47], v191 offset:2048
  v_mfma_f32_16x16x32_bf16 v[170:173], v[182:185], a[4:7], v[170:173]
  ds_read_b128 a[48:51], v192 offset:0
  s_add_u32 m0, s23, 86016
  v_mfma_f32_16x16x32_bf16 v[178:181], a[4:7], a[4:7], v[178:181]
  ds_read_b128 a[52:55], v192 offset:2048
  buffer_load_dwordx4 v15, s[44:47], s17 offen offset:0 lds
  v_mfma_f32_16x16x32_bf16 v[110:113], a[8:11], a[64:67], v[110:113]
  ds_read_b128 a[56:59], v193 offset:0
  v_mfma_f32_16x16x32_bf16 v[114:117], a[8:11], a[68:71], v[114:117]
  ds_read_b128 a[60:63], v193 offset:2048
  v_mfma_f32_16x16x32_bf16 v[118:121], a[12:15], a[64:67], v[118:121]
  buffer_load_dwordx4 v16, s[44:47], s17 offen offset:1024 lds
  v_mfma_f32_16x16x32_bf16 v[122:125], a[12:15], a[68:71], v[122:125]
  v_mfma_f32_16x16x32_bf16 v[126:129], a[16:19], a[64:67], v[126:129]
  v_mfma_f32_16x16x32_bf16 v[130:133], a[16:19], a[68:71], v[130:133]
  buffer_load_dwordx4 v17, s[44:47], s17 offen offset:2048 lds
  s_cmp_eq_u32 s22, 9
  s_cselect_b32 s99, 0xffe20000, 0
  s_add_u32 s17, s17, 196608
  s_add_u32 s17, s17, s99
  v_mfma_f32_16x16x32_bf16 v[134:137], a[20:23], a[64:67], v[134:137]
  s_add_u32 m0, s83, 131072
  v_mfma_f32_16x16x32_bf16 v[138:141], a[20:23], a[68:71], v[138:141]
  buffer_load_dwordx4 v234, s[76:79], s80 offen lds
  s_add_u32 s80, s80, 5120
  v_mfma_f32_16x16x32_bf16 v[142:145], a[24:27], a[64:67], v[142:145]
  v_mfma_f32_16x16x32_bf16 v[146:149], a[24:27], a[68:71], v[146:149]
  s_add_u32 m0, s83, 132096
  v_mfma_f32_16x16x32_bf16 v[150:153], a[28:31], a[64:67], v[150:153]
  buffer_load_dwordx4 v234, s[76:79], s80 offen lds
  v_mfma_f32_16x16x32_bf16 v[154:157], a[28:31], a[68:71], v[154:157]
  s_waitcnt vmcnt(24)
  s_waitcnt lgkmcnt(0)
  s_barrier
  v_mfma_f32_16x16x32_bf16 v[158:161], v[182:185], a[72:75], v[158:161]
  ds_read_b64_tr_b16 a[64:65], v194 offset:49152
  v_mfma_f32_16x16x32_bf16 v[162:165], v[182:185], a[76:79], v[162:165]
  ds_read_b64_tr_b16 a[66:67], v194 offset:50176
  v_mfma_f32_16x16x32_bf16 v[94:97], a[32:35], a[72:75], v[94:97]
  ds_read_b64_tr_b16 a[68:69], v195 offset:49152
  v_mfma_f32_16x16x32_bf16 v[98:101], a[32:35], a[76:79], v[98:101]
  ds_read_b64_tr_b16 a[70:71], v195 offset:50176
  v_mfma_f32_16x16x32_bf16 v[102:105], a[36:39], a[72:75], v[102:105]
  ds_read_b128 a[0:3], v186 offset:32768
  v_mfma_f32_16x16x32_bf16 v[106:109], a[36:39], a[76:79], v[106:109]
  ds_read_b128 a[4:7], v186 offset:34816
  v_mfma_f32_16x16x32_bf16 v[166:169], v[182:185], a[32:35], v[166:169]
  ds_read_b128 a[8:11], v187 offset:32768
  v_mfma_f32_16x16x32_bf16 v[174:177], a[32:35], a[32:35], v[174:177]
  ds_read_b128 a[12:15], v187 offset:34816
  v_mfma_f32_16x16x32_bf16 v[170:173], v[182:185], a[36:39], v[170:173]
  ds_read_b128 a[16:19], v188 offset:32768
  v_mfma_f32_16x16x32_bf16 v[178:181], a[36:39], a[36:39], v[178:181]
  ds_read_b128 a[20:23], v188 offset:34816
  v_mfma_f32_16x16x32_bf16 v[110:113], a[40:43], a[72:75], v[110:113]
  ds_read_b128 a[24:27], v189 offset:32768
  v_mfma_f32_16x16x32_bf16 v[114:117], a[40:43], a[76:79], v[114:117]
  ds_read_b128 a[28:31], v189 offset:34816
  v_mfma_f32_16x16x32_bf16 v[118:121], a[44:47], a[72:75], v[118:121]
  v_mfma_f32_16x16x32_bf16 v[122:125], a[44:47], a[76:79], v[122:125]
  v_mfma_f32_16x16x32_bf16 v[126:129], a[48:51], a[72:75], v[126:129]
  v_mfma_f32_16x16x32_bf16 v[130:133], a[48:51], a[76:79], v[130:133]
  v_mfma_f32_16x16x32_bf16 v[134:137], a[52:55], a[72:75], v[134:137]
  v_mfma_f32_16x16x32_bf16 v[138:141], a[52:55], a[76:79], v[138:141]
  v_mfma_f32_16x16x32_bf16 v[142:145], a[56:59], a[72:75], v[142:145]
  v_mfma_f32_16x16x32_bf16 v[146:149], a[56:59], a[76:79], v[146:149]
  v_mfma_f32_16x16x32_bf16 v[150:153], a[60:63], a[72:75], v[150:153]
  v_mfma_f32_16x16x32_bf16 v[154:157], a[60:63], a[76:79], v[154:157]
  s_waitcnt lgkmcnt(0)
  v_mfma_f32_16x16x32_bf16 v[158:161], v[182:185], a[64:67], v[158:161]
  ds_read_b64_tr_b16 a[72:73], v194 offset:57344
  v_mfma_f32_16x16x32_bf16 v[162:165], v[182:185], a[68:71], v[162:165]
  ds_read_b64_tr_b16 a[74:75], v194 offset:58368
  v_mfma_f32_16x16x32_bf16 v[94:97], a[0:3], a[64:67], v[94:97]
  ds_read_b64_tr_b16 a[76:77], v195 offset:57344
  v_mfma_f32_16x16x32_bf16 v[98:101], a[0:3], a[68:71], v[98:101]
  ds_read_b64_tr_b16 a[78:79], v195 offset:58368
  v_mfma_f32_16x16x32_bf16 v[102:105], a[4:7], a[64:67], v[102:105]
  ds_read_b128 a[32:35], v190 offset:32768
  v_mfma_f32_16x16x32_bf16 v[106:109], a[4:7], a[68:71], v[106:109]
  ds_read_b128 a[36:39], v190 offset:34816
  v_mfma_f32_16x16x32_bf16 v[166:169], v[182:185], a[0:3], v[166:169]
  ds_read_b128 a[40:43], v191 offset:32768
  v_mfma_f32_16x16x32_bf16 v[174:177], a[0:3], a[0:3], v[174:177]
  ds_read_b128 a[44:47], v191 offset:34816
  v_mfma_f32_16x16x32_bf16 v[170:173], v[182:185], a[4:7], v[170:173]
  ds_read_b128 a[48:51], v192 offset:32768
  v_mfma_f32_16x16x32_bf16 v[178:181], a[4:7], a[4:7], v[178:181]
  ds_read_b128 a[52:55], v192 offset:34816
  v_mfma_f32_16x16x32_bf16 v[110:113], a[8:11], a[64:67], v[110:113]
  ds_read_b128 a[56:59], v193 offset:32768
  v_mfma_f32_16x16x32_bf16 v[114:117], a[8:11], a[68:71], v[114:117]
  ds_read_b128 a[60:63], v193 offset:34816
  v_mfma_f32_16x16x32_bf16 v[118:121], a[12:15], a[64:67], v[118:121]
  v_xor_b32 v186, 0x10000, v186
  v_mfma_f32_16x16x32_bf16 v[122:125], a[12:15], a[68:71], v[122:125]
  v_xor_b32 v187, 0x10000, v187
  v_mfma_f32_16x16x32_bf16 v[126:129], a[16:19], a[64:67], v[126:129]
  v_xor_b32 v188, 0x10000, v188
  v_mfma_f32_16x16x32_bf16 v[130:133], a[16:19], a[68:71], v[130:133]
  v_xor_b32 v189, 0x10000, v189
  v_mfma_f32_16x16x32_bf16 v[134:137], a[20:23], a[64:67], v[134:137]
  v_xor_b32 v190, 0x10000, v190
  v_mfma_f32_16x16x32_bf16 v[138:141], a[20:23], a[68:71], v[138:141]
  v_xor_b32 v191, 0x10000, v191
  v_mfma_f32_16x16x32_bf16 v[142:145], a[24:27], a[64:67], v[142:145]
  v_xor_b32 v192, 0x10000, v192
  v_mfma_f32_16x16x32_bf16 v[146:149], a[24:27], a[68:71], v[146:149]
  v_xor_b32 v193, 0x10000, v193
  v_mfma_f32_16x16x32_bf16 v[150:153], a[28:31], a[64:67], v[150:153]
  v_xor_b32 v194, 0x10000, v194
  v_mfma_f32_16x16x32_bf16 v[154:157], a[28:31], a[68:71], v[154:157]
  v_xor_b32 v195, 0x10000, v195
  s_waitcnt vmcnt(16)
  s_waitcnt lgkmcnt(0)
  s_barrier
  v_mfma_f32_16x16x32_bf16 v[158:161], v[182:185], a[72:75], v[158:161]
  ds_read_b64_tr_b16 a[64:65], v194 offset:16384
  v_mfma_f32_16x16x32_bf16 v[162:165], v[182:185], a[76:79], v[162:165]
  ds_read_b64_tr_b16 a[66:67], v194 offset:17408
  v_mfma_f32_16x16x32_bf16 v[94:97], a[32:35], a[72:75], v[94:97]
  ds_read_b64_tr_b16 a[68:69], v195 offset:16384
  v_mfma_f32_16x16x32_bf16 v[98:101], a[32:35], a[76:79], v[98:101]
  ds_read_b64_tr_b16 a[70:71], v195 offset:17408
  v_mfma_f32_16x16x32_bf16 v[102:105], a[36:39], a[72:75], v[102:105]
  ds_read_b128 a[0:3], v186 offset:0
  v_mfma_f32_16x16x32_bf16 v[106:109], a[36:39], a[76:79], v[106:109]
  ds_read_b128 a[4:7], v186 offset:2048
  v_mfma_f32_16x16x32_bf16 v[166:169], v[182:185], a[32:35], v[166:169]
  ds_read_b128 a[8:11], v187 offset:0
  v_mfma_f32_16x16x32_bf16 v[174:177], a[32:35], a[32:35], v[174:177]
  ds_read_b128 a[12:15], v187 offset:2048
  v_mfma_f32_16x16x32_bf16 v[170:173], v[182:185], a[36:39], v[170:173]
  ds_read_b128 a[16:19], v188 offset:0
  v_mfma_f32_16x16x32_bf16 v[178:181], a[36:39], a[36:39], v[178:181]
  ds_read_b128 a[20:23], v188 offset:2048
  v_mfma_f32_16x16x32_bf16 v[110:113], a[40:43], a[72:75], v[110:113]
  ds_read_b128 a[24:27], v189 offset:0
  v_mfma_f32_16x16x32_bf16 v[114:117], a[40:43], a[76:79], v[114:117]
  ds_read_b128 a[28:31], v189 offset:2048
  v_mfma_f32_16x16x32_bf16 v[118:121], a[44:47], a[72:75], v[118:121]
  v_mfma_f32_16x16x32_bf16 v[122:125], a[44:47], a[76:79], v[122:125]
  v_mfma_f32_16x16x32_bf16 v[126:129], a[48:51], a[72:75], v[126:129]
  v_mfma_f32_16x16x32_bf16 v[130:133], a[48:51], a[76:79], v[130:133]
  v_mfma_f32_16x16x32_bf16 v[134:137], a[52:55], a[72:75], v[134:137]
  v_mfma_f32_16x16x32_bf16 v[138:141], a[52:55], a[76:79], v[138:141]
  v_mfma_f32_16x16x32_bf16 v[142:145], a[56:59], a[72:75], v[142:145]
  v_mfma_f32_16x16x32_bf16 v[146:149], a[56:59], a[76:79], v[146:149]
  v_mfma_f32_16x16x32_bf16 v[150:153], a[60:63], a[72:75], v[150:153]
  v_mfma_f32_16x16x32_bf16 v[154:157], a[60:63], a[76:79], v[154:157]
  s_waitcnt lgkmcnt(0)
  v_mfma_f32_16x16x32_bf16 v[158:161], v[182:185], a[64:67], v[158:161]
  ds_read_b64_tr_b16 a[72:73], v194 offset:24576
  v_mfma_f32_16x16x32_bf16 v[162:165], v[182:185], a[68:71], v[162:165]
  ds_read_b64_tr_b16 a[74:75], v194 offset:25600
  v_mfma_f32_16x16x32_bf16 v[94:97], a[0:3], a[64:67], v[94:97]
  ds_read_b64_tr_b16 a[76:77], v195 offset:24576
  v_mfma_f32_16x16x32_bf16 v[98:101], a[0:3], a[68:71], v[98:101]
  ds_read_b64_tr_b16 a[78:79], v195 offset:25600
  v_mfma_f32_16x16x32_bf16 v[102:105], a[4:7], a[64:67], v[102:105]
  ds_read_b128 a[32:35], v190 offset:0
  v_mfma_f32_16x16x32_bf16 v[106:109], a[4:7], a[68:71], v[106:109]
  ds_read_b128 a[36:39], v190 offset:2048
  v_mfma_f32_16x16x32_bf16 v[166:169], v[182:185], a[0:3], v[166:169]
  ds_read_b128 a[40:43], v191 offset:0
  v_mfma_f32_16x16x32_bf16 v[174:177], a[0:3], a[0:3], v[174:177]
  ds_read_b128 a[44:47], v191 offset:2048
  v_mfma_f32_16x16x32_bf16 v[170:173], v[182:185], a[4:7], v[170:173]
  ds_read_b128 a[48:51], v192 offset:0
  v_mfma_f32_16x16x32_bf16 v[178:181], a[4:7], a[4:7], v[178:181]
  ds_read_b128 a[52:55], v192 offset:2048
  v_mfma_f32_16x16x32_bf16 v[110:113], a[8:11], a[64:67], v[110:113]
  ds_read_b128 a[56:59], v193 offset:0
  v_mfma_f32_16x16x32_bf16 v[114:117], a[8:11], a[68:71], v[114:117]
  ds_read_b128 a[60:63], v193 offset:2048
  v_mfma_f32_16x16x32_bf16 v[118:121], a[12:15], a[64:67], v[118:121]
  v_mfma_f32_16x16x32_bf16 v[122:125], a[12:15], a[68:71], v[122:125]
  v_mfma_f32_16x16x32_bf16 v[126:129], a[16:19], a[64:67], v[126:129]
  v_mfma_f32_16x16x32_bf16 v[130:133], a[16:19], a[68:71], v[130:133]
  v_mfma_f32_16x16x32_bf16 v[134:137], a[20:23], a[64:67], v[134:137]
  v_mfma_f32_16x16x32_bf16 v[138:141], a[20:23], a[68:71], v[138:141]
  v_mfma_f32_16x16x32_bf16 v[142:145], a[24:27], a[64:67], v[142:145]
  v_mfma_f32_16x16x32_bf16 v[146:149], a[24:27], a[68:71], v[146:149]
  v_mfma_f32_16x16x32_bf16 v[150:153], a[28:31], a[64:67], v[150:153]
  v_mfma_f32_16x16x32_bf16 v[154:157], a[28:31], a[68:71], v[154:157]
  s_waitcnt vmcnt(8)
  s_waitcnt lgkmcnt(0)
  s_barrier
  v_mfma_f32_16x16x32_bf16 v[158:161], v[182:185], a[72:75], v[158:161]
  ds_read_b64_tr_b16 a[64:65], v194 offset:49152
  v_mfma_f32_16x16x32_bf16 v[162:165], v[182:185], a[76:79], v[162:165]
  ds_read_b64_tr_b16 a[66:67], v194 offset:50176
  v_mfma_f32_16x16x32_bf16 v[94:97], a[32:35], a[72:75], v[94:97]
  ds_read_b64_tr_b16 a[68:69], v195 offset:49152
  v_mfma_f32_16x16x32_bf16 v[98:101], a[32:35], a[76:79], v[98:101]
  ds_read_b64_tr_b16 a[70:71], v195 offset:50176
  v_mfma_f32_16x16x32_bf16 v[102:105], a[36:39], a[72:75], v[102:105]
  ds_read_b128 a[0:3], v186 offset:32768
  v_mfma_f32_16x16x32_bf16 v[106:109], a[36:39], a[76:79], v[106:109]
  ds_read_b128 a[4:7], v186 offset:34816
  v_mfma_f32_16x16x32_bf16 v[166:169], v[182:185], a[32:35], v[166:169]
  ds_read_b128 a[8:11], v187 offset:32768
  v_mfma_f32_16x16x32_bf16 v[174:177], a[32:35], a[32:35], v[174:177]
  ds_read_b128 a[12:15], v187 offset:34816
  v_mfma_f32_16x16x32_bf16 v[170:173], v[182:185], a[36:39], v[170:173]
  ds_read_b128 a[16:19], v188 offset:32768
  v_mfma_f32_16x16x32_bf16 v[178:181], a[36:39], a[36:39], v[178:181]
  ds_read_b128 a[20:23], v188 offset:34816
  v_mfma_f32_16x16x32_bf16 v[110:113], a[40:43], a[72:75], v[110:113]
  ds_read_b128 a[24:27], v189 offset:32768
  v_mfma_f32_16x16x32_bf16 v[114:117], a[40:43], a[76:79], v[114:117]
  ds_read_b128 a[28:31], v189 offset:34816
  v_mfma_f32_16x16x32_bf16 v[118:121], a[44:47], a[72:75], v[118:121]
  v_mfma_f32_16x16x32_bf16 v[122:125], a[44:47], a[76:79], v[122:125]
  v_mfma_f32_16x16x32_bf16 v[126:129], a[48:51], a[72:75], v[126:129]
  v_mfma_f32_16x16x32_bf16 v[130:133], a[48:51], a[76:79], v[130:133]
  v_mfma_f32_16x16x32_bf16 v[134:137], a[52:55], a[72:75], v[134:137]
  v_mfma_f32_16x16x32_bf16 v[138:141], a[52:55], a[76:79], v[138:141]
  v_mfma_f32_16x16x32_bf16 v[142:145], a[56:59], a[72:75], v[142:145]
  v_mfma_f32_16x16x32_bf16 v[146:149], a[56:59], a[76:79], v[146:149]
  v_mfma_f32_16x16x32_bf16 v[150:153], a[60:63], a[72:75], v[150:153]
  v_mfma_f32_16x16x32_bf16 v[154:157], a[60:63], a[76:79], v[154:157]
  s_waitcnt lgkmcnt(0)
  v_mfma_f32_16x16x32_bf16 v[158:161], v[182:185], a[64:67], v[158:161]
  ds_read_b64_tr_b16 a[72:73], v194 offset:57344
  v_mfma_f32_16x16x32_bf16 v[162:165], v[182:185], a[68:71], v[162:165]
  ds_read_b64_tr_b16 a[74:75], v194 offset:58368
  v_mfma_f32_16x16x32_bf16 v[94:97], a[0:3], a[64:67], v[94:97]
  ds_read_b64_tr_b16 a[76:77], v195 offset:57344
  v_mfma_f32_16x16x32_bf16 v[98:101], a[0:3], a[68:71], v[98:101]
  ds_read_b64_tr_b16 a[78:79], v195 offset:58368
  v_mfma_f32_16x16x32_bf16 v[102:105], a[4:7], a[64:67], v[102:105]
  ds_read_b128 a[32:35], v190 offset:32768
  v_mfma_f32_16x16x32_bf16 v[106:109], a[4:7], a[68:71], v[106:109]
  ds_read_b128 a[36:39], v190 offset:34816
  v_mfma_f32_16x16x32_bf16 v[166:169], v[182:185], a[0:3], v[166:169]
  ds_read_b128 a[40:43], v191 offset:32768
  v_mfma_f32_16x16x32_bf16 v[174:177], a[0:3], a[0:3], v[174:177]
  ds_read_b128 a[44:47], v191 offset:34816
  v_mfma_f32_16x16x32_bf16 v[170:173], v[182:185], a[4:7], v[170:173]
  ds_read_b128 a[48:51], v192 offset:32768
  v_mfma_f32_16x16x32_bf16 v[178:181], a[4:7], a[4:7], v[178:181]
  ds_read_b128 a[52:55], v192 offset:34816
  v_mfma_f32_16x16x32_bf16 v[110:113], a[8:11], a[64:67], v[110:113]
  ds_read_b128 a[56:59], v193 offset:32768
  v_mfma_f32_16x16x32_bf16 v[114:117], a[8:11], a[68:71], v[114:117]
  ds_read_b128 a[60:63], v193 offset:34816
  v_mfma_f32_16x16x32_bf16 v[118:121], a[12:15], a[64:67], v[118:121]
  v_mfma_f32_16x16x32_bf16 v[122:125], a[12:15], a[68:71], v[122:125]
  v_mfma_f32_16x16x32_bf16 v[126:129], a[16:19], a[64:67], v[126:129]
  v_mfma_f32_16x16x32_bf16 v[130:133], a[16:19], a[68:71], v[130:133]
  v_mfma_f32_16x16x32_bf16 v[134:137], a[20:23], a[64:67], v[134:137]
  v_mfma_f32_16x16x32_bf16 v[138:141], a[20:23], a[68:71], v[138:141]
  v_mfma_f32_16x16x32_bf16 v[142:145], a[24:27], a[64:67], v[142:145]
  v_mfma_f32_16x16x32_bf16 v[146:149], a[24:27], a[68:71], v[146:149]
  v_mfma_f32_16x16x32_bf16 v[150:153], a[28:31], a[64:67], v[150:153]
  v_mfma_f32_16x16x32_bf16 v[154:157], a[28:31], a[68:71], v[154:157]
  s_waitcnt lgkmcnt(7)
  v_mfma_f32_16x16x32_bf16 v[166:169], v[182:185], a[32:35], v[166:169]
  v_mfma_f32_16x16x32_bf16 v[174:177], a[32:35], a[32:35], v[174:177]
  s_waitcnt lgkmcnt(6)
  v_mfma_f32_16x16x32_bf16 v[170:173], v[182:185], a[36:39], v[170:173]
  v_mfma_f32_16x16x32_bf16 v[178:181], a[36:39], a[36:39], v[178:181]
  v_mfma_f32_16x16x32_bf16 v[158:161], v[182:185], a[72:75], v[158:161]
  v_mfma_f32_16x16x32_bf16 v[162:165], v[182:185], a[76:79], v[162:165]
  s_nop 2
  v_cndmask_b32 v174, v174, v175, s[88:89]
  v_cndmask_b32 v174, v174, v176, s[90:91]
  v_cndmask_b32 v174, v174, v177, s[92:93]
  v_mfma_f32_16x16x32_bf16 v[94:97], a[32:35], a[72:75], v[94:97]
  v_cndmask_b32 v178, v178, v179, s[88:89]
  v_cndmask_b32 v178, v178, v180, s[90:91]
  v_cndmask_b32 v178, v178, v181, s[92:93]
  v_mfma_f32_16x16x32_bf16 v[98:101], a[32:35], a[76:79], v[98:101]
  v_mul_f32 v166, 0xbacccccd, v166
  v_mul_f32 v170, 0xbacccccd, v170
  v_mul_f32 v174, 0x3acccccd, v174
  v_mfma_f32_16x16x32_bf16 v[102:105], a[36:39], a[72:75], v[102:105]
  v_mul_f32 v178, 0x3acccccd, v178
  v_fma_f32 v174, -v166, v166, v174
  v_fma_f32 v178, -v170, v170, v178
  v_mfma_f32_16x16x32_bf16 v[106:109], a[36:39], a[76:79], v[106:109]
  v_add_f32 v174, 0x3727c5ac, v174
  v_add_f32 v178, 0x3727c5ac, v178
  v_rsq_f32 v174, v174
  s_waitcnt lgkmcnt(5)
  v_mfma_f32_16x16x32_bf16 v[110:113], a[40:43], a[72:75], v[110:113]
  v_rsq_f32 v178, v178
  v_mul_f32 v174, s94, v174
  v_mul_f32 v178, s94, v178
  v_mfma_f32_16x16x32_bf16 v[114:117], a[40:43], a[76:79], v[114:117]
  ds_write2_b32 v93, v166, v174 offset0:0 offset1:128
  ds_write2_b32 v93, v170, v178 offset0:16 offset1:144
  s_waitcnt lgkmcnt(6)
  v_mfma_f32_16x16x32_bf16 v[118:121], a[44:47], a[72:75], v[118:121]
  v_mfma_f32_16x16x32_bf16 v[122:125], a[44:47], a[76:79], v[122:125]
  s_waitcnt lgkmcnt(0)
  s_barrier
  ds_read_b128 v[20:23], v196 offset:0
  ds_read_b128 v[24:27], v196 offset:512
  ds_read_b128 v[28:31], v196 offset:64
  v_mfma_f32_16x16x32_bf16 v[126:129], a[48:51], a[72:75], v[126:129]
  ds_read_b128 v[32:35], v196 offset:576
  ds_read_b128 v[36:39], v197 offset:0
  ds_read_b128 v[40:43], v197 offset:512
  v_mfma_f32_16x16x32_bf16 v[130:133], a[48:51], a[76:79], v[130:133]
  ds_read_b128 v[44:47], v197 offset:64
  ds_read_b128 v[48:51], v197 offset:576
  ds_read_b128 v[52:55], v198 offset:0
  v_mfma_f32_16x16x32_bf16 v[134:137], a[52:55], a[72:75], v[134:137]
  ds_read_b128 v[56:59], v198 offset:512
  ds_read_b128 v[60:63], v198 offset:64
  ds_read_b128 v[64:67], v198 offset:576
  v_mfma_f32_16x16x32_bf16 v[138:141], a[52:55], a[76:79], v[138:141]
  ds_read_b128 v[68:71], v199 offset:0
  ds_read_b128 v[72:75], v199 offset:512
  ds_read_b128 v[76:79], v199 offset:64
  v_mfma_f32_16x16x32_bf16 v[142:145], a[56:59], a[72:75], v[142:145]
  ds_read_b128 v[80:83], v199 offset:576
  v_mfma_f32_16x16x32_bf16 v[146:149], a[56:59], a[76:79], v[146:149]
  v_mfma_f32_16x16x32_bf16 v[150:153], a[60:63], a[72:75], v[150:153]
  v_mfma_f32_16x16x32_bf16 v[154:157], a[60:63], a[76:79], v[154:157]
  s_waitcnt lgkmcnt(15)
  v_pk_fma_f32 v[94:95], v[158:159], v[20:21], v[94:95]
  v_pk_fma_f32 v[96:97], v[158:159], v[22:23], v[96:97]
  s_waitcnt lgkmcnt(13)
  v_pk_fma_f32 v[102:103], v[158:159], v[28:29], v[102:103]
  v_pk_fma_f32 v[104:105], v[158:159], v[30:31], v[104:105]
  v_pk_mul_f32 v[94:95], v[94:95], v[24:25]
  v_pk_mul_f32 v[96:97], v[96:97], v[26:27]
  s_waitcnt lgkmcnt(12)
  v_pk_mul_f32 v[102:103], v[102:103], v[32:33]
  v_pk_mul_f32 v[104:105], v[104:105], v[34:35]
  v_cvt_pk_bf16_f32 v202, v94, v95
  v_cvt_pk_bf16_f32 v203, v96, v97
  v_cvt_pk_bf16_f32 v204, v102, v103
  v_cvt_pk_bf16_f32 v205, v104, v105
  buffer_store_dwordx4 v[202:205], v200, s[32:35], s4 offen sc1
  v_pk_fma_f32 v[98:99], v[162:163], v[20:21], v[98:99]
  v_pk_fma_f32 v[100:101], v[162:163], v[22:23], v[100:101]
  v_pk_fma_f32 v[106:107], v[162:163], v[28:29], v[106:107]
  v_pk_fma_f32 v[108:109], v[162:163], v[30:31], v[108:109]
  v_pk_mul_f32 v[98:99], v[98:99], v[24:25]
  v_pk_mul_f32 v[100:101], v[100:101], v[26:27]
  v_pk_mul_f32 v[106:107], v[106:107], v[32:33]
  v_pk_mul_f32 v[108:109], v[108:109], v[34:35]
  v_cvt_pk_bf16_f32 v206, v98, v99
  v_cvt_pk_bf16_f32 v207, v100, v101
  v_cvt_pk_bf16_f32 v208, v106, v107
  v_cvt_pk_bf16_f32 v209, v108, v109
  buffer_store_dwordx4 v[206:209], v201, s[32:35], s4 offen sc1
  s_waitcnt lgkmcnt(11)
  v_pk_fma_f32 v[110:111], v[158:159], v[36:37], v[110:111]
  v_pk_fma_f32 v[112:113], v[158:159], v[38:39], v[112:113]
  s_waitcnt lgkmcnt(9)
  v_pk_fma_f32 v[118:119], v[158:159], v[44:45], v[118:119]
  v_pk_fma_f32 v[120:121], v[158:159], v[46:47], v[120:121]
  v_pk_mul_f32 v[110:111], v[110:111], v[40:41]
  v_pk_mul_f32 v[112:113], v[112:113], v[42:43]
  s_waitcnt lgkmcnt(8)
  v_pk_mul_f32 v[118:119], v[118:119], v[48:49]
  v_pk_mul_f32 v[120:121], v[120:121], v[50:51]
  v_cvt_pk_bf16_f32 v210, v110, v111
  v_cvt_pk_bf16_f32 v211, v112, v113
  v_cvt_pk_bf16_f32 v212, v118, v119
  v_cvt_pk_bf16_f32 v213, v120, v121
  buffer_store_dwordx4 v[210:213], v200, s[32:35], s5 offen sc1
  v_pk_fma_f32 v[114:115], v[162:163], v[36:37], v[114:115]
  v_pk_fma_f32 v[116:117], v[162:163], v[38:39], v[116:117]
  v_pk_fma_f32 v[122:123], v[162:163], v[44:45], v[122:123]
  v_pk_fma_f32 v[124:125], v[162:163], v[46:47], v[124:125]
  v_pk_mul_f32 v[114:115], v[114:115], v[40:41]
  v_pk_mul_f32 v[116:117], v[116:117], v[42:43]
  v_pk_mul_f32 v[122:123], v[122:123], v[48:49]
  v_pk_mul_f32 v[124:125], v[124:125], v[50:51]
  v_cvt_pk_bf16_f32 v214, v114, v115
  v_cvt_pk_bf16_f32 v215, v116, v117
  v_cvt_pk_bf16_f32 v216, v122, v123
  v_cvt_pk_bf16_f32 v217, v124, v125
  buffer_store_dwordx4 v[214:217], v201, s[32:35], s5 offen sc1
  s_waitcnt lgkmcnt(7)
  v_pk_fma_f32 v[126:127], v[158:159], v[52:53], v[126:127]
  v_pk_fma_f32 v[128:129], v[158:159], v[54:55], v[128:129]
  s_waitcnt lgkmcnt(5)
  v_pk_fma_f32 v[134:135], v[158:159], v[60:61], v[134:135]
  v_pk_fma_f32 v[136:137], v[158:159], v[62:63], v[136:137]
  v_pk_mul_f32 v[126:127], v[126:127], v[56:57]
  v_pk_mul_f32 v[128:129], v[128:129], v[58:59]
  s_waitcnt lgkmcnt(4)
  v_pk_mul_f32 v[134:135], v[134:135], v[64:65]
  v_pk_mul_f32 v[136:137], v[136:137], v[66:67]
  v_cvt_pk_bf16_f32 v218, v126, v127
  v_cvt_pk_bf16_f32 v219, v128, v129
  v_cvt_pk_bf16_f32 v220, v134, v135
  v_cvt_pk_bf16_f32 v221, v136, v137
  buffer_store_dwordx4 v[218:221], v200, s[32:35], s6 offen sc1
  v_pk_fma_f32 v[130:131], v[162:163], v[52:53], v[130:131]
  v_pk_fma_f32 v[132:133], v[162:163], v[54:55], v[132:133]
  v_pk_fma_f32 v[138:139], v[162:163], v[60:61], v[138:139]
  v_pk_fma_f32 v[140:141], v[162:163], v[62:63], v[140:141]
  v_pk_mul_f32 v[130:131], v[130:131], v[56:57]
  v_pk_mul_f32 v[132:133], v[132:133], v[58:59]
  v_pk_mul_f32 v[138:139], v[138:139], v[64:65]
  v_pk_mul_f32 v[140:141], v[140:141], v[66:67]
  v_cvt_pk_bf16_f32 v222, v130, v131
  v_cvt_pk_bf16_f32 v223, v132, v133
  v_cvt_pk_bf16_f32 v224, v138, v139
  v_cvt_pk_bf16_f32 v225, v140, v141
  buffer_store_dwordx4 v[222:225], v201, s[32:35], s6 offen sc1
  s_waitcnt lgkmcnt(3)
  v_pk_fma_f32 v[142:143], v[158:159], v[68:69], v[142:143]
  v_pk_fma_f32 v[144:145], v[158:159], v[70:71], v[144:145]
  s_waitcnt lgkmcnt(1)
  v_pk_fma_f32 v[150:151], v[158:159], v[76:77], v[150:151]
  v_pk_fma_f32 v[152:153], v[158:159], v[78:79], v[152:153]
  v_pk_mul_f32 v[142:143], v[142:143], v[72:73]
  v_pk_mul_f32 v[144:145], v[144:145], v[74:75]
  s_waitcnt lgkmcnt(0)
  v_pk_mul_f32 v[150:151], v[150:151], v[80:81]
  v_pk_mul_f32 v[152:153], v[152:153], v[82:83]
  v_cvt_pk_bf16_f32 v226, v142, v143
  v_cvt_pk_bf16_f32 v227, v144, v145
  v_cvt_pk_bf16_f32 v228, v150, v151
  v_cvt_pk_bf16_f32 v229, v152, v153
  buffer_store_dwordx4 v[226:229], v200, s[32:35], s7 offen sc1
  v_pk_fma_f32 v[146:147], v[162:163], v[68:69], v[146:147]
  v_pk_fma_f32 v[148:149], v[162:163], v[70:71], v[148:149]
  v_pk_fma_f32 v[154:155], v[162:163], v[76:77], v[154:155]
  v_pk_fma_f32 v[156:157], v[162:163], v[78:79], v[156:157]
  v_pk_mul_f32 v[146:147], v[146:147], v[72:73]
  v_pk_mul_f32 v[148:149], v[148:149], v[74:75]
  v_pk_mul_f32 v[154:155], v[154:155], v[80:81]
  v_pk_mul_f32 v[156:157], v[156:157], v[82:83]
  v_cvt_pk_bf16_f32 v230, v146, v147
  v_cvt_pk_bf16_f32 v231, v148, v149
  v_cvt_pk_bf16_f32 v232, v154, v155
  v_cvt_pk_bf16_f32 v233, v156, v157
  buffer_store_dwordx4 v[230:233], v201, s[32:35], s7 offen sc1
L_p1done:
  v_bfe_u32 v2, v0, 2, 2
  v_lshl_add_u32 v2, v13, 3, v2
  v_lshlrev_b32 v2, 8, v2
  v_and_b32 v3, 3, v0
  v_lshl_add_u32 v2, v3, 3, v2
  s_lshl_b32 s55, s3, 6
  s_add_u32 s55, s55, 131072
  v_add_u32 v2, s55, v2
  s_mov_b32 s52, s81
  s_mov_b32 s53, s82
  s_waitcnt vmcnt(8)
  s_barrier
  ds_read_b64_tr_b16 a[232:233], v2 offset:0
  ds_read_b64_tr_b16 a[234:235], v2 offset:1024
  ds_read_b64_tr_b16 a[236:237], v2 offset:32
  ds_read_b64_tr_b16 a[238:239], v2 offset:1056
  ds_read_b64_tr_b16 a[0:1], v18 offset:24576
  ds_read_b64_tr_b16 a[2:3], v18 offset:25344
  ds_read_b64_tr_b16 a[4:5], v18 offset:36864
  ds_read_b64_tr_b16 a[6:7], v18 offset:37632
  ds_read_b64_tr_b16 a[8:9], v19 offset:24576
  ds_read_b64_tr_b16 a[10:11], v19 offset:25344
  ds_read_b64_tr_b16 a[12:13], v18 offset:30720
  ds_read_b64_tr_b16 a[14:15], v18 offset:31488
  ds_read_b64_tr_b16 a[16:17], v18 offset:43008
  ds_read_b64_tr_b16 a[18:19], v18 offset:43776
  ds_read_b64_tr_b16 a[20:21], v19 offset:30720
  ds_read_b64_tr_b16 a[22:23], v19 offset:31488
  v_add_u32 v18, 0xffff4000, v18
  v_add_u32 v19, 0xffff4000, v19
  s_add_u32 m0, s23, 0
  s_nop 0
  buffer_load_dwordx4 v15, s[40:43], s17 offen offset:0 lds
  buffer_load_dwordx4 v16, s[40:43], s17 offen offset:1024 lds
  buffer_load_dwordx4 v17, s[40:43], s17 offen offset:2048 lds
  s_add_u32 m0, s23, 12288
  s_nop 0
  buffer_load_dwordx4 v15, s[44:47], s17 offen offset:0 lds
  buffer_load_dwordx4 v16, s[44:47], s17 offen offset:1024 lds
  buffer_load_dwordx4 v17, s[44:47], s17 offen offset:2048 lds
  s_cmp_eq_u32 s22, 8
  s_cselect_b32 s99, 0xffe20000, 0
  s_add_u32 s17, s17, 196608
  s_add_u32 s17, s17, s99
  s_add_u32 m0, s23, 24576
  s_and_b32 s4, s3, 1
  s_lshr_b32 s5, s3, 1
  v_and_b32 v21, 31, v0
  v_lshrrev_b32 v22, 5, v0
  v_lshlrev_b32 v2, 2, v22
  v_sub_u32 v2, v21, v2
  v_cmp_le_i32 s[64:65], 0, v2
  v_cmp_le_i32 s[66:67], 1, v2
  v_cmp_le_i32 s[68:69], 2, v2
  v_cmp_le_i32 s[70:71], 3, v2
  v_cmp_le_i32 s[72:73], 16, v2
  v_cmp_le_i32 s[74:75], 17, v2
  v_cmp_le_i32 s[76:77], 18, v2
  v_cmp_le_i32 s[78:79], 19, v2
  v_cmp_le_i32 s[80:81], 8, v2
  v_cmp_le_i32 s[82:83], 9, v2
  v_cmp_le_i32 s[84:85], 10, v2
  v_cmp_le_i32 s[86:87], 11, v2
  v_cmp_le_i32 s[88:89], 24, v2
  v_cmp_le_i32 s[90:91], 25, v2
  v_cmp_le_i32 s[92:93], 26, v2
  v_cmp_le_i32 s[94:95], 27, v2
  v_mov_b32 v3, 0xffff
  v_mov_b32 v4, 0xffff0000
  v_cndmask_b32 v24, 0, v3, s[64:65]
  v_cndmask_b32 v5, 0, v4, s[66:67]
  v_or_b32 v24, v24, v5
  v_cndmask_b32 v25, 0, v3, s[68:69]
  v_cndmask_b32 v5, 0, v4, s[70:71]
  v_or_b32 v25, v25, v5
  v_cndmask_b32 v26, 0, v3, s[72:73]
  v_cndmask_b32 v5, 0, v4, s[74:75]
  v_or_b32 v26, v26, v5
  v_cndmask_b32 v27, 0, v3, s[76:77]
  v_cndmask_b32 v5, 0, v4, s[78:79]
  v_or_b32 v27, v27, v5
  v_cndmask_b32 v28, 0, v3, s[80:81]
  v_cndmask_b32 v5, 0, v4, s[82:83]
  v_or_b32 v28, v28, v5
  v_cndmask_b32 v29, 0, v3, s[84:85]
  v_cndmask_b32 v5, 0, v4, s[86:87]
  v_or_b32 v29, v29, v5
  v_cndmask_b32 v30, 0, v3, s[88:89]
  v_cndmask_b32 v5, 0, v4, s[90:91]
  v_or_b32 v30, v30, v5
  v_cndmask_b32 v31, 0, v3, s[92:93]
  v_cndmask_b32 v5, 0, v4, s[94:95]
  v_or_b32 v31, v31, v5
  v_and_b32 v2, 7, v0
  v_bfe_u32 v3, v0, 3, 1
  v_lshl_or_b32 v2, v3, 4, v2
  v_bfe_u32 v3, v0, 4, 1
  v_lshl_or_b32 v2, v3, 3, v2
  v_lshlrev_b32 v2, 4, v2
  s_mul_i32 s55, s5, 5152
  s_mul_i32 s56, s4, 1536
  s_add_u32 s56, s56, s55
  v_lshl_add_u32 v23, v22, 9, v2
  v_add_u32 v23, s56, v23
  s_lshl_b32 s56, s4, 3
  s_add_u32 s57, s56, s55
  s_add_u32 s57, s57, 1024
  v_add_u32 v32, s57, v2
  v_lshl_add_u32 v35, v21, 4, s56
  s_mul_i32 s56, s4, 320
  s_add_u32 s55, s55, 30912
  s_add_u32 s56, s56, s55
  v_mul_u32_u24 v2, 640, v22
  v_lshl_add_u32 v2, v21, 4, v2
  v_add_u32 v33, s56, v2
  v_add_u32 v34, 1280, v33
  s_add_u32 s55, s55, 2560
  v_mov_b32 v2, s55
  v_cmp_gt_u32 vcc, 20, v21
  s_nop 1
  v_cndmask_b32 v33, v2, v33, vcc
  v_cndmask_b32 v34, v2, v34, vcc
  v_min_u32 v2, 11, v0
  s_lshl_b32 s55, s50, 2
  v_add_u32 v3, s55, v2
  v_cmp_le_u32 vcc, 8, v3
  v_mov_b32 v4, 0x3f803f80
  v_mul_u32_u24 v2, 2576, v2
  v_cndmask_b32 v36, 0, v4, vcc
  v_cndmask_b32 v37, 0, v4, vcc
  v_cndmask_b32 v38, 0, v4, vcc
  v_cndmask_b32 v39, 0, v4, vcc
  ds_write_b128 v2, v[36:39] offset:33472
  v_min_u32 v2, 13, v0
  v_lshrrev_b32 v3, 1, v2
  v_add_u32 v3, 2, v3
  v_mul_u32_u24 v4, 11, v3
  v_lshrrev_b32 v4, 5, v4
  v_mul_u32_u24 v5, 3, v4
  v_sub_u32 v3, v3, v5
  s_sub_u32 s55, s50, 2
  v_add_u32 v3, s55, v3
  v_max_i32 v3, 0, v3
  s_mul_i32 s55, s51, 40
  s_lshr_b32 s55, s55, 5
  v_and_b32 v2, 1, v2
  v_add_u32 v2, s55, v2
  v_mul_u32_u24 v4, 5, v4
  v_lshrrev_b32 v5, 2, v2
  v_add_u32 v4, v4, v5
  v_lshrrev_b32 v52, 1, v3
  v_and_b32 v5, 1, v3
  v_lshl_or_b32 v52, v5, 3, v52
  v_lshl_or_b32 v52, v4, 4, v52
  v_lshlrev_b32 v52, 7, v52
  v_lshlrev_b32 v3, 3, v7
  v_add_u32 v3, 32896, v3
  v_cmp_gt_u32 vcc, 16, v0
  s_nop 1
  v_cndmask_b32 v52, v3, v52, vcc
  s_lshl_b32 s56, s50, 3
  s_and_b32 s56, s56, 8
  s_and_b32 s57, s51, 7
  s_or_b32 s56, s56, s57
  s_cmp_eq_u32 s56, 15
  s_cselect_b32 s56, 128, 0
  s_xor_b32 s55, s2, s56
  s_lshl_b32 s55, s55, 7
  s_waitcnt lgkmcnt(0)
  v_lshlrev_b32 v2, 3, v0
  s_waitcnt vmcnt(6)
  s_barrier
  s_cmp_lg_u32 s3, 0
  s_cbranch_scc1 L_nf_2
  s_add_u32 s96, s48, 1
  v_mov_b32 v10, s96
  s_mov_b64 exec, 0xffff
  buffer_store_dwordx2 v[10:11], v2, s[32:35], s55 offen sc1
  s_mov_b64 exec, -1
L_nf_2:
  s_add_u32 m0, s23, 24576
  s_nop 0
  buffer_load_dwordx4 v15, s[40:43], s17 offen offset:0 lds
  buffer_load_dwordx4 v16, s[40:43], s17 offen offset:1024 lds
  buffer_load_dwordx4 v17, s[40:43], s17 offen offset:2048 lds
  s_add_u32 m0, s23, 36864
  s_nop 0
  buffer_load_dwordx4 v15, s[44:47], s17 offen offset:0 lds
  buffer_load_dwordx4 v16, s[44:47], s17 offen offset:1024 lds
  buffer_load_dwordx4 v17, s[44:47], s17 offen offset:2048 lds
  s_cmp_eq_u32 s22, 7
  s_cselect_b32 s99, 0xffe20000, 0
  s_add_u32 s17, s17, 196608
  s_add_u32 s17, s17, s99
  s_add_u32 m0, s23, 49152
  s_nop 0
  buffer_load_dwordx4 v15, s[40:43], s17 offen offset:0 lds
  buffer_load_dwordx4 v16, s[40:43], s17 offen offset:1024 lds
  buffer_load_dwordx4 v17, s[40:43], s17 offen offset:2048 lds
  s_add_u32 m0, s23, 61440
  s_nop 0
  buffer_load_dwordx4 v15, s[44:47], s17 offen offset:0 lds
  buffer_load_dwordx4 v16, s[44:47], s17 offen offset:1024 lds
  buffer_load_dwordx4 v17, s[44:47], s17 offen offset:2048 lds
  s_cmp_eq_u32 s22, 6
  s_cselect_b32 s99, 0xffe20000, 0
  s_add_u32 s17, s17, 196608
  s_add_u32 s17, s17, s99
  s_add_u32 m0, s23, 73728
  v_mov_b32 v62, 0
  v_mov_b32 v63, 0
  v_mov_b32 v64, 0
  v_mov_b32 v65, 0
  v_lshlrev_b32 v2, 9, v22
  s_mul_i32 s57, s51, 2560
  s_add_u32 s57, s57, 1048576
  s_mul_i32 s13, s3, 7728
  s_lshl_b32 s55, s50, 2
  s_mul_i32 s56, s3, 3
  s_add_u32 s55, s55, s56
  s_sub_u32 s55, s55, 8
  s_add_u32 s56, s55, 0
  s_max_i32 s58, s56, 0
  s_mul_i32 s58, s58, 122880
  s_add_u32 s58, s58, s57
  s_add_u32 s7, s58, 40960
  s_add_u32 s10, s58, 81920
  s_cmp_lt_i32 s56, 0
  s_cselect_b32 s10, 268435456, s10
  s_cselect_b64 vcc, -1, 0
  v_cndmask_b32 v66, v14, v2, vcc
  s_add_u32 s56, s55, 1
  s_max_i32 s58, s56, 0
  s_mul_i32 s58, s58, 122880
  s_add_u32 s58, s58, s57
  s_add_u32 s8, s58, 40960
  s_add_u32 s11, s58, 81920
  s_cmp_lt_i32 s56, 0
  s_cselect_b32 s11, 268435456, s11
  s_cselect_b64 vcc, -1, 0
  v_cndmask_b32 v67, v14, v2, vcc
  s_add_u32 s56, s55, 2
  s_max_i32 s58, s56, 0
  s_mul_i32 s58, s58, 122880
  s_add_u32 s58, s58, s57
  s_add_u32 s9, s58, 40960
  s_add_u32 s12, s58, 81920
  s_cmp_lt_i32 s56, 0
  s_cselect_b32 s12, 268435456, s12
  s_cselect_b64 vcc, -1, 0
  v_cndmask_b32 v68, v14, v2, vcc
  s_lshl_b32 s6, s50, 2
  s_lshl_b32 s55, s5, 1
  s_add_u32 s6, s6, s55
  s_mul_i32 s60, s6, 122880
  s_add_u32 s60, s60, s57
  s_mul_i32 s61, s4, 1536
  s_add_u32 s61, s61, s60
  s_add_u32 s62, s60, 122880
  s_add_u32 s63, s61, 122880
  v_lshlrev_b32 v2, 9, v13
  v_lshl_add_u32 v20, v7, 4, v2
  v_bfe_u32 v5, v0, 2, 1
  v_lshrrev_b32 v6, 5, v0
  v_xor_b32 v6, v6, v5
  v_bfe_u32 v3, v0, 4, 1
  v_lshl_or_b32 v6, v3, 1, v6
  v_mul_u32_u24 v2, 352, v7
  v_lshl_add_u32 v2, v6, 4, v2
  s_mul_i32 s55, s3, 11264
  s_add_u32 s55, s55, 0
  v_add_u32 v21, s55, v2
  v_and_b32 v3, 7, v0
  v_bfe_u32 v4, v0, 3, 1
  s_lshl_b32 s55, s3, 3
  v_add_u32 v2, s55, v3
  v_mul_u32_u24 v2, 352, v2
  v_add_u32 v2, 0, v2
  v_lshl_add_u32 v53, v6, 4, v2
  v_lshl_add_u32 v53, v4, 3, v53
  v_add_u32 v53, 256, v53
  v_xor_b32 v4, v4, v5
  v_lshl_add_u32 v2, v4, 4, v2
  v_lshl_add_u32 v22, v13, 6, v2
  v_lshrrev_b32 v4, 3, v0
  v_mul_u32_u24 v2, 1280, v3
  v_lshl_add_u32 v69, v4, 4, v2
  v_lshl_add_u32 v70, v4, 2, v2
  v_add_u32 v70, 128, v70
  s_lshl_b32 s20, s50, 2
  s_lshl_b32 s55, s15, 1
  s_add_u32 s20, s20, s55
  s_lshl_b32 s55, s20, 5
  s_lshl_b32 s56, s3, 3
  s_add_u32 s55, s55, s56
  s_mul_i32 s19, s55, 1280
  s_mul_i32 s55, s14, 160
  s_add_u32 s19, s19, s55
  v_and_b32 v2, 7, v0
  v_lshlrev_b32 v2, 4, v2
  v_lshrrev_b32 v3, 3, v0
  v_lshl_add_u32 v71, v3, 9, v2
  v_lshrrev_b32 v4, 5, v0
  v_lshl_add_u32 v72, v4, 9, v2
  v_and_b32 v3, 3, v3
  v_lshl_add_u32 v72, v3, 2, v72
  v_add_u32 v72, 4096, v72
  v_and_b32 v3, 1, v13
  v_lshl_add_u32 v73, v3, 2, v2
  v_accvgpr_write_b32 a192, v21
  v_accvgpr_write_b32 a193, v22
  v_accvgpr_write_b32 a194, v53
  v_accvgpr_write_b32 a195, v69
  v_accvgpr_write_b32 a196, v70
  v_accvgpr_write_b32 a197, v71
  v_accvgpr_write_b32 a198, v72
  v_accvgpr_write_b32 a199, v73
  s_cmp_lg_u32 s3, 1
  s_cbranch_scc1 L_np_3
  buffer_load_dwordx2 v[8:9], v52, s[32:35], 0 offen sc1
L_np_3:
  v_mov_b32 v36, 0x3f803f80
  v_mov_b32 v37, 0x3f803f80
  v_mov_b32 v38, 0x3f803f80
  v_mov_b32 v39, 0x3f803f80
  s_nop 1
  v_mfma_f32_16x16x32_bf16 v[40:43], a[0:3], v[36:39], 0
  v_mfma_f32_16x16x32_bf16 v[44:47], a[4:7], v[36:39], 0
  v_mfma_f32_16x16x32_bf16 v[48:51], a[8:11], v[36:39], 0
  v_mfma_f32_16x16x32_bf16 v[40:43], a[12:15], v[36:39], v[40:43]
  v_mfma_f32_16x16x32_bf16 v[44:47], a[16:19], v[36:39], v[44:47]
  v_mfma_f32_16x16x32_bf16 v[48:51], a[20:23], v[36:39], v[48:51]
  s_lshl_b32 s21, s20, 11
  s_lshr_b32 s56, s3, 1
  s_lshl_b32 s56, s56, 10
  s_add_u32 s21, s21, s56
  s_and_b32 s56, s3, 1
  s_lshl_b32 s56, s56, 7
  s_add_u32 s21, s21, s56
  s_lshr_b32 s56, s14, 1
  s_lshl_b32 s56, s56, 8
  s_add_u32 s21, s21, s56
  s_and_b32 s56, s14, 1
  s_lshl_b32 s56, s56, 3
  s_add_u32 s21, s21, s56
  s_add_u32 s21, s21, 23068672
  s_and_b32 s28, s51, 1
  s_lshl_b32 s28, s28, 2
  s_xor_b32 s28, s28, s50
  s_bfe_u32 s29, s51, 0x20001
  s_and_b32 s55, s50, 4
  s_or_b32 s29, s29, s55
  s_and_b32 s55, s51, 8
  s_or_b32 s29, s29, s55
  s_lshl_b32 s31, s28, 9
  s_add_u32 s31, s31, 131072
  s_lshl_b32 s30, s29, 3
  s_add_u32 s30, s30, s31
  s_lshl_b32 s55, s29, 13
  s_add_u32 s31, s31, s55
  s_mul_i32 s57, s29, 10
  s_add_u32 s57, s57, s22
  s_lshl2_add_u32 s57, s57, s3
  s_lshl_b32 s57, s57, 8
  s_add_u32 s57, s57, 23330816
  v_lshl_add_u32 v36, v13, 4, s57
  v_lshl_add_u32 v36, v7, 6, v36
  v_cmp_eq_u32 vcc, 1, v7
  s_nop 1
  v_cndmask_b32 v40, v40, v44, vcc
  v_cndmask_b32 v41, v41, v45, vcc
  v_cndmask_b32 v42, v42, v46, vcc
  v_cndmask_b32 v43, v43, v47, vcc
  v_cmp_eq_u32 vcc, 2, v7
  s_nop 1
  v_cndmask_b32 v40, v40, v48, vcc
  v_cndmask_b32 v41, v41, v49, vcc
  v_cndmask_b32 v42, v42, v50, vcc
  v_cndmask_b32 v43, v43, v51, vcc
  s_mov_b32 exec_lo, 0xf000f
  s_mov_b32 exec_hi, 0xf000f
  buffer_store_dwordx4 v[40:43], v36, s[32:35], 0 offen sc1
  s_mov_b64 exec, -1
  s_cmp_lg_u32 s3, 1
  s_cbranch_scc1 L_pdone_6
  s_add_u32 s96, s48, 1
  s_mov_b32 s97, 0
  s_waitcnt vmcnt(1)
  s_branch L_pchk_5
L_poll_4:
  buffer_load_dwordx2 v[8:9], v52, s[32:35], 0 offen sc1
  s_add_u32 s97, s97, 1
  s_waitcnt vmcnt(0)
L_pchk_5:
  v_subrev_u32 v8, s96, v8
  v_xor_b32 v9, s49, v9
  v_lshrrev_b32 v8, 4, v8
  v_or_b32 v8, v8, v9
  v_cmp_ne_u32 vcc, 0, v8
  s_nop 0
  s_cbranch_vccz L_pdone_6
  s_cmp_lt_u32 s97, 0x8000
  s_cbranch_scc1 L_poll_4
L_pdone_6:
  s_waitcnt vmcnt(1)
  s_barrier
  s_add_u32 m0, s13, 0
  s_nop 0
  buffer_load_dwordx4 v66, s[32:35], s7 offen offset:0 sc1 lds
  buffer_load_dwordx4 v66, s[32:35], s7 offen offset:1024 sc1 lds
  s_add_u32 m0, s13, 2576
  s_nop 0
  buffer_load_dwordx4 v67, s[32:35], s8 offen offset:0 sc1 lds
  buffer_load_dwordx4 v67, s[32:35], s8 offen offset:1024 sc1 lds
  s_add_u32 m0, s13, 5152
  s_nop 0
  buffer_load_dwordx4 v68, s[32:35], s9 offen offset:0 sc1 lds
  buffer_load_dwordx4 v68, s[32:35], s9 offen offset:1024 sc1 lds
  buffer_load_dwordx4 v[54:57], v14, s[32:35], s61 offen sc1
  s_mov_b32 exec_hi, 0
  s_add_u32 m0, s13, 0
  s_nop 0
  buffer_load_dwordx4 v66, s[32:35], s7 offen offset:2048 sc1 lds
  s_add_u32 m0, s13, 2576
  s_nop 0
  buffer_load_dwordx4 v67, s[32:35], s8 offen offset:2048 sc1 lds
  s_add_u32 m0, s13, 5152
  s_nop 0
  buffer_load_dwordx4 v68, s[32:35], s9 offen offset:2048 sc1 lds
  buffer_load_dwordx2 v[62:63], v35, s[32:35], s60 offen offset:1024 sc1
  buffer_load_dwordx2 v[64:65], v35, s[32:35], s62 offen offset:1024 sc1
  s_add_u32 m0, s13, 30912
  s_nop 0
  buffer_load_dwordx4 v14, s[32:35], s10 offen offset:2048 sc1 lds
  s_add_u32 m0, s13, 33488
  s_nop 0
  buffer_load_dwordx4 v14, s[32:35], s11 offen offset:2048 sc1 lds
  s_add_u32 m0, s13, 36064
  s_nop 0
  buffer_load_dwordx4 v14, s[32:35], s12 offen offset:2048 sc1 lds
  s_mov_b64 exec, -1
  s_add_u32 m0, s13, 30912
  s_nop 0
  buffer_load_dwordx4 v14, s[32:35], s10 offen offset:0 sc1 lds
  ds_read_b64_tr_b16 a[24:25], v18 offset:0
  ds_read_b64_tr_b16 a[26:27], v18 offset:768
  ds_read_b64_tr_b16 a[28:29], v18 offset:12288
  ds_read_b64_tr_b16 a[30:31], v18 offset:13056
  ds_read_b64_tr_b16 a[32:33], v19 offset:0
  ds_read_b64_tr_b16 a[34:35], v19 offset:768
  buffer_load_dwordx4 v14, s[32:35], s10 offen offset:1024 sc1 lds
  ds_read_b64_tr_b16 a[36:37], v18 offset:6144
  ds_read_b64_tr_b16 a[38:39], v18 offset:6912
  ds_read_b64_tr_b16 a[40:41], v18 offset:18432
  ds_read_b64_tr_b16 a[42:43], v18 offset:19200
  ds_read_b64_tr_b16 a[44:45], v19 offset:6144
  ds_read_b64_tr_b16 a[46:47], v19 offset:6912
  s_add_u32 m0, s13, 33488
  s_nop 0
  buffer_load_dwordx4 v14, s[32:35], s11 offen offset:0 sc1 lds
  ds_read_b64_tr_b16 a[48:49], v18 offset:24576
  ds_read_b64_tr_b16 a[50:51], v18 offset:25344
  ds_read_b64_tr_b16 a[52:53], v18 offset:36864
  ds_read_b64_tr_b16 a[54:55], v18 offset:37632
  ds_read_b64_tr_b16 a[56:57], v19 offset:24576
  ds_read_b64_tr_b16 a[58:59], v19 offset:25344
  buffer_load_dwordx4 v14, s[32:35], s11 offen offset:1024 sc1 lds
  ds_read_b64_tr_b16 a[60:61], v18 offset:30720
  ds_read_b64_tr_b16 a[62:63], v18 offset:31488
  ds_read_b64_tr_b16 a[64:65], v18 offset:43008
  ds_read_b64_tr_b16 a[66:67], v18 offset:43776
  ds_read_b64_tr_b16 a[68:69], v19 offset:30720
  ds_read_b64_tr_b16 a[70:71], v19 offset:31488
  v_add_u32 v18, 0xc000, v18
  v_add_u32 v19, 0xc000, v19
  s_add_u32 m0, s13, 36064
  s_nop 0
  buffer_load_dwordx4 v14, s[32:35], s12 offen offset:0 sc1 lds
  ds_read_b64_tr_b16 a[72:73], v18 offset:0
  ds_read_b64_tr_b16 a[74:75], v18 offset:768
  ds_read_b64_tr_b16 a[76:77], v18 offset:12288
  ds_read_b64_tr_b16 a[78:79], v18 offset:13056
  ds_read_b64_tr_b16 a[80:81], v19 offset:0
  ds_read_b64_tr_b16 a[82:83], v19 offset:768
  buffer_load_dwordx4 v14, s[32:35], s12 offen offset:1024 sc1 lds
  ds_read_b64_tr_b16 a[84:85], v18 offset:6144
  ds_read_b64_tr_b16 a[86:87], v18 offset:6912
  ds_read_b64_tr_b16 a[88:89], v18 offset:18432
  ds_read_b64_tr_b16 a[90:91], v18 offset:19200
  ds_read_b64_tr_b16 a[92:93], v19 offset:6144
  ds_read_b64_tr_b16 a[94:95], v19 offset:6912
  buffer_load_dwordx4 v[58:61], v14, s[32:35], s63 offen sc1
  s_mul_i32 s7, s6, 40960
  s_mul_i32 s56, s51, 2560
  s_add_u32 s7, s7, s56
  s_add_u32 s7, s7, 9437184
  s_lshl_b32 s56, s4, 10
  s_add_u32 s8, s56, s7
  s_mul_i32 s6, s20, 40960
  s_mul_i32 s55, s3, 10240
  s_add_u32 s4, s6, s55
  s_add_u32 s4, s4, 9437184
  s_add_u32 s5, s4, 40960
  s_mul_i32 s55, s14, 5120
  s_add_u32 s6, s6, s55
  s_lshl_b32 s55, s3, 7
  s_add_u32 s6, s6, s55
  s_add_u32 s6, s6, 12582912
  s_lshl_b32 s10, s3, 10
  s_lshl_b32 s11, s28, 13
  s_add_u32 s11, s11, 23068672
  s_add_u32 s9, s11, 4096
  s_lshl_b32 s55, s28, 2
  s_mul_i32 s55, s55, 98304
  s_lshl_b32 s56, s29, 2
  s_add_u32 s56, s56, s3
  s_mul_i32 s56, s56, 1536
  s_add_u32 s55, s55, s56
  s_add_u32 s12, s55, 16777216
  s_mul_i32 s13, s20, 98304
  s_mul_i32 s55, s3, 24576
  s_add_u32 s13, s13, s55
  s_add_u32 s13, s13, 16777216
  s_waitcnt vmcnt(11)
  s_waitcnt lgkmcnt(0)
  s_barrier
  ds_read_b128 v[138:141], v23 offset:0
  ds_read_b64 v[52:53], v32 offset:0
  ds_read_b128 v[142:145], v23 offset:20608
  ds_read_b64 v[146:147], v32 offset:20608
  s_waitcnt lgkmcnt(2)
  v_mfma_f32_32x32x16_bf16 v[36:51], v[138:141], v[54:57], 0
  ds_read_b128 v[138:141], v23 offset:2576
  v_mfma_f32_32x32x8_bf16 v[36:51], v[52:53], v[62:63], v[36:51]
  ds_read_b64 v[52:53], v32 offset:2576
  s_waitcnt lgkmcnt(2)
  v_mfma_f32_32x32x16_bf16 v[66:81], v[142:145], v[54:57], 0
  ds_read_b128 v[142:145], v23 offset:5152
  v_mfma_f32_32x32x8_bf16 v[66:81], v[146:147], v[62:63], v[66:81]
  ds_read_b64 v[146:147], v32 offset:5152
  s_waitcnt lgkmcnt(2)
  v_mfma_f32_32x32x16_bf16 v[82:97], v[138:141], v[54:57], 0
  ds_read_b128 v[138:141], v23 offset:7728
  v_mfma_f32_32x32x8_bf16 v[82:97], v[52:53], v[62:63], v[82:97]
  ds_read_b64 v[52:53], v32 offset:7728
  s_nop 5
  v_cndmask_b32 v114, v36, v66, s[64:65]
  v_cndmask_b32 v115, v37, v67, s[66:67]
  v_cndmask_b32 v116, v38, v68, s[68:69]
  v_cndmask_b32 v117, v39, v69, s[70:71]
  v_cndmask_b32 v118, v40, v70, s[72:73]
  v_cndmask_b32 v119, v41, v71, s[74:75]
  s_waitcnt lgkmcnt(2)
  v_mfma_f32_32x32x16_bf16 v[98:113], v[142:145], v[54:57], 0
  ds_read_b128 v[142:145], v23 offset:10304
  v_cndmask_b32 v120, v42, v72, s[76:77]
  v_cndmask_b32 v121, v43, v73, s[78:79]
  v_cndmask_b32 v122, v44, v74, s[80:81]
  v_cndmask_b32 v123, v45, v75, s[82:83]
  v_cndmask_b32 v124, v46, v76, s[84:85]
  v_mfma_f32_32x32x8_bf16 v[98:113], v[146:147], v[62:63], v[98:113]
  ds_read_b64 v[146:147], v32 offset:10304
  v_cndmask_b32 v125, v47, v77, s[86:87]
  v_cndmask_b32 v126, v48, v78, s[88:89]
  v_cndmask_b32 v127, v49, v79, s[90:91]
  v_cndmask_b32 v128, v50, v80, s[92:93]
  v_cndmask_b32 v129, v51, v81, s[94:95]
  v_max3_f32 v2, v82, v83, v84
  s_waitcnt lgkmcnt(2)
  v_mfma_f32_32x32x16_bf16 v[36:51], v[138:141], v[54:57], 0
  ds_read_b128 v[138:141], v23 offset:12880
  v_max_f32 v2, v2, v85
  v_max3_f32 v2, v2, v86, v87
  v_max3_f32 v2, v2, v88, v89
  v_max3_f32 v2, v2, v90, v91
  v_max3_f32 v2, v2, v92, v93
  v_mfma_f32_32x32x8_bf16 v[36:51], v[52:53], v[62:63], v[36:51]
  ds_read_b64 v[52:53], v32 offset:12880
  v_max3_f32 v2, v2, v94, v95
  v_max3_f32 v2, v2, v96, v97
  v_max3_f32 v2, v2, v98, v99
  v_max3_f32 v2, v2, v100, v101
  v_max3_f32 v2, v2, v102, v103
  v_max3_f32 v2, v2, v104, v105
  s_waitcnt lgkmcnt(2)
  v_mfma_f32_32x32x16_bf16 v[66:81], v[142:145], v[54:57], 0
  ds_read_b128 v[142:145], v23 offset:15456
  v_max3_f32 v2, v2, v106, v107
  v_max3_f32 v2, v2, v108, v109
  v_max3_f32 v2, v2, v110, v111
  v_max3_f32 v2, v2, v112, v113
  v_max3_f32 v2, v2, v114, v115
  v_mfma_f32_32x32x8_bf16 v[66:81], v[146:147], v[62:63], v[66:81]
  ds_read_b64 v[146:147], v32 offset:15456
  v_max3_f32 v2, v2, v116, v117
  v_max3_f32 v2, v2, v118, v119
  v_max3_f32 v2, v2, v120, v121
  v_max3_f32 v2, v2, v122, v123
  v_max3_f32 v2, v2, v124, v125
  v_max3_f32 v2, v2, v126, v127
  s_waitcnt lgkmcnt(2)
  v_mfma_f32_32x32x16_bf16 v[82:97], v[138:141], v[54:57], 0
  ds_read_b128 v[138:141], v23 offset:18032
  v_max3_f32 v2, v2, v128, v129
  v_max3_f32 v2, v2, v36, v37
  v_max3_f32 v2, v2, v38, v39
  v_max3_f32 v2, v2, v40, v41
  v_max3_f32 v2, v2, v42, v43
  v_mfma_f32_32x32x8_bf16 v[82:97], v[52:53], v[62:63], v[82:97]
  ds_read_b64 v[52:53], v32 offset:18032
  v_max3_f32 v2, v2, v44, v45
  v_max3_f32 v2, v2, v46, v47
  v_max3_f32 v2, v2, v48, v49
  v_max3_f32 v2, v2, v50, v51
  v_max3_f32 v2, v2, v66, v67
  v_max3_f32 v2, v2, v68, v69
  s_waitcnt lgkmcnt(2)
  v_mfma_f32_32x32x16_bf16 v[98:113], v[142:145], v[54:57], 0
  ds_read_b128 v[142:145], v23 offset:5152
  v_max3_f32 v2, v2, v70, v71
  v_max3_f32 v2, v2, v72, v73
  v_max3_f32 v2, v2, v74, v75
  v_max3_f32 v2, v2, v76, v77
  v_max3_f32 v2, v2, v78, v79
  v_mfma_f32_32x32x8_bf16 v[98:113], v[146:147], v[62:63], v[98:113]
  ds_read_b64 v[146:147], v32 offset:5152
  v_max3_f32 v2, v2, v80, v81
  v_max3_f32 v2, v2, v82, v83
  v_max3_f32 v2, v2, v84, v85
  v_max3_f32 v2, v2, v86, v87
  v_max3_f32 v2, v2, v88, v89
  v_max3_f32 v2, v2, v90, v91
  s_waitcnt lgkmcnt(2)
  v_mfma_f32_32x32x16_bf16 v[36:51], v[138:141], v[54:57], 0
  ds_read_b128 v[138:141], v23 offset:2576
  v_max3_f32 v2, v2, v92, v93
  v_max3_f32 v2, v2, v94, v95
  v_max3_f32 v2, v2, v96, v97
  v_mfma_f32_32x32x8_bf16 v[36:51], v[52:53], v[62:63], v[36:51]
  ds_read_b64 v[52:53], v32 offset:2576
  s_waitcnt vmcnt(1)
  s_barrier
  ds_read_b128 a[240:243], v33 offset:0
  buffer_store_dwordx4 a[232:235], v14, s[32:35], s52 offen sc1
  ds_read_b128 a[244:247], v34 offset:0
  ds_read_b128 a[248:251], v33 offset:20608
  ds_read_b128 a[252:255], v34 offset:20608
  v_max3_f32 v2, v2, v98, v99
  v_max3_f32 v2, v2, v100, v101
  v_max3_f32 v2, v2, v102, v103
  v_max3_f32 v2, v2, v104, v105
  v_max3_f32 v2, v2, v106, v107
  v_max3_f32 v2, v2, v108, v109
  v_max3_f32 v2, v2, v110, v111
  v_max3_f32 v2, v2, v112, v113
  v_max3_f32 v2, v2, v36, v37
  v_max3_f32 v2, v2, v38, v39
  v_max3_f32 v2, v2, v40, v41
  v_max3_f32 v2, v2, v42, v43
  v_max3_f32 v2, v2, v44, v45
  v_max3_f32 v2, v2, v46, v47
  v_max3_f32 v2, v2, v48, v49
  v_max3_f32 v2, v2, v50, v51
  v_mov_b32 v3, v2
  buffer_store_dwordx4 a[236:239], v14, s[32:35], s53 offen sc1
  s_nop 0
  v_permlane32_swap_b32 v2, v3
  v_min_f32 v82, -v2, -v3
  v_min_f32 v83, -v2, -v3
  v_pk_mov_b32 v[84:85], v[82:83], v[82:83]
  v_pk_mov_b32 v[86:87], v[82:83], v[82:83]
  v_pk_mov_b32 v[88:89], v[82:83], v[82:83]
  v_pk_mov_b32 v[90:91], v[82:83], v[82:83]
  v_pk_mov_b32 v[92:93], v[82:83], v[82:83]
  v_pk_mov_b32 v[94:95], v[82:83], v[82:83]
  v_pk_mov_b32 v[96:97], v[82:83], v[82:83]
  v_pk_add_f32 v[66:67], v[114:115], v[82:83]
  v_pk_add_f32 v[68:69], v[116:117], v[82:83]
  v_pk_add_f32 v[70:71], v[118:119], v[82:83]
  v_pk_add_f32 v[72:73], v[120:121], v[82:83]
  v_pk_add_f32 v[74:75], v[122:123], v[82:83]
  v_pk_add_f32 v[76:77], v[124:125], v[82:83]
  v_pk_add_f32 v[78:79], v[126:127], v[82:83]
  v_pk_add_f32 v[80:81], v[128:129], v[82:83]
  s_waitcnt lgkmcnt(4)
  v_mfma_f32_32x32x16_bf16 v[36:51], v[138:141], v[54:57], v[82:97]
  buffer_load_dwordx4 v[156:159], v14, s[32:35], s16 offen offset:0 sc1
  v_exp_f32 v66, v66
  v_exp_f32 v67, v67
  v_exp_f32 v68, v68
  v_exp_f32 v69, v69
  v_cvt_pk_bf16_f32 v130, v66, v67
  v_exp_f32 v70, v70
  v_exp_f32 v71, v71
  v_cvt_pk_bf16_f32 v131, v68, v69
  v_exp_f32 v72, v72
  v_exp_f32 v73, v73
  v_cvt_pk_bf16_f32 v132, v70, v71
  v_exp_f32 v74, v74
  buffer_load_dwordx4 v[160:163], v14, s[32:35], s16 offen offset:1024 sc1
  v_exp_f32 v75, v75
  v_cvt_pk_bf16_f32 v133, v72, v73
  v_exp_f32 v76, v76
  v_exp_f32 v77, v77
  v_mfma_f32_32x32x8_bf16 v[36:51], v[52:53], v[62:63], v[36:51]
  ds_read_b128 v[138:141], v23 offset:7728
  ds_read_b64 v[52:53], v32 offset:7728
  v_cvt_pk_bf16_f32 v134, v74, v75
  v_exp_f32 v78, v78
  v_exp_f32 v79, v79
  v_cvt_pk_bf16_f32 v135, v76, v77
  v_exp_f32 v80, v80
  v_exp_f32 v81, v81
  buffer_load_dwordx4 v[164:167], v14, s[32:35], s16 offen offset:2048 sc1
  v_cvt_pk_bf16_f32 v136, v78, v79
  v_cvt_pk_bf16_f32 v137, v80, v81
  v_bfi_b32 v114, v24, 0, v130
  v_bfi_b32 v115, v25, 0, v131
  v_bfi_b32 v116, v26, 0, v132
  v_bfi_b32 v117, v27, 0, v133
  v_bfi_b32 v118, v28, 0, v134
  v_bfi_b32 v119, v29, 0, v135
  v_bfi_b32 v120, v30, 0, v136
  v_bfi_b32 v121, v31, 0, v137
  v_and_b32 v130, v24, v130
  v_and_b32 v131, v25, v131
  v_and_b32 v132, v26, v132
  v_and_b32 v133, v27, v133
  v_and_b32 v134, v28, v134
  v_and_b32 v135, v29, v135
  v_and_b32 v136, v30, v136
  v_and_b32 v137, v31, v137
  s_waitcnt lgkmcnt(2)
  v_mfma_f32_32x32x16_bf16 v[66:81], v[142:145], v[54:57], v[82:97]
  buffer_load_dwordx4 v[168:171], v14, s[32:35], s16 offen offset:3072 sc1
  s_add_u32 s16, s16, 4096
  v_exp_f32 v36, v36
  v_exp_f32 v37, v37
  v_exp_f32 v38, v38
  v_exp_f32 v39, v39
  v_mfma_f32_32x32x8_bf16 v[66:81], v[146:147], v[62:63], v[66:81]
  ds_read_b128 v[142:145], v23 offset:10304
  ds_read_b64 v[146:147], v32 offset:10304
  v_cvt_pk_bf16_f32 v122, v36, v37
  v_exp_f32 v40, v40
  v_exp_f32 v41, v41
  v_cvt_pk_bf16_f32 v123, v38, v39
  v_mfma_f32_32x32x16_bf16 v[98:113], a[240:243], v[114:117], 0
  buffer_load_dwordx4 v[172:175], v14, s[32:35], s16 offen offset:0 sc1
  v_exp_f32 v42, v42
  v_exp_f32 v43, v43
  v_cvt_pk_bf16_f32 v124, v40, v41
  v_exp_f32 v44, v44
  v_mfma_f32_32x32x16_bf16 v[98:113], a[244:247], v[118:121], v[98:113]
  ds_read_b128 a[240:243], v33 offset:2576
  ds_read_b128 a[244:247], v34 offset:2576
  v_exp_f32 v45, v45
  v_cvt_pk_bf16_f32 v125, v42, v43
  v_exp_f32 v46, v46
  v_exp_f32 v47, v47
  v_mfma_f32_32x32x16_bf16 v[98:113], a[248:251], v[130:133], v[98:113]
  v_cvt_pk_bf16_f32 v126, v44, v45
  buffer_load_dwordx4 v[176:179], v14, s[32:35], s16 offen offset:1024 sc1
  v_exp_f32 v48, v48
  v_exp_f32 v49, v49
  v_cvt_pk_bf16_f32 v127, v46, v47
  v_mfma_f32_32x32x16_bf16 v[98:113], a[252:255], v[134:137], v[98:113]
  ds_read_b128 a[248:251], v33 offset:5152
  ds_read_b128 a[252:255], v34 offset:5152
  v_exp_f32 v50, v50
  v_exp_f32 v51, v51
  v_cvt_pk_bf16_f32 v128, v48, v49
  v_cvt_pk_bf16_f32 v129, v50, v51
  s_waitcnt lgkmcnt(2)
  v_mfma_f32_32x32x16_bf16 v[36:51], v[138:141], v[54:57], v[82:97]
  v_exp_f32 v66, v66
  v_exp_f32 v67, v67
  buffer_load_dwordx4 v[180:183], v14, s[32:35], s16 offen offset:2048 sc1
  v_exp_f32 v68, v68
  v_exp_f32 v69, v69
  v_cvt_pk_bf16_f32 v114, v66, v67
  v_exp_f32 v70, v70
  v_mfma_f32_32x32x8_bf16 v[36:51], v[52:53], v[62:63], v[36:51]
  ds_read_b128 v[138:141], v23 offset:12880
  ds_read_b64 v[52:53], v32 offset:12880
  v_exp_f32 v71, v71
  v_cvt_pk_bf16_f32 v115, v68, v69
  v_exp_f32 v72, v72
  v_exp_f32 v73, v73
  v_cvt_pk_bf16_f32 v116, v70, v71
  v_exp_f32 v74, v74
  buffer_load_dwordx4 v[184:187], v14, s[32:35], s16 offen offset:3072 sc1
  s_add_u32 s16, s16, 4096
  v_mfma_f32_32x32x16_bf16 v[98:113], a[240:243], v[122:125], v[98:113]
  v_exp_f32 v75, v75
  v_cvt_pk_bf16_f32 v117, v72, v73
  v_exp_f32 v76, v76
  v_exp_f32 v77, v77
  v_cvt_pk_bf16_f32 v118, v74, v75
  v_exp_f32 v78, v78
  v_mfma_f32_32x32x16_bf16 v[98:113], a[244:247], v[126:129], v[98:113]
  ds_read_b128 a[240:243], v33 offset:7728
  ds_read_b128 a[244:247], v34 offset:7728
  v_exp_f32 v79, v79
  v_cvt_pk_bf16_f32 v119, v76, v77
  buffer_load_dwordx4 v[188:191], v14, s[32:35], s16 offen offset:0 sc1
  v_exp_f32 v80, v80
  v_exp_f32 v81, v81
  v_cvt_pk_bf16_f32 v120, v78, v79
  v_cvt_pk_bf16_f32 v121, v80, v81
  s_waitcnt lgkmcnt(4)
  v_mfma_f32_32x32x16_bf16 v[66:81], v[142:145], v[54:57], v[82:97]
  v_exp_f32 v36, v36
  v_exp_f32 v37, v37
  v_exp_f32 v38, v38
  v_exp_f32 v39, v39
  v_cvt_pk_bf16_f32 v122, v36, v37
  v_exp_f32 v40, v40
  v_mfma_f32_32x32x8_bf16 v[66:81], v[146:147], v[62:63], v[66:81]
  buffer_load_dwordx4 v[192:195], v14, s[32:35], s16 offen offset:1024 sc1
  ds_read_b128 v[142:145], v23 offset:15456
  ds_read_b64 v[146:147], v32 offset:15456
  v_exp_f32 v41, v41
  v_cvt_pk_bf16_f32 v123, v38, v39
  v_exp_f32 v42, v42
  v_exp_f32 v43, v43
  v_cvt_pk_bf16_f32 v124, v40, v41
  v_exp_f32 v44, v44
  v_mfma_f32_32x32x16_bf16 v[98:113], a[248:251], v[114:117], v[98:113]
  v_exp_f32 v45, v45
  v_cvt_pk_bf16_f32 v125, v42, v43
  v_exp_f32 v46, v46
  v_exp_f32 v47, v47
  buffer_load_dwordx4 v[196:199], v14, s[32:35], s16 offen offset:2048 sc1
  v_cvt_pk_bf16_f32 v126, v44, v45
  v_exp_f32 v48, v48
  v_mfma_f32_32x32x16_bf16 v[98:113], a[252:255], v[118:121], v[98:113]
  ds_read_b128 a[248:251], v33 offset:10304
  ds_read_b128 a[252:255], v34 offset:10304
  v_exp_f32 v49, v49
  v_cvt_pk_bf16_f32 v127, v46, v47
  v_exp_f32 v50, v50
  v_exp_f32 v51, v51
  v_cvt_pk_bf16_f32 v128, v48, v49
  v_cvt_pk_bf16_f32 v129, v50, v51
  s_waitcnt lgkmcnt(4)
  v_mfma_f32_32x32x16_bf16 v[36:51], v[138:141], v[54:57], v[82:97]
  v_exp_f32 v66, v66
  buffer_load_dwordx4 v[200:203], v14, s[32:35], s16 offen offset:3072 sc1
  s_add_u32 s16, s16, 4096
  v_exp_f32 v67, v67
  v_exp_f32 v68, v68
  v_exp_f32 v69, v69
  v_cvt_pk_bf16_f32 v114, v66, v67
  v_exp_f32 v70, v70
  v_mfma_f32_32x32x8_bf16 v[36:51], v[52:53], v[62:63], v[36:51]
  ds_read_b128 v[138:141], v23 offset:18032
  ds_read_b64 v[52:53], v32 offset:18032
  v_exp_f32 v71, v71
  v_cvt_pk_bf16_f32 v115, v68, v69
  v_exp_f32 v72, v72
  v_exp_f32 v73, v73
  buffer_load_dwordx4 v[204:207], v14, s[32:35], s16 offen offset:0 sc1
  v_cvt_pk_bf16_f32 v116, v70, v71
  v_exp_f32 v74, v74
  v_mfma_f32_32x32x16_bf16 v[98:113], a[240:243], v[122:125], v[98:113]
  v_exp_f32 v75, v75
  v_cvt_pk_bf16_f32 v117, v72, v73
  v_exp_f32 v76, v76
  v_exp_f32 v77, v77
  v_cvt_pk_bf16_f32 v118, v74, v75
  v_exp_f32 v78, v78
  v_mfma_f32_32x32x16_bf16 v[98:113], a[244:247], v[126:129], v[98:113]
  ds_read_b128 a[240:243], v33 offset:12880
  ds_read_b128 a[244:247], v34 offset:12880
  v_exp_f32 v79, v79
  buffer_load_dwordx4 v[208:211], v14, s[32:35], s16 offen offset:1024 sc1
  v_cvt_pk_bf16_f32 v119, v76, v77
  v_exp_f32 v80, v80
  v_exp_f32 v81, v81
  v_cvt_pk_bf16_f32 v120, v78, v79
  v_cvt_pk_bf16_f32 v121, v80, v81
  s_waitcnt lgkmcnt(4)
  v_mfma_f32_32x32x16_bf16 v[66:81], v[142:145], v[54:57], v[82:97]
  v_exp_f32 v36, v36
  v_exp_f32 v37, v37
  v_exp_f32 v38, v38
  v_exp_f32 v39, v39
  v_cvt_pk_bf16_f32 v122, v36, v37
  v_exp_f32 v40, v40
  buffer_load_dwordx4 v[212:215], v14, s[32:35], s16 offen offset:2048 sc1
  v_mfma_f32_32x32x8_bf16 v[66:81], v[146:147], v[62:63], v[66:81]
  ds_read_b128 v[142:145], v23 offset:23184
  ds_read_b64 v[146:147], v32 offset:23184
  v_exp_f32 v41, v41
  v_cvt_pk_bf16_f32 v123, v38, v39
  v_exp_f32 v42, v42
  v_exp_f32 v43, v43
  v_cvt_pk_bf16_f32 v124, v40, v41
  v_exp_f32 v44, v44
  v_mfma_f32_32x32x16_bf16 v[98:113], a[248:251], v[114:117], v[98:113]
  v_exp_f32 v45, v45
  v_cvt_pk_bf16_f32 v125, v42, v43
  v_exp_f32 v46, v46
  buffer_load_dwordx4 v[216:219], v14, s[32:35], s16 offen offset:3072 sc1
  s_add_u32 s16, s16, 4096
  v_exp_f32 v47, v47
  v_cvt_pk_bf16_f32 v126, v44, v45
  v_exp_f32 v48, v48
  v_mfma_f32_32x32x16_bf16 v[98:113], a[252:255], v[118:121], v[98:113]
  ds_read_b128 a[248:251], v33 offset:15456
  ds_read_b128 a[252:255], v34 offset:15456
  v_exp_f32 v49, v49
  v_cvt_pk_bf16_f32 v127, v46, v47
  v_exp_f32 v50, v50
  v_exp_f32 v51, v51
  v_cvt_pk_bf16_f32 v128, v48, v49
  v_cvt_pk_bf16_f32 v129, v50, v51
  s_waitcnt lgkmcnt(4)
  v_mfma_f32_32x32x16_bf16 v[36:51], v[138:141], v[54:57], v[82:97]
  buffer_load_dwordx4 v[220:223], v14, s[32:35], s16 offen offset:0 sc1
  v_exp_f32 v66, v66
  v_exp_f32 v67, v67
  v_exp_f32 v68, v68
  v_exp_f32 v69, v69
  v_cvt_pk_bf16_f32 v114, v66, v67
  v_exp_f32 v70, v70
  v_mfma_f32_32x32x8_bf16 v[36:51], v[52:53], v[62:63], v[36:51]
  ds_read_b128 v[138:141], v23 offset:2576
  ds_read_b64 v[52:53], v32 offset:2576
  v_exp_f32 v71, v71
  v_cvt_pk_bf16_f32 v115, v68, v69
  v_exp_f32 v72, v72
  v_exp_f32 v73, v73
  buffer_load_dwordx4 v[224:227], v14, s[32:35], s16 offen offset:1024 sc1
  v_cvt_pk_bf16_f32 v116, v70, v71
  v_exp_f32 v74, v74
  v_mfma_f32_32x32x16_bf16 v[98:113], a[240:243], v[122:125], v[98:113]
  v_exp_f32 v75, v75
  v_cvt_pk_bf16_f32 v117, v72, v73
  v_exp_f32 v76, v76
  v_exp_f32 v77, v77
  v_cvt_pk_bf16_f32 v118, v74, v75
  v_exp_f32 v78, v78
  v_mfma_f32_32x32x16_bf16 v[98:113], a[244:247], v[126:129], v[98:113]
  ds_read_b128 a[240:243], v33 offset:18032
  ds_read_b128 a[244:247], v34 offset:18032
  buffer_load_dwordx4 v[228:231], v14, s[32:35], s16 offen offset:2048 sc1
  v_exp_f32 v79, v79
  v_cvt_pk_bf16_f32 v119, v76, v77
  v_exp_f32 v80, v80
  v_exp_f32 v81, v81
  v_cvt_pk_bf16_f32 v120, v78, v79
  v_cvt_pk_bf16_f32 v121, v80, v81
  s_waitcnt lgkmcnt(4)
  v_mfma_f32_32x32x16_bf16 v[98:113], a[248:251], v[114:117], v[98:113]
  v_exp_f32 v36, v36
  v_exp_f32 v37, v37
  v_exp_f32 v38, v38
  v_exp_f32 v39, v39
  v_cvt_pk_bf16_f32 v122, v36, v37
  v_exp_f32 v40, v40
  buffer_load_dwordx4 v[232:235], v14, s[32:35], s16 offen offset:3072 sc1
  s_add_u32 s16, s16, 4096
  v_exp_f32 v41, v41
  v_cvt_pk_bf16_f32 v123, v38, v39
  v_exp_f32 v42, v42
  v_exp_f32 v43, v43
  v_cvt_pk_bf16_f32 v124, v40, v41
  v_exp_f32 v44, v44
  v_mfma_f32_32x32x16_bf16 v[98:113], a[252:255], v[118:121], v[98:113]
  v_exp_f32 v45, v45
  v_cvt_pk_bf16_f32 v125, v42, v43
  v_exp_f32 v46, v46
  v_exp_f32 v47, v47
  buffer_load_dwordx4 v[236:239], v14, s[32:35], s16 offen offset:0 sc1
  v_cvt_pk_bf16_f32 v126, v44, v45
  v_exp_f32 v48, v48
  v_exp_f32 v49, v49
  v_cvt_pk_bf16_f32 v127, v46, v47
  v_exp_f32 v50, v50
  v_exp_f32 v51, v51
  v_cvt_pk_bf16_f32 v128, v48, v49
  v_cvt_pk_bf16_f32 v129, v50, v51
  s_waitcnt lgkmcnt(1)
  v_mfma_f32_32x32x16_bf16 v[98:113], a[240:243], v[122:125], v[98:113]
  s_waitcnt lgkmcnt(0)
  v_mfma_f32_32x32x16_bf16 v[98:113], a[244:247], v[126:129], v[98:113]
  buffer_load_dwordx4 v[240:243], v14, s[32:35], s16 offen offset:1024 sc1
  s_waitcnt vmcnt(24)
  v_mfma_f32_32x32x16_bf16 v[36:51], v[138:141], v[58:61], 0
  ds_read_b128 v[138:141], v23 offset:5152
  v_mfma_f32_32x32x8_bf16 v[36:51], v[52:53], v[64:65], v[36:51]
  ds_read_b64 v[52:53], v32 offset:5152
  v_mfma_f32_32x32x16_bf16 v[66:81], v[142:145], v[58:61], 0
  buffer_load_dwordx4 v[244:247], v14, s[32:35], s16 offen offset:2048 sc1
  ds_read_b128 v[142:145], v23 offset:7728
  v_mfma_f32_32x32x8_bf16 v[66:81], v[146:147], v[64:65], v[66:81]
  ds_read_b64 v[146:147], v32 offset:7728
  s_nop 0
  v_rcp_f32 v3, v110
  s_nop 0
  v_mul_f32 v98, v3, v98
  v_mul_f32 v99, v3, v99
  v_mul_f32 v100, v3, v100
  v_mul_f32 v101, v3, v101
  v_mul_f32 v102, v3, v102
  v_mul_f32 v103, v3, v103
  v_mul_f32 v104, v3, v104
  v_mul_f32 v105, v3, v105
  v_mul_f32 v106, v3, v106
  buffer_load_dwordx4 v[248:251], v14, s[32:35], s16 offen offset:3072 sc1
  s_add_u32 s16, s16, 4096
  v_mul_f32 v107, v3, v107
  v_mul_f32 v108, v3, v108
  v_mul_f32 v109, v3, v109
  v_cvt_pk_bf16_f32 v130, v98, v99
  v_cvt_pk_bf16_f32 v131, v100, v101
  v_cvt_pk_bf16_f32 v132, v102, v103
  v_cvt_pk_bf16_f32 v133, v104, v105
  v_cvt_pk_bf16_f32 v134, v106, v107
  v_cvt_pk_bf16_f32 v135, v108, v109
  buffer_store_dwordx4 v[130:133], v14, s[32:35], s8 offen sc1
  s_mov_b32 exec_hi, 0
  buffer_store_dwordx2 v[134:135], v35, s[32:35], s7 offen offset:2048 sc1
  s_mov_b64 exec, -1
  s_add_u32 s7, s7, 40960
  s_add_u32 s8, s8, 40960
  s_waitcnt lgkmcnt(2)
  v_mfma_f32_32x32x16_bf16 v[82:97], v[138:141], v[58:61], 0
  ds_read_b128 v[138:141], v23 offset:10304
  v_mfma_f32_32x32x8_bf16 v[82:97], v[52:53], v[64:65], v[82:97]
  ds_read_b64 v[52:53], v32 offset:10304
  buffer_load_dwordx4 v[252:255], v14, s[32:35], s16 offen offset:0 sc1
  v_cndmask_b32 v114, v36, v66, s[64:65]
  v_cndmask_b32 v115, v37, v67, s[66:67]
  v_cndmask_b32 v116, v38, v68, s[68:69]
  v_cndmask_b32 v117, v39, v69, s[70:71]
  v_cndmask_b32 v118, v40, v70, s[72:73]
  v_cndmask_b32 v119, v41, v71, s[74:75]
  s_waitcnt lgkmcnt(2)
  v_mfma_f32_32x32x16_bf16 v[98:113], v[142:145], v[58:61], 0
  ds_read_b128 v[142:145], v23 offset:12880
  v_cndmask_b32 v120, v42, v72, s[76:77]
  v_cndmask_b32 v121, v43, v73, s[78:79]
  v_cndmask_b32 v122, v44, v74, s[80:81]
  v_cndmask_b32 v123, v45, v75, s[82:83]
  v_cndmask_b32 v124, v46, v76, s[84:85]
  v_mfma_f32_32x32x8_bf16 v[98:113], v[146:147], v[64:65], v[98:113]
  ds_read_b64 v[146:147], v32 offset:12880
  v_cndmask_b32 v125, v47, v77, s[86:87]
  v_cndmask_b32 v126, v48, v78, s[88:89]
  v_cndmask_b32 v127, v49, v79, s[90:91]
  v_cndmask_b32 v128, v50, v80, s[92:93]
  s_add_u32 m0, s23, 73728
  s_nop 0
  buffer_load_dwordx4 v15, s[40:43], s17 offen offset:0 lds
  v_cndmask_b32 v129, v51, v81, s[94:95]
  v_max3_f32 v2, v82, v83, v84
  s_waitcnt lgkmcnt(2)
  v_mfma_f32_32x32x16_bf16 v[36:51], v[138:141], v[58:61], 0
  ds_read_b128 v[138:141], v23 offset:15456
  v_max_f32 v2, v2, v85
  v_max3_f32 v2, v2, v86, v87
  v_max3_f32 v2, v2, v88, v89
  v_max3_f32 v2, v2, v90, v91
  v_max3_f32 v2, v2, v92, v93
  v_mfma_f32_32x32x8_bf16 v[36:51], v[52:53], v[64:65], v[36:51]
  ds_read_b64 v[52:53], v32 offset:15456
  v_max3_f32 v2, v2, v94, v95
  v_max3_f32 v2, v2, v96, v97
  v_max3_f32 v2, v2, v98, v99
  v_max3_f32 v2, v2, v100, v101
  v_max3_f32 v2, v2, v102, v103
  v_max3_f32 v2, v2, v104, v105
  s_waitcnt lgkmcnt(2)
  v_mfma_f32_32x32x16_bf16 v[66:81], v[142:145], v[58:61], 0
  buffer_load_dwordx4 v16, s[40:43], s17 offen offset:1024 lds
  ds_read_b128 v[142:145], v23 offset:18032
  v_max3_f32 v2, v2, v106, v107
  v_max3_f32 v2, v2, v108, v109
  v_max3_f32 v2, v2, v110, v111
  v_max3_f32 v2, v2, v112, v113
  v_max3_f32 v2, v2, v114, v115
  v_mfma_f32_32x32x8_bf16 v[66:81], v[146:147], v[64:65], v[66:81]
  ds_read_b64 v[146:147], v32 offset:18032
  v_max3_f32 v2, v2, v116, v117
  v_max3_f32 v2, v2, v118, v119
  v_max3_f32 v2, v2, v120, v121
  v_max3_f32 v2, v2, v122, v123
  v_max3_f32 v2, v2, v124, v125
  v_max3_f32 v2, v2, v126, v127
  s_waitcnt lgkmcnt(2)
  v_mfma_f32_32x32x16_bf16 v[82:97], v[138:141], v[58:61], 0
  ds_read_b128 v[138:141], v23 offset:20608
  v_max3_f32 v2, v2, v128, v129
  v_max3_f32 v2, v2, v36, v37
  buffer_load_dwordx4 v17, s[40:43], s17 offen offset:2048 lds
  s_add_u32 m0, s23, 86016
  v_max3_f32 v2, v2, v38, v39
  v_max3_f32 v2, v2, v40, v41
  v_max3_f32 v2, v2, v42, v43
  v_mfma_f32_32x32x8_bf16 v[82:97], v[52:53], v[64:65], v[82:97]
  ds_read_b64 v[52:53], v32 offset:20608
  v_max3_f32 v2, v2, v44, v45
  v_max3_f32 v2, v2, v46, v47
  v_max3_f32 v2, v2, v48, v49
  v_max3_f32 v2, v2, v50, v51
  v_max3_f32 v2, v2, v66, v67
  v_max3_f32 v2, v2, v68, v69
  s_waitcnt lgkmcnt(2)
  v_mfma_f32_32x32x16_bf16 v[98:113], v[142:145], v[58:61], 0
  ds_read_b128 v[142:145], v23 offset:7728
  v_max3_f32 v2, v2, v70, v71
  v_max3_f32 v2, v2, v72, v73
  v_max3_f32 v2, v2, v74, v75
  v_max3_f32 v2, v2, v76, v77
  v_max3_f32 v2, v2, v78, v79
  buffer_load_dwordx4 v15, s[44:47], s17 offen offset:0 lds
  v_mfma_f32_32x32x8_bf16 v[98:113], v[146:147], v[64:65], v[98:113]
  ds_read_b64 v[146:147], v32 offset:7728
  v_max3_f32 v2, v2, v80, v81
  v_max3_f32 v2, v2, v82, v83
  v_max3_f32 v2, v2, v84, v85
  v_max3_f32 v2, v2, v86, v87
  v_max3_f32 v2, v2, v88, v89
  v_max3_f32 v2, v2, v90, v91
  s_waitcnt lgkmcnt(2)
  v_mfma_f32_32x32x16_bf16 v[36:51], v[138:141], v[58:61], 0
  ds_read_b128 v[138:141], v23 offset:5152
  v_max3_f32 v2, v2, v92, v93
  v_max3_f32 v2, v2, v94, v95
  v_max3_f32 v2, v2, v96, v97
  v_mfma_f32_32x32x8_bf16 v[36:51], v[52:53], v[64:65], v[36:51]
  ds_read_b64 v[52:53], v32 offset:5152
  ds_read_b128 a[240:243], v33 offset:2576
  buffer_load_dwordx4 v16, s[44:47], s17 offen offset:1024 lds
  ds_read_b128 a[244:247], v34 offset:2576
  ds_read_b128 a[248:251], v33 offset:23184
  ds_read_b128 a[252:255], v34 offset:23184
  v_max3_f32 v2, v2, v98, v99
  v_max3_f32 v2, v2, v100, v101
  v_max3_f32 v2, v2, v102, v103
  v_max3_f32 v2, v2, v104, v105
  v_max3_f32 v2, v2, v106, v107
  v_max3_f32 v2, v2, v108, v109
  v_max3_f32 v2, v2, v110, v111
  v_max3_f32 v2, v2, v112, v113
  v_max3_f32 v2, v2, v36, v37
  v_max3_f32 v2, v2, v38, v39
  v_max3_f32 v2, v2, v40, v41
  v_max3_f32 v2, v2, v42, v43
  v_max3_f32 v2, v2, v44, v45
  v_max3_f32 v2, v2, v46, v47
  v_max3_f32 v2, v2, v48, v49
  v_max3_f32 v2, v2, v50, v51
  v_mov_b32 v3, v2
  buffer_load_dwordx4 v17, s[44:47], s17 offen offset:2048 lds
  s_cmp_eq_u32 s22, 5
  s_cselect_b32 s99, 0xffe20000, 0
  s_add_u32 s17, s17, 196608
  s_add_u32 s17, s17, s99
  s_add_u32 m0, s23, 0
  v_permlane32_swap_b32 v2, v3
  v_min_f32 v82, -v2, -v3
  v_min_f32 v83, -v2, -v3
  v_pk_mov_b32 v[84:85], v[82:83], v[82:83]
  v_pk_mov_b32 v[86:87], v[82:83], v[82:83]
  v_pk_mov_b32 v[88:89], v[82:83], v[82:83]
  v_pk_mov_b32 v[90:91], v[82:83], v[82:83]
  v_pk_mov_b32 v[92:93], v[82:83], v[82:83]
  v_pk_mov_b32 v[94:95], v[82:83], v[82:83]
  v_pk_mov_b32 v[96:97], v[82:83], v[82:83]
  v_pk_add_f32 v[66:67], v[114:115], v[82:83]
  v_pk_add_f32 v[68:69], v[116:117], v[82:83]
  v_pk_add_f32 v[70:71], v[118:119], v[82:83]
  v_pk_add_f32 v[72:73], v[120:121], v[82:83]
  v_pk_add_f32 v[74:75], v[122:123], v[82:83]
  v_pk_add_f32 v[76:77], v[124:125], v[82:83]
  v_pk_add_f32 v[78:79], v[126:127], v[82:83]
  v_pk_add_f32 v[80:81], v[128:129], v[82:83]
  s_waitcnt lgkmcnt(4)
  v_mfma_f32_32x32x16_bf16 v[36:51], v[138:141], v[58:61], v[82:97]
  v_exp_f32 v66, v66
  buffer_load_dwordx4 v15, s[40:43], s17 offen offset:0 lds
  v_exp_f32 v67, v67
  v_exp_f32 v68, v68
  v_exp_f32 v69, v69
  v_cvt_pk_bf16_f32 v130, v66, v67
  v_exp_f32 v70, v70
  v_exp_f32 v71, v71
  v_cvt_pk_bf16_f32 v131, v68, v69
  v_exp_f32 v72, v72
  v_exp_f32 v73, v73
  v_cvt_pk_bf16_f32 v132, v70, v71
  v_exp_f32 v74, v74
  buffer_load_dwordx4 v16, s[40:43], s17 offen offset:1024 lds
  v_exp_f32 v75, v75
  v_cvt_pk_bf16_f32 v133, v72, v73
  v_exp_f32 v76, v76
  v_exp_f32 v77, v77
  v_mfma_f32_32x32x8_bf16 v[36:51], v[52:53], v[64:65], v[36:51]
  ds_read_b128 v[138:141], v23 offset:10304
  ds_read_b64 v[52:53], v32 offset:10304
  v_cvt_pk_bf16_f32 v134, v74, v75
  v_exp_f32 v78, v78
  v_exp_f32 v79, v79
  v_cvt_pk_bf16_f32 v135, v76, v77
  v_exp_f32 v80, v80
  v_exp_f32 v81, v81
  buffer_load_dwordx4 v17, s[40:43], s17 offen offset:2048 lds
  s_add_u32 m0, s23, 12288
  v_cvt_pk_bf16_f32 v136, v78, v79
  v_cvt_pk_bf16_f32 v137, v80, v81
  v_bfi_b32 v114, v24, 0, v130
  v_bfi_b32 v115, v25, 0, v131
  v_bfi_b32 v116, v26, 0, v132
  v_bfi_b32 v117, v27, 0, v133
  v_bfi_b32 v118, v28, 0, v134
  v_bfi_b32 v119, v29, 0, v135
  v_bfi_b32 v120, v30, 0, v136
  v_bfi_b32 v121, v31, 0, v137
  v_and_b32 v130, v24, v130
  v_and_b32 v131, v25, v131
  v_and_b32 v132, v26, v132
  v_and_b32 v133, v27, v133
  v_and_b32 v134, v28, v134
  v_and_b32 v135, v29, v135
  v_and_b32 v136, v30, v136
  v_and_b32 v137, v31, v137
  s_waitcnt lgkmcnt(2)
  v_mfma_f32_32x32x16_bf16 v[66:81], v[142:145], v[58:61], v[82:97]
  buffer_load_dwordx4 v15, s[44:47], s17 offen offset:0 lds
  v_exp_f32 v36, v36
  v_exp_f32 v37, v37
  v_exp_f32 v38, v38
  v_exp_f32 v39, v39
  v_mfma_f32_32x32x8_bf16 v[66:81], v[146:147], v[64:65], v[66:81]
  ds_read_b128 v[142:145], v23 offset:12880
  ds_read_b64 v[146:147], v32 offset:12880
  s_waitcnt vmcnt(4)
  s_barrier
  s_cmp_lg_u32 s3, 0
  s_cbranch_scc1 L_nf_7
  s_add_u32 s96, s48, 4
  v_mov_b32 v10, s96
  s_mov_b64 exec, 0x1ffff
  buffer_store_dwordx2 v[10:11], v12, s[32:35], s54 offen offset:0 sc1
  s_mov_b64 exec, -1
L_nf_7:
  ds_read_b64_tr_b16 a[96:97], v18 offset:24576
  ds_read_b64_tr_b16 a[98:99], v18 offset:25344
  v_cvt_pk_bf16_f32 v122, v36, v37
  v_exp_f32 v40, v40
  v_exp_f32 v41, v41
  v_cvt_pk_bf16_f32 v123, v38, v39
  v_mfma_f32_32x32x16_bf16 v[98:113], a[240:243], v[114:117], 0
  ds_read_b64_tr_b16 a[100:101], v18 offset:36864
  ds_read_b64_tr_b16 a[102:103], v18 offset:37632
  v_exp_f32 v42, v42
  v_exp_f32 v43, v43
  v_cvt_pk_bf16_f32 v124, v40, v41
  v_exp_f32 v44, v44
  ds_read_b64_tr_b16 a[104:105], v19 offset:24576
  ds_read_b64_tr_b16 a[106:107], v19 offset:25344
  v_mfma_f32_32x32x16_bf16 v[98:113], a[244:247], v[118:121], v[98:113]
  ds_read_b128 a[240:243], v33 offset:5152
  ds_read_b128 a[244:247], v34 offset:5152
  v_exp_f32 v45, v45
  v_cvt_pk_bf16_f32 v125, v42, v43
  v_exp_f32 v46, v46
  ds_read_b64_tr_b16 a[108:109], v18 offset:30720
  ds_read_b64_tr_b16 a[110:111], v18 offset:31488
  v_exp_f32 v47, v47
  v_mfma_f32_32x32x16_bf16 v[98:113], a[248:251], v[130:133], v[98:113]
  v_cvt_pk_bf16_f32 v126, v44, v45
  v_exp_f32 v48, v48
  ds_read_b64_tr_b16 a[112:113], v18 offset:43008
  ds_read_b64_tr_b16 a[114:115], v18 offset:43776
  v_exp_f32 v49, v49
  v_cvt_pk_bf16_f32 v127, v46, v47
  v_mfma_f32_32x32x16_bf16 v[98:113], a[252:255], v[134:137], v[98:113]
  ds_read_b128 a[248:251], v33 offset:7728
  ds_read_b128 a[252:255], v34 offset:7728
  v_exp_f32 v50, v50
  ds_read_b64_tr_b16 a[116:117], v19 offset:30720
  ds_read_b64_tr_b16 a[118:119], v19 offset:31488
  v_add_u32 v18, 0xffff4000, v18
  v_add_u32 v19, 0xffff4000, v19
  v_exp_f32 v51, v51
  v_cvt_pk_bf16_f32 v128, v48, v49
  v_cvt_pk_bf16_f32 v129, v50, v51
  s_waitcnt lgkmcnt(8)
  v_mfma_f32_32x32x16_bf16 v[36:51], v[138:141], v[58:61], v[82:97]
  v_exp_f32 v66, v66
  buffer_load_dwordx4 v16, s[44:47], s17 offen offset:1024 lds
  v_exp_f32 v67, v67
  v_exp_f32 v68, v68
  v_exp_f32 v69, v69
  v_cvt_pk_bf16_f32 v114, v66, v67
  v_exp_f32 v70, v70
  v_mfma_f32_32x32x8_bf16 v[36:51], v[52:53], v[64:65], v[36:51]
  ds_read_b128 v[138:141], v23 offset:15456
  ds_read_b64 v[52:53], v32 offset:15456
  v_exp_f32 v71, v71
  v_cvt_pk_bf16_f32 v115, v68, v69
  v_exp_f32 v72, v72
  v_exp_f32 v73, v73
  buffer_load_dwordx4 v17, s[44:47], s17 offen offset:2048 lds
  s_cmp_eq_u32 s22, 4
  s_cselect_b32 s99, 0xffe20000, 0
  s_add_u32 s17, s17, 196608
  s_add_u32 s17, s17, s99
  s_add_u32 m0, s23, 24576
  v_cvt_pk_bf16_f32 v116, v70, v71
  v_exp_f32 v74, v74
  v_mfma_f32_32x32x16_bf16 v[98:113], a[240:243], v[122:125], v[98:113]
  v_exp_f32 v75, v75
  v_cvt_pk_bf16_f32 v117, v72, v73
  v_exp_f32 v76, v76
  v_exp_f32 v77, v77
  v_cvt_pk_bf16_f32 v118, v74, v75
  v_exp_f32 v78, v78
  v_mfma_f32_32x32x16_bf16 v[98:113], a[244:247], v[126:129], v[98:113]
  ds_read_b128 a[240:243], v33 offset:10304
  ds_read_b128 a[244:247], v34 offset:10304
  v_exp_f32 v79, v79
  buffer_load_dwordx4 v15, s[40:43], s17 offen offset:0 lds
  v_cvt_pk_bf16_f32 v119, v76, v77
  v_exp_f32 v80, v80
  v_exp_f32 v81, v81
  v_cvt_pk_bf16_f32 v120, v78, v79
  v_cvt_pk_bf16_f32 v121, v80, v81
  s_waitcnt lgkmcnt(6)
  v_mfma_f32_32x32x16_bf16 v[66:81], v[142:145], v[58:61], v[82:97]
  v_exp_f32 v36, v36
  v_exp_f32 v37, v37
  v_exp_f32 v38, v38
  v_exp_f32 v39, v39
  v_cvt_pk_bf16_f32 v122, v36, v37
  v_exp_f32 v40, v40
  buffer_load_dwordx4 v16, s[40:43], s17 offen offset:1024 lds
  v_mfma_f32_32x32x8_bf16 v[66:81], v[146:147], v[64:65], v[66:81]
  ds_read_b128 v[142:145], v23 offset:18032
  ds_read_b64 v[146:147], v32 offset:18032
  v_exp_f32 v41, v41
  v_cvt_pk_bf16_f32 v123, v38, v39
  v_exp_f32 v42, v42
  v_exp_f32 v43, v43
  v_cvt_pk_bf16_f32 v124, v40, v41
  v_exp_f32 v44, v44
  v_mfma_f32_32x32x16_bf16 v[98:113], a[248:251], v[114:117], v[98:113]
  v_exp_f32 v45, v45
  v_cvt_pk_bf16_f32 v125, v42, v43
  v_exp_f32 v46, v46
  buffer_load_dwordx4 v17, s[40:43], s17 offen offset:2048 lds
  s_add_u32 m0, s23, 36864
  v_exp_f32 v47, v47
  v_cvt_pk_bf16_f32 v126, v44, v45
  v_exp_f32 v48, v48
  v_mfma_f32_32x32x16_bf16 v[98:113], a[252:255], v[118:121], v[98:113]
  ds_read_b128 a[248:251], v33 offset:12880
  ds_read_b128 a[252:255], v34 offset:12880
  v_exp_f32 v49, v49
  v_cvt_pk_bf16_f32 v127, v46, v47
  v_exp_f32 v50, v50
  v_exp_f32 v51, v51
  v_cvt_pk_bf16_f32 v128, v48, v49
  v_cvt_pk_bf16_f32 v129, v50, v51
  s_waitcnt lgkmcnt(4)
  v_mfma_f32_32x32x16_bf16 v[36:51], v[138:141], v[58:61], v[82:97]
  buffer_load_dwordx4 v15, s[44:47], s17 offen offset:0 lds
  v_exp_f32 v66, v66
  v_exp_f32 v67, v67
  v_exp_f32 v68, v68
  v_exp_f32 v69, v69
  v_cvt_pk_bf16_f32 v114, v66, v67
  v_exp_f32 v70, v70
  v_mfma_f32_32x32x8_bf16 v[36:51], v[52:53], v[64:65], v[36:51]
  ds_read_b128 v[138:141], v23 offset:20608
  ds_read_b64 v[52:53], v32 offset:20608
  v_exp_f32 v71, v71
  v_cvt_pk_bf16_f32 v115, v68, v69
  v_exp_f32 v72, v72
  buffer_load_dwordx4 v16, s[44:47], s17 offen offset:1024 lds
  v_exp_f32 v73, v73
  v_cvt_pk_bf16_f32 v116, v70, v71
  v_exp_f32 v74, v74
  v_mfma_f32_32x32x16_bf16 v[98:113], a[240:243], v[122:125], v[98:113]
  v_exp_f32 v75, v75
  v_cvt_pk_bf16_f32 v117, v72, v73
  v_exp_f32 v76, v76
  v_exp_f32 v77, v77
  v_cvt_pk_bf16_f32 v118, v74, v75
  v_exp_f32 v78, v78
  v_mfma_f32_32x32x16_bf16 v[98:113], a[244:247], v[126:129], v[98:113]
  ds_read_b128 a[240:243], v33 offset:15456
  buffer_load_dwordx4 v17, s[44:47], s17 offen offset:2048 lds
  s_cmp_eq_u32 s22, 3
  s_cselect_b32 s99, 0xffe20000, 0
  s_add_u32 s17, s17, 196608
  s_add_u32 s17, s17, s99
  s_add_u32 m0, s23, 49152
  ds_read_b128 a[244:247], v34 offset:15456
  v_exp_f32 v79, v79
  v_cvt_pk_bf16_f32 v119, v76, v77
  v_exp_f32 v80, v80
  v_exp_f32 v81, v81
  v_cvt_pk_bf16_f32 v120, v78, v79
  v_cvt_pk_bf16_f32 v121, v80, v81
  s_waitcnt lgkmcnt(4)
  v_mfma_f32_32x32x16_bf16 v[66:81], v[142:145], v[58:61], v[82:97]
  v_exp_f32 v36, v36
  v_exp_f32 v37, v37
  v_exp_f32 v38, v38
  v_exp_f32 v39, v39
  v_cvt_pk_bf16_f32 v122, v36, v37
  buffer_load_dwordx4 v15, s[40:43], s17 offen offset:0 lds
  v_exp_f32 v40, v40
  v_mfma_f32_32x32x8_bf16 v[66:81], v[146:147], v[64:65], v[66:81]
  v_exp_f32 v41, v41
  v_cvt_pk_bf16_f32 v123, v38, v39
  v_exp_f32 v42, v42
  v_exp_f32 v43, v43
  v_cvt_pk_bf16_f32 v124, v40, v41
  v_exp_f32 v44, v44
  v_mfma_f32_32x32x16_bf16 v[98:113], a[248:251], v[114:117], v[98:113]
  v_exp_f32 v45, v45
  v_cvt_pk_bf16_f32 v125, v42, v43
  v_exp_f32 v46, v46
  buffer_load_dwordx4 v16, s[40:43], s17 offen offset:1024 lds
  v_exp_f32 v47, v47
  v_cvt_pk_bf16_f32 v126, v44, v45
  v_exp_f32 v48, v48
  v_mfma_f32_32x32x16_bf16 v[98:113], a[252:255], v[118:121], v[98:113]
  ds_read_b128 a[248:251], v33 offset:18032
  ds_read_b128 a[252:255], v34 offset:18032
  v_exp_f32 v49, v49
  v_cvt_pk_bf16_f32 v127, v46, v47
  v_exp_f32 v50, v50
  v_exp_f32 v51, v51
  v_cvt_pk_bf16_f32 v128, v48, v49
  v_cvt_pk_bf16_f32 v129, v50, v51
  s_cmp_lg_u32 s3, 1
  s_cbranch_scc1 L_np_8
  v_lshlrev_b32 v8, 3, v7
  buffer_load_dwordx2 v[8:9], v8, s[32:35], s98 offen offset:0 sc1
L_np_8:
  s_waitcnt lgkmcnt(2)
  v_mfma_f32_32x32x16_bf16 v[36:51], v[138:141], v[58:61], v[82:97]
  buffer_load_dwordx4 v17, s[40:43], s17 offen offset:2048 lds
  s_add_u32 m0, s23, 61440
  v_exp_f32 v66, v66
  v_exp_f32 v67, v67
  v_exp_f32 v68, v68
  v_exp_f32 v69, v69
  v_cvt_pk_bf16_f32 v114, v66, v67
  v_exp_f32 v70, v70
  v_mfma_f32_32x32x8_bf16 v[36:51], v[52:53], v[64:65], v[36:51]
  v_exp_f32 v71, v71
  v_cvt_pk_bf16_f32 v115, v68, v69
  buffer_load_dwordx4 v15, s[44:47], s17 offen offset:0 lds
  v_exp_f32 v72, v72
  v_exp_f32 v73, v73
  v_cvt_pk_bf16_f32 v116, v70, v71
  v_exp_f32 v74, v74
  v_mfma_f32_32x32x16_bf16 v[98:113], a[240:243], v[122:125], v[98:113]
  v_exp_f32 v75, v75
  v_cvt_pk_bf16_f32 v117, v72, v73
  v_exp_f32 v76, v76
  v_exp_f32 v77, v77
  v_cvt_pk_bf16_f32 v118, v74, v75
  v_exp_f32 v78, v78
  v_mfma_f32_32x32x16_bf16 v[98:113], a[244:247], v[126:129], v[98:113]
  buffer_load_dwordx4 v16, s[44:47], s17 offen offset:1024 lds
  ds_read_b128 a[240:243], v33 offset:20608
  ds_read_b128 a[244:247], v34 offset:20608
  v_exp_f32 v79, v79
  v_cvt_pk_bf16_f32 v119, v76, v77
  v_exp_f32 v80, v80
  v_exp_f32 v81, v81
  v_cvt_pk_bf16_f32 v120, v78, v79
  v_cvt_pk_bf16_f32 v121, v80, v81
  s_waitcnt lgkmcnt(2)
  v_mfma_f32_32x32x16_bf16 v[98:113], a[248:251], v[114:117], v[98:113]
  v_exp_f32 v36, v36
  v_exp_f32 v37, v37
  v_exp_f32 v38, v38
  v_exp_f32 v39, v39
  buffer_load_dwordx4 v17, s[44:47], s17 offen offset:2048 lds
  s_cmp_eq_u32 s22, 2
  s_cselect_b32 s99, 0xffe20000, 0
  s_add_u32 s17, s17, 196608
  s_add_u32 s17, s17, s99
  s_add_u32 m0, s23, 73728
  v_cvt_pk_bf16_f32 v122, v36, v37
  v_exp_f32 v40, v40
  v_exp_f32 v41, v41
  v_cvt_pk_bf16_f32 v123, v38, v39
  v_exp_f32 v42, v42
  v_exp_f32 v43, v43
  v_cvt_pk_bf16_f32 v124, v40, v41
  v_exp_f32 v44, v44
  v_mfma_f32_32x32x16_bf16 v[98:113], a[252:255], v[118:121], v[98:113]
  v_exp_f32 v45, v45
  v_cvt_pk_bf16_f32 v125, v42, v43
  v_exp_f32 v46, v46
  v_exp_f32 v47, v47
  v_cvt_pk_bf16_f32 v126, v44, v45
  v_exp_f32 v48, v48
  v_exp_f32 v49, v49
  v_cvt_pk_bf16_f32 v127, v46, v47
  v_exp_f32 v50, v50
  v_exp_f32 v51, v51
  v_cvt_pk_bf16_f32 v128, v48, v49
  v_cvt_pk_bf16_f32 v129, v50, v51
  s_waitcnt lgkmcnt(1)
  v_mfma_f32_32x32x16_bf16 v[98:113], a[240:243], v[122:125], v[98:113]
  s_waitcnt lgkmcnt(0)
  v_mfma_f32_32x32x16_bf16 v[98:113], a[244:247], v[126:129], v[98:113]
  s_cmp_lg_u32 s3, 1
  s_cbranch_scc1 L_pdone_11
  s_add_u32 s96, s48, 4
  s_mov_b32 s97, 0
  s_waitcnt vmcnt(4)
  s_branch L_pchk_10
L_poll_9:
  v_lshlrev_b32 v8, 3, v7
  buffer_load_dwordx2 v[8:9], v8, s[32:35], s98 offen offset:0 sc1
  s_add_u32 s97, s97, 1
  s_waitcnt vmcnt(0)
L_pchk_10:
  v_subrev_u32 v8, s96, v8
  v_xor_b32 v9, s49, v9
  v_lshrrev_b32 v8, 4, v8
  v_or_b32 v8, v8, v9
  v_cmp_ne_u32 vcc, 0, v8
  s_nop 0
  s_cbranch_vccz L_pdone_11
  s_cmp_lt_u32 s97, 0x8000
  s_cbranch_scc1 L_poll_9
L_pdone_11:
  s_barrier
  s_add_u32 s55, s4, 4096
  s_add_u32 s56, s4, 8192
  buffer_load_dwordx4 a[200:203], v20, s[32:35], s4 offen offset:0 sc1
  buffer_load_dwordx4 a[208:211], v20, s[32:35], s4 offen offset:2048 sc1
  buffer_load_dwordx4 a[216:219], v20, s[32:35], s55 offen offset:0 sc1
  buffer_load_dwordx4 a[224:227], v20, s[32:35], s55 offen offset:2048 sc1
  buffer_load_dwordx4 a[232:235], v20, s[32:35], s56 offen offset:0 sc1
  buffer_load_dwordx4 a[204:207], v20, s[32:35], s4 offen offset:256 sc1
  buffer_load_dwordx4 a[212:215], v20, s[32:35], s4 offen offset:2304 sc1
  buffer_load_dwordx4 a[220:223], v20, s[32:35], s55 offen offset:256 sc1
  buffer_load_dwordx4 a[228:231], v20, s[32:35], s55 offen offset:2304 sc1
  buffer_load_dwordx4 a[236:239], v20, s[32:35], s56 offen offset:256 sc1
  v_accvgpr_read_b32 v21, a192
  v_accvgpr_read_b32 v22, a193
  v_accvgpr_read_b32 v23, a194
  v_accvgpr_read_b32 v24, a195
  v_accvgpr_read_b32 v25, a196
  v_accvgpr_read_b32 v26, a197
  v_accvgpr_read_b32 v27, a198
  v_accvgpr_read_b32 v28, a199
  v_rcp_f32 v3, v110
  s_nop 0
  v_mul_f32 v98, v3, v98
  v_mul_f32 v99, v3, v99
  v_mul_f32 v100, v3, v100
  v_mul_f32 v101, v3, v101
  v_mul_f32 v102, v3, v102
  v_mul_f32 v103, v3, v103
  v_mul_f32 v104, v3, v104
  v_mul_f32 v105, v3, v105
  v_mul_f32 v106, v3, v106
  v_mul_f32 v107, v3, v107
  v_mul_f32 v108, v3, v108
  v_mul_f32 v109, v3, v109
  v_cvt_pk_bf16_f32 v130, v98, v99
  v_cvt_pk_bf16_f32 v131, v100, v101
  v_cvt_pk_bf16_f32 v132, v102, v103
  v_cvt_pk_bf16_f32 v133, v104, v105
  v_cvt_pk_bf16_f32 v134, v106, v107
  v_cvt_pk_bf16_f32 v135, v108, v109
  buffer_store_dwordx4 v[130:133], v14, s[32:35], s8 offen sc1
  s_mov_b32 exec_hi, 0
  buffer_store_dwordx2 v[134:135], v35, s[32:35], s7 offen offset:2048 sc1
  s_mov_b64 exec, -1
  s_add_u32 s55, s19, 0
  buffer_load_dwordx4 v[30:33], v24, s[24:27], s55 offen
  buffer_load_dword v40, v25, s[24:27], s55 offen
  s_add_u32 s55, s19, 40960
  buffer_load_dwordx4 v[36:39], v24, s[24:27], s55 offen
  buffer_load_dword v41, v25, s[24:27], s55 offen
  s_waitcnt vmcnt(16)
  s_barrier
  s_waitcnt vmcnt(15)
  v_mfma_f32_16x16x32_bf16 v[54:57], v[156:159], a[200:203], 0
  buffer_load_dwordx4 v15, s[40:43], s17 offen offset:0 lds
  ds_read_b64_tr_b16 a[120:121], v18 offset:0
  ds_read_b64_tr_b16 a[122:123], v18 offset:768
  s_waitcnt vmcnt(15)
  v_mfma_f32_16x16x32_bf16 v[54:57], v[176:179], a[208:211], v[54:57]
  v_lshrrev_b32 v4, 1, v13
  v_and_b32 v5, 1, v13
  s_waitcnt vmcnt(14)
  v_mfma_f32_16x16x32_bf16 v[54:57], v[196:199], a[216:219], v[54:57]
  buffer_load_dwordx4 v16, s[40:43], s17 offen offset:1024 lds
  s_waitcnt vmcnt(14)
  v_mfma_f32_16x16x32_bf16 v[54:57], v[216:219], a[224:227], v[54:57]
  ds_read_b64_tr_b16 a[124:125], v18 offset:12288
  ds_read_b64_tr_b16 a[126:127], v18 offset:13056
  s_waitcnt vmcnt(13)
  v_mfma_f32_16x16x32_bf16 v[54:57], v[236:239], a[232:235], v[54:57]
  v_mov_b32 v34, v14
  v_add_u32 v35, 81920, v14
  v_mfma_f32_16x16x32_bf16 v[58:61], v[160:163], a[200:203], 0
  buffer_load_dwordx4 v17, s[40:43], s17 offen offset:2048 lds
  s_add_u32 m0, s23, 86016
  v_mfma_f32_16x16x32_bf16 v[58:61], v[180:183], a[208:211], v[58:61]
  ds_read_b64_tr_b16 a[128:129], v19 offset:0
  ds_read_b64_tr_b16 a[130:131], v19 offset:768
  v_mfma_f32_16x16x32_bf16 v[58:61], v[200:203], a[216:219], v[58:61]
  s_mul_i32 s60, s28, 163840
  s_add_u32 s60, s60, s10
  v_mfma_f32_16x16x32_bf16 v[58:61], v[220:223], a[224:227], v[58:61]
  buffer_load_dwordx4 v15, s[44:47], s17 offen offset:0 lds
  v_mfma_f32_16x16x32_bf16 v[58:61], v[240:243], a[232:235], v[58:61]
  ds_read_b64_tr_b16 a[132:133], v18 offset:6144
  ds_read_b64_tr_b16 a[134:135], v18 offset:6912
  v_mfma_f32_16x16x32_bf16 v[62:65], v[164:167], a[200:203], 0
  s_add_u32 s60, s60, 12582912
  s_lshl_b32 s24, s22, 12
  ds_write_b128 v21, v[54:57] offset:0
  v_mfma_f32_16x16x32_bf16 v[62:65], v[184:187], a[208:211], v[62:65]
  buffer_load_dwordx4 v16, s[44:47], s17 offen offset:1024 lds
  v_mfma_f32_16x16x32_bf16 v[62:65], v[204:207], a[216:219], v[62:65]
  ds_read_b64_tr_b16 a[136:137], v18 offset:18432
  ds_read_b64_tr_b16 a[138:139], v18 offset:19200
  v_mfma_f32_16x16x32_bf16 v[62:65], v[224:227], a[224:227], v[62:65]
  s_add_u32 s24, s24, s60
  s_add_u32 s25, s24, 4096
  v_mfma_f32_16x16x32_bf16 v[62:65], v[244:247], a[232:235], v[62:65]
  buffer_load_dwordx4 v17, s[44:47], s17 offen offset:2048 lds
  s_cmp_eq_u32 s22, 1
  s_cselect_b32 s99, 0xffe20000, 0
  s_add_u32 s17, s17, 196608
  s_add_u32 s17, s17, s99
  s_add_u32 m0, s23, 0
  v_mfma_f32_16x16x32_bf16 v[66:69], v[168:171], a[200:203], 0
  ds_read_b64_tr_b16 a[140:141], v19 offset:6144
  ds_read_b64_tr_b16 a[142:143], v19 offset:6912
  ds_write_b128 v21, v[58:61] offset:64
  s_cmp_eq_u32 s22, 9
  s_cselect_b32 s25, s60, s25
  s_add_u32 s26, s25, 4096
  v_mfma_f32_16x16x32_bf16 v[66:69], v[188:191], a[208:211], v[66:69]
  ds_read_b64_tr_b16 a[144:145], v18 offset:24576
  ds_read_b64_tr_b16 a[146:147], v18 offset:25344
  v_mfma_f32_16x16x32_bf16 v[66:69], v[208:211], a[216:219], v[66:69]
  s_cmp_eq_u32 s22, 8
  s_cselect_b32 s26, s60, s26
  s_add_u32 s27, s26, 4096
  v_mfma_f32_16x16x32_bf16 v[66:69], v[228:231], a[224:227], v[66:69]
  ds_read_b64_tr_b16 a[148:149], v18 offset:36864
  ds_read_b64_tr_b16 a[150:151], v18 offset:37632
  v_mfma_f32_16x16x32_bf16 v[66:69], v[248:251], a[232:235], v[66:69]
  s_cmp_eq_u32 s22, 7
  s_cselect_b32 s27, s60, s27
  s_add_u32 s52, s27, 4096
  v_mfma_f32_16x16x32_bf16 v[70:73], v[172:175], a[200:203], 0
  ds_read_b64_tr_b16 a[152:153], v19 offset:24576
  ds_read_b64_tr_b16 a[154:155], v19 offset:25344
  ds_write_b128 v21, v[62:65] offset:128
  v_mfma_f32_16x16x32_bf16 v[70:73], v[192:195], a[208:211], v[70:73]
  s_cmp_eq_u32 s22, 6
  s_cselect_b32 s52, s60, s52
  s_add_u32 s53, s52, 4096
  v_mfma_f32_16x16x32_bf16 v[70:73], v[212:215], a[216:219], v[70:73]
  ds_read_b64_tr_b16 a[156:157], v18 offset:30720
  ds_read_b64_tr_b16 a[158:159], v18 offset:31488
  v_mfma_f32_16x16x32_bf16 v[70:73], v[232:235], a[224:227], v[70:73]
  s_cmp_eq_u32 s22, 5
  s_cselect_b32 s53, s60, s53
  s_add_u32 s7, s53, 4096
  v_mfma_f32_16x16x32_bf16 v[70:73], v[252:255], a[232:235], v[70:73]
  ds_read_b64_tr_b16 a[160:161], v18 offset:43008
  ds_read_b64_tr_b16 a[162:163], v18 offset:43776
  s_waitcnt vmcnt(16)
  v_mfma_f32_16x16x32_bf16 v[74:77], v[156:159], a[204:207], 0
  s_cmp_eq_u32 s22, 4
  s_cselect_b32 s7, s60, s7
  s_add_u32 s8, s7, 4096
  ds_write_b128 v21, v[66:69] offset:192
  ds_read_b64_tr_b16 a[164:165], v19 offset:30720
  ds_read_b64_tr_b16 a[166:167], v19 offset:31488
  v_add_u32 v18, 0xc000, v18
  v_add_u32 v19, 0xc000, v19
  s_waitcnt vmcnt(15)
  v_mfma_f32_16x16x32_bf16 v[74:77], v[176:179], a[212:215], v[74:77]
  s_cmp_eq_u32 s22, 3
  s_cselect_b32 s8, s60, s8
  s_add_u32 s16, s8, 4096
  s_waitcnt vmcnt(14)
  v_mfma_f32_16x16x32_bf16 v[74:77], v[196:199], a[220:223], v[74:77]
  ds_read_b64_tr_b16 a[168:169], v18 offset:0
  ds_read_b64_tr_b16 a[170:171], v18 offset:768
  s_waitcnt vmcnt(13)
  v_mfma_f32_16x16x32_bf16 v[74:77], v[216:219], a[228:231], v[74:77]
  s_cmp_eq_u32 s22, 2
  s_cselect_b32 s16, s60, s16
  s_add_u32 s20, s16, 4096
  s_waitcnt vmcnt(12)
  v_mfma_f32_16x16x32_bf16 v[74:77], v[236:239], a[236:239], v[74:77]
  ds_read_b64_tr_b16 a[172:173], v18 offset:12288
  ds_read_b64_tr_b16 a[174:175], v18 offset:13056
  v_mfma_f32_16x16x32_bf16 v[78:81], v[160:163], a[204:207], 0
  s_cmp_eq_u32 s22, 1
  s_cselect_b32 s20, s60, s20
  v_mul_u32_u24 v29, 196608, v5
  ds_write_b128 v21, v[70:73] offset:256
  v_mfma_f32_16x16x32_bf16 v[78:81], v[180:183], a[212:215], v[78:81]
  ds_read_b64_tr_b16 a[176:177], v19 offset:0
  ds_read_b64_tr_b16 a[178:179], v19 offset:768
  v_mfma_f32_16x16x32_bf16 v[78:81], v[200:203], a[220:223], v[78:81]
  v_lshl_add_u32 v29, v4, 8, v29
  v_lshl_add_u32 v29, v7, 4, v29
  v_mfma_f32_16x16x32_bf16 v[78:81], v[220:223], a[228:231], v[78:81]
  ds_read_b64_tr_b16 a[180:181], v18 offset:6144
  ds_read_b64_tr_b16 a[182:183], v18 offset:6912
  v_mfma_f32_16x16x32_bf16 v[78:81], v[240:243], a[236:239], v[78:81]
  ds_read_b64_tr_b16 a[184:185], v18 offset:18432
  ds_read_b64_tr_b16 a[186:187], v18 offset:19200
  v_mfma_f32_16x16x32_bf16 v[82:85], v[164:167], a[204:207], 0
  s_waitcnt vmcnt(10)
  s_barrier
  s_cmp_lg_u32 s3, 0
  s_cbranch_scc1 L_nf_12
  s_add_u32 s96, s48, 5
  v_mov_b32 v10, s96
  s_mov_b64 exec, 0xffff
  buffer_store_dwordx2 v[10:11], v12, s[32:35], s54 offen offset:128 sc1
  s_mov_b64 exec, -1
L_nf_12:
  ds_read_b64_tr_b16 a[188:189], v19 offset:6144
  ds_read_b64_tr_b16 a[190:191], v19 offset:6912
  ds_write_b128 v21, v[74:77] offset:5632
  v_mfma_f32_16x16x32_bf16 v[82:85], v[184:187], a[212:215], v[82:85]
  v_mfma_f32_16x16x32_bf16 v[82:85], v[204:207], a[220:223], v[82:85]
  v_mfma_f32_16x16x32_bf16 v[82:85], v[224:227], a[228:231], v[82:85]
  v_mfma_f32_16x16x32_bf16 v[82:85], v[244:247], a[236:239], v[82:85]
  v_mfma_f32_16x16x32_bf16 v[86:89], v[168:171], a[204:207], 0
  ds_write_b128 v21, v[78:81] offset:5696
  v_mfma_f32_16x16x32_bf16 v[86:89], v[188:191], a[212:215], v[86:89]
  v_mfma_f32_16x16x32_bf16 v[86:89], v[208:211], a[220:223], v[86:89]
  v_mfma_f32_16x16x32_bf16 v[86:89], v[228:231], a[228:231], v[86:89]
  v_mfma_f32_16x16x32_bf16 v[86:89], v[248:251], a[236:239], v[86:89]
  v_mfma_f32_16x16x32_bf16 v[90:93], v[172:175], a[204:207], 0
  s_nop 0
  ds_write_b128 v21, v[82:85] offset:5760
  v_mfma_f32_16x16x32_bf16 v[90:93], v[192:195], a[212:215], v[90:93]
  v_mfma_f32_16x16x32_bf16 v[90:93], v[212:215], a[220:223], v[90:93]
  v_mfma_f32_16x16x32_bf16 v[90:93], v[232:235], a[228:231], v[90:93]
  v_mfma_f32_16x16x32_bf16 v[90:93], v[252:255], a[236:239], v[90:93]
  s_nop 0
  ds_write_b128 v21, v[86:89] offset:5824
  s_nop 5
  ds_write_b128 v21, v[90:93] offset:5888
  s_lshl_b32 s55, s3, 9
  s_add_u32 s55, s55, 262144
  v_lshl_add_u32 v96, v0, 3, s55
  buffer_load_dwordx2 v[94:95], v96, s[32:35], 0 offen sc1
  s_waitcnt vmcnt(9)
  v_lshlrev_b32 v144, 16, v30
  v_and_b32 v145, 0xffff0000, v30
  v_lshlrev_b32 v146, 16, v31
  v_and_b32 v147, 0xffff0000, v31
  v_lshlrev_b32 v148, 16, v32
  v_and_b32 v149, 0xffff0000, v32
  v_lshlrev_b32 v150, 16, v33
  v_and_b32 v151, 0xffff0000, v33
  s_waitcnt vmcnt(8)
  v_lshlrev_b32 v152, 16, v40
  v_and_b32 v153, 0xffff0000, v40
  s_waitcnt lgkmcnt(0)
  s_barrier
  ds_read_b128 v[54:57], v22 offset:0
  ds_read_b128 v[58:61], v22 offset:32
  ds_read_b64 v[86:87], v23 offset:0
  ds_read_b128 v[62:65], v22 offset:11264
  ds_read_b128 v[66:69], v22 offset:11296
  ds_read_b64 v[88:89], v23 offset:11264
  ds_read_b128 v[70:73], v22 offset:22528
  ds_read_b128 v[74:77], v22 offset:22560
  ds_read_b64 v[90:91], v23 offset:22528
  ds_read_b128 v[78:81], v22 offset:33792
  ds_read_b128 v[82:85], v22 offset:33824
  ds_read_b64 v[92:93], v23 offset:33792
  buffer_load_dwordx4 v15, s[40:43], s17 offen offset:0 lds
  buffer_load_dwordx4 v16, s[40:43], s17 offen offset:1024 lds
  buffer_load_dwordx4 v17, s[40:43], s17 offen offset:2048 lds
  s_add_u32 m0, s23, 12288
  s_nop 0
  buffer_load_dwordx4 v15, s[44:47], s17 offen offset:0 lds
  buffer_load_dwordx4 v16, s[44:47], s17 offen offset:1024 lds
  buffer_load_dwordx4 v17, s[44:47], s17 offen offset:2048 lds
  s_waitcnt lgkmcnt(11)
  v_pk_add_f32 v[144:145], v[144:145], v[54:55]
  v_pk_add_f32 v[146:147], v[146:147], v[56:57]
  s_waitcnt lgkmcnt(10)
  v_pk_add_f32 v[148:149], v[148:149], v[58:59]
  v_pk_add_f32 v[150:151], v[150:151], v[60:61]
  s_waitcnt lgkmcnt(9)
  v_pk_add_f32 v[152:153], v[152:153], v[86:87]
  s_waitcnt lgkmcnt(8)
  v_pk_add_f32 v[144:145], v[144:145], v[62:63]
  v_pk_add_f32 v[146:147], v[146:147], v[64:65]
  s_waitcnt lgkmcnt(7)
  v_pk_add_f32 v[148:149], v[148:149], v[66:67]
  v_pk_add_f32 v[150:151], v[150:151], v[68:69]
  s_waitcnt lgkmcnt(6)
  v_pk_add_f32 v[152:153], v[152:153], v[88:89]
  s_waitcnt lgkmcnt(5)
  v_pk_add_f32 v[144:145], v[144:145], v[70:71]
  v_pk_add_f32 v[146:147], v[146:147], v[72:73]
  s_waitcnt lgkmcnt(4)
  v_pk_add_f32 v[148:149], v[148:149], v[74:75]
  v_pk_add_f32 v[150:151], v[150:151], v[76:77]
  s_waitcnt lgkmcnt(3)
  v_pk_add_f32 v[152:153], v[152:153], v[90:91]
  s_waitcnt lgkmcnt(2)
  v_pk_add_f32 v[134:135], v[144:145], v[78:79]
  v_pk_add_f32 v[136:137], v[146:147], v[80:81]
  s_waitcnt lgkmcnt(1)
  v_pk_add_f32 v[138:139], v[148:149], v[82:83]
  v_pk_add_f32 v[140:141], v[150:151], v[84:85]
  s_waitcnt lgkmcnt(0)
  v_pk_add_f32 v[142:143], v[152:153], v[92:93]
  s_cmp_lg_u32 s3, 1
  s_cbranch_scc1 L_np_14
  s_load_dwordx16 s[64:79], s[32:33], s98 offset:128 glc
  s_load_dwordx16 s[80:95], s[32:33], s98 offset:192 glc
L_np_14:
  v_cvt_pk_bf16_f32 v30, v134, v135
  v_cvt_pk_bf16_f32 v31, v136, v137
  v_cvt_pk_bf16_f32 v32, v138, v139
  v_cvt_pk_bf16_f32 v33, v140, v141
  v_cvt_pk_bf16_f32 v40, v142, v143
  buffer_store_dwordx4 v[30:33], v26, s[32:35], s6 offen sc1
  buffer_store_dword v40, v27, s[32:35], s6 offen sc1
  v_pk_mul_f32 v[144:145], v[134:135], v[134:135]
  v_pk_add_f32 v[146:147], v[134:135], v[136:137]
  v_pk_fma_f32 v[144:145], v[136:137], v[136:137], v[144:145]
  v_pk_fma_f32 v[144:145], v[138:139], v[138:139], v[144:145]
  v_pk_add_f32 v[146:147], v[146:147], v[138:139]
  v_pk_fma_f32 v[144:145], v[140:141], v[140:141], v[144:145]
  v_pk_add_f32 v[146:147], v[146:147], v[140:141]
  v_pk_fma_f32 v[144:145], v[142:143], v[142:143], v[144:145]
  v_pk_add_f32 v[146:147], v[146:147], v[142:143]
  v_add_f32 v134, v146, v147
  v_add_f32 v144, v144, v145
  s_nop 1
  v_permlane16_swap_b32 v134, v144
  v_add_f32 v134, v134, v144
  s_nop 1
  v_add_f32_dpp v134, v134, v134 row_ror:8 row_mask:0xf bank_mask:0xf
  v_mov_b32 v144, v134
  s_nop 1
  v_permlane32_swap_b32 v134, v144
  v_add_f32 v134, v134, v144
  s_mov_b64 exec, 0x00ff00ff
  buffer_store_dword v134, v28, s[32:35], s21 offen sc1
  s_mov_b64 exec, -1
  s_add_u32 s6, s6, 40960
  s_add_u32 s21, s21, 2048
  s_add_u32 s62, s48, 5
  s_mov_b32 s63, s49
  s_waitcnt lgkmcnt(0)
  s_xor_b64 s[64:65], s[64:65], s[62:63]
  s_xor_b64 s[66:67], s[66:67], s[62:63]
  s_or_b64 s[64:65], s[64:65], s[66:67]
  s_xor_b64 s[68:69], s[68:69], s[62:63]
  s_or_b64 s[64:65], s[64:65], s[68:69]
  s_xor_b64 s[70:71], s[70:71], s[62:63]
  s_or_b64 s[64:65], s[64:65], s[70:71]
  s_xor_b64 s[72:73], s[72:73], s[62:63]
  s_or_b64 s[64:65], s[64:65], s[72:73]
  s_xor_b64 s[74:75], s[74:75], s[62:63]
  s_or_b64 s[64:65], s[64:65], s[74:75]
  s_xor_b64 s[76:77], s[76:77], s[62:63]
  s_or_b64 s[64:65], s[64:65], s[76:77]
  s_xor_b64 s[78:79], s[78:79], s[62:63]
  s_or_b64 s[64:65], s[64:65], s[78:79]
  s_xor_b64 s[80:81], s[80:81], s[62:63]
  s_or_b64 s[64:65], s[64:65], s[80:81]
  s_xor_b64 s[82:83], s[82:83], s[62:63]
  s_or_b64 s[64:65], s[64:65], s[82:83]
  s_xor_b64 s[84:85], s[84:85], s[62:63]
  s_or_b64 s[64:65], s[64:65], s[84:85]
  s_xor_b64 s[86:87], s[86:87], s[62:63]
  s_or_b64 s[64:65], s[64:65], s[86:87]
  s_xor_b64 s[88:89], s[88:89], s[62:63]
  s_or_b64 s[64:65], s[64:65], s[88:89]
  s_xor_b64 s[90:91], s[90:91], s[62:63]
  s_or_b64 s[64:65], s[64:65], s[90:91]
  s_xor_b64 s[92:93], s[92:93], s[62:63]
  s_or_b64 s[64:65], s[64:65], s[92:93]
  s_xor_b64 s[94:95], s[94:95], s[62:63]
  s_or_b64 s[64:65], s[64:65], s[94:95]
  s_add_u32 s96, s48, 4
  s_mov_b32 s97, 0
  s_waitcnt vmcnt(9)
  s_branch L_pchk_16
L_poll_15:
  buffer_load_dwordx2 v[94:95], v96, s[32:35], 0 offen sc1
  s_add_u32 s97, s97, 1
  s_waitcnt vmcnt(0)
L_pchk_16:
  v_subrev_u32 v94, s96, v94
  v_xor_b32 v95, s49, v95
  v_lshrrev_b32 v94, 4, v94
  v_or_b32 v94, v94, v95
  v_cmp_ne_u32 vcc, 0, v94
  s_nop 0
  s_cbranch_vccz L_pdone_17
  s_cmp_lt_u32 s97, 0x8000
  s_cbranch_scc1 L_poll_15
L_pdone_17:
  s_cmp_lg_u32 s3, 1
  s_cbranch_scc1 L_pdone_20
  s_mov_b32 s99, 0
  s_cmp_eq_u64 s[64:65], 0
  s_cbranch_scc1 L_pdone_20
L_poll_18:
  s_load_dwordx16 s[64:79], s[32:33], s98 offset:128 glc
  s_load_dwordx16 s[80:95], s[32:33], s98 offset:192 glc
  s_add_u32 s99, s99, 1
L_pchk_19:
  s_waitcnt lgkmcnt(0)
  s_xor_b64 s[64:65], s[64:65], s[62:63]
  s_xor_b64 s[66:67], s[66:67], s[62:63]
  s_or_b64 s[64:65], s[64:65], s[66:67]
  s_xor_b64 s[68:69], s[68:69], s[62:63]
  s_or_b64 s[64:65], s[64:65], s[68:69]
  s_xor_b64 s[70:71], s[70:71], s[62:63]
  s_or_b64 s[64:65], s[64:65], s[70:71]
  s_xor_b64 s[72:73], s[72:73], s[62:63]
  s_or_b64 s[64:65], s[64:65], s[72:73]
  s_xor_b64 s[74:75], s[74:75], s[62:63]
  s_or_b64 s[64:65], s[64:65], s[74:75]
  s_xor_b64 s[76:77], s[76:77], s[62:63]
  s_or_b64 s[64:65], s[64:65], s[76:77]
  s_xor_b64 s[78:79], s[78:79], s[62:63]
  s_or_b64 s[64:65], s[64:65], s[78:79]
  s_xor_b64 s[80:81], s[80:81], s[62:63]
  s_or_b64 s[64:65], s[64:65], s[80:81]
  s_xor_b64 s[82:83], s[82:83], s[62:63]
  s_or_b64 s[64:65], s[64:65], s[82:83]
  s_xor_b64 s[84:85], s[84:85], s[62:63]
  s_or_b64 s[64:65], s[64:65], s[84:85]
  s_xor_b64 s[86:87], s[86:87], s[62:63]
  s_or_b64 s[64:65], s[64:65], s[86:87]
  s_xor_b64 s[88:89], s[88:89], s[62:63]
  s_or_b64 s[64:65], s[64:65], s[88:89]
  s_xor_b64 s[90:91], s[90:91], s[62:63]
  s_or_b64 s[64:65], s[64:65], s[90:91]
  s_xor_b64 s[92:93], s[92:93], s[62:63]
  s_or_b64 s[64:65], s[64:65], s[92:93]
  s_xor_b64 s[94:95], s[94:95], s[62:63]
  s_or_b64 s[64:65], s[64:65], s[94:95]
  s_cbranch_scc0 L_pdone_20
  s_cmp_lt_u32 s99, 0x8000
  s_cbranch_scc1 L_poll_18
L_pdone_20:
  s_waitcnt vmcnt(9)
  s_barrier
  s_add_u32 s55, s5, 4096
  s_add_u32 s56, s5, 8192
  buffer_load_dwordx4 v[94:97], v20, s[32:35], s5 offen offset:0 sc1
  buffer_load_dwordx4 v[102:105], v20, s[32:35], s5 offen offset:2048 sc1
  buffer_load_dwordx4 v[110:113], v20, s[32:35], s55 offen offset:0 sc1
  buffer_load_dwordx4 v[118:121], v20, s[32:35], s55 offen offset:2048 sc1
  buffer_load_dwordx4 v[126:129], v20, s[32:35], s56 offen offset:0 sc1
  buffer_load_dwordx4 v[98:101], v20, s[32:35], s5 offen offset:256 sc1
  buffer_load_dwordx4 v[106:109], v20, s[32:35], s5 offen offset:2304 sc1
  buffer_load_dwordx4 v[114:117], v20, s[32:35], s55 offen offset:256 sc1
  buffer_load_dwordx4 v[122:125], v20, s[32:35], s55 offen offset:2304 sc1
  buffer_load_dwordx4 v[130:133], v20, s[32:35], s56 offen offset:256 sc1
  v_pk_mov_b32 v[42:43], 0, 0
  v_pk_mov_b32 v[44:45], 0, 0
  v_pk_mov_b32 v[46:47], 0, 0
  v_pk_mov_b32 v[48:49], 0, 0
  v_pk_mov_b32 v[50:51], 0, 0
  v_pk_mov_b32 v[52:53], 0, 0
  s_mul_i32 s55, s29, 40
  s_add_u32 s55, s55, s3
  s_lshl_b32 s55, s55, 8
  s_add_u32 s55, s55, 23330816
  v_lshlrev_b32 v4, 10, v7
  v_lshl_add_u32 v4, v13, 4, v4
  v_add_u32 v4, s55, v4
  ds_read_b64_tr_b16 a[192:193], v18 offset:24576
  ds_read_b64_tr_b16 a[194:195], v18 offset:25344
  ds_read_b64_tr_b16 a[196:197], v18 offset:36864
  ds_read_b64_tr_b16 a[198:199], v18 offset:37632
  ds_read_b64_tr_b16 a[200:201], v19 offset:24576
  ds_read_b64_tr_b16 a[202:203], v19 offset:25344
  ds_read_b64_tr_b16 a[204:205], v18 offset:30720
  ds_read_b64_tr_b16 a[206:207], v18 offset:31488
  ds_read_b64_tr_b16 a[208:209], v18 offset:43008
  ds_read_b64_tr_b16 a[210:211], v18 offset:43776
  ds_read_b64_tr_b16 a[212:213], v19 offset:30720
  ds_read_b64_tr_b16 a[214:215], v19 offset:31488
  v_add_u32 v18, 0xffff4000, v18
  v_add_u32 v19, 0xffff4000, v19
  s_waitcnt vmcnt(13)
  s_waitcnt vmcnt(10)
  s_barrier
  s_cmp_lg_u32 s3, 0
  s_cbranch_scc1 L_nf_21
  s_add_u32 s96, s48, 6
  v_mov_b32 v10, s96
  s_mov_b64 exec, 0xffff
  buffer_store_dwordx2 v[10:11], v12, s[32:35], s54 offen offset:256 sc1
  s_mov_b64 exec, -1
L_nf_21:
  ds_read_b64_tr_b16 a[216:217], v18 offset:0
  ds_read_b64_tr_b16 a[218:219], v18 offset:768
  ds_read_b64_tr_b16 a[220:221], v18 offset:12288
  ds_read_b64_tr_b16 a[222:223], v18 offset:13056
  ds_read_b64_tr_b16 a[224:225], v19 offset:0
  ds_read_b64_tr_b16 a[226:227], v19 offset:768
  ds_read_b64_tr_b16 a[228:229], v18 offset:6144
  ds_read_b64_tr_b16 a[230:231], v18 offset:6912
  ds_read_b64_tr_b16 a[232:233], v18 offset:18432
  ds_read_b64_tr_b16 a[234:235], v18 offset:19200
  ds_read_b64_tr_b16 a[236:237], v19 offset:6144
  ds_read_b64_tr_b16 a[238:239], v19 offset:6912
  s_waitcnt vmcnt(9)
  v_mfma_f32_16x16x32_bf16 v[54:57], v[156:159], v[94:97], 0
  buffer_load_dwordx4 a[240:243], v14, s[32:35], s18 offen offset:0 sc1
  s_waitcnt vmcnt(9)
  v_mfma_f32_16x16x32_bf16 v[54:57], v[176:179], v[102:105], v[54:57]
  s_waitcnt vmcnt(8)
  v_mfma_f32_16x16x32_bf16 v[54:57], v[196:199], v[110:113], v[54:57]
  buffer_load_dwordx4 a[244:247], v14, s[32:35], s18 offen offset:1024 sc1
  s_waitcnt vmcnt(8)
  v_mfma_f32_16x16x32_bf16 v[54:57], v[216:219], v[118:121], v[54:57]
  s_waitcnt vmcnt(7)
  v_mfma_f32_16x16x32_bf16 v[54:57], v[236:239], v[126:129], v[54:57]
  buffer_load_dwordx4 a[248:251], v14, s[32:35], s18 offen offset:2048 sc1
  v_mfma_f32_16x16x32_bf16 v[58:61], v[160:163], v[94:97], 0
  v_mfma_f32_16x16x32_bf16 v[58:61], v[180:183], v[102:105], v[58:61]
  buffer_load_dwordx4 a[252:255], v14, s[32:35], s18 offen offset:3072 sc1
  s_add_u32 s18, s18, 4096
  v_mfma_f32_16x16x32_bf16 v[58:61], v[200:203], v[110:113], v[58:61]
  v_mfma_f32_16x16x32_bf16 v[58:61], v[220:223], v[118:121], v[58:61]
  s_add_u32 m0, s10, 45056
  s_nop 0
  buffer_load_dwordx4 v14, s[32:35], s18 offen offset:0 sc1 lds
  v_mfma_f32_16x16x32_bf16 v[58:61], v[240:243], v[126:129], v[58:61]
  v_mfma_f32_16x16x32_bf16 v[62:65], v[164:167], v[94:97], 0
  s_add_u32 m0, s10, 48128
  s_nop 0
  buffer_load_dwordx4 v14, s[32:35], s18 offen offset:1024 sc1 lds
  ds_write_b128 v21, v[54:57] offset:0
  v_mfma_f32_16x16x32_bf16 v[62:65], v[184:187], v[102:105], v[62:65]
  v_mfma_f32_16x16x32_bf16 v[62:65], v[204:207], v[110:113], v[62:65]
  s_add_u32 m0, s10, 51200
  s_nop 0
  buffer_load_dwordx4 v14, s[32:35], s18 offen offset:2048 sc1 lds
  v_mfma_f32_16x16x32_bf16 v[62:65], v[224:227], v[118:121], v[62:65]
  v_mfma_f32_16x16x32_bf16 v[62:65], v[244:247], v[126:129], v[62:65]
  s_add_u32 m0, s10, 54272
  s_nop 0
  buffer_load_dwordx4 v14, s[32:35], s18 offen offset:3072 sc1 lds
  s_add_u32 s18, s18, 4096
  v_mfma_f32_16x16x32_bf16 v[66:69], v[168:171], v[94:97], 0
  ds_write_b128 v21, v[58:61] offset:64
  s_add_u32 m0, s10, 61440
  s_nop 0
  buffer_load_dwordx4 v14, s[32:35], s18 offen offset:0 sc1 lds
  v_mfma_f32_16x16x32_bf16 v[66:69], v[188:191], v[102:105], v[66:69]
  v_mfma_f32_16x16x32_bf16 v[66:69], v[208:211], v[110:113], v[66:69]
  s_mov_b32 exec_lo, 0x3ff03ff
  s_mov_b32 exec_hi, 0x3ff03ff
  buffer_load_dwordx4 v[42:45], v4, s[32:35], 0 offen offset:0 sc1
  buffer_load_dwordx4 v[46:49], v4, s[32:35], 0 offen offset:64 sc1
  buffer_load_dwordx4 v[50:53], v4, s[32:35], 0 offen offset:128 sc1
  s_mov_b64 exec, -1
  v_mfma_f32_16x16x32_bf16 v[66:69], v[228:231], v[118:121], v[66:69]
  v_mfma_f32_16x16x32_bf16 v[66:69], v[248:251], v[126:129], v[66:69]
  v_mfma_f32_16x16x32_bf16 v[70:73], v[172:175], v[94:97], 0
  ds_write_b128 v21, v[62:65] offset:128
  v_mfma_f32_16x16x32_bf16 v[70:73], v[192:195], v[102:105], v[70:73]
  v_mfma_f32_16x16x32_bf16 v[70:73], v[212:215], v[110:113], v[70:73]
  v_mfma_f32_16x16x32_bf16 v[70:73], v[232:235], v[118:121], v[70:73]
  v_mfma_f32_16x16x32_bf16 v[70:73], v[252:255], v[126:129], v[70:73]
  s_waitcnt vmcnt(16)
  v_mfma_f32_16x16x32_bf16 v[74:77], v[156:159], v[98:101], 0
  ds_write_b128 v21, v[66:69] offset:192
  s_waitcnt vmcnt(15)
  v_mfma_f32_16x16x32_bf16 v[74:77], v[176:179], v[106:109], v[74:77]
  s_waitcnt vmcnt(14)
  v_mfma_f32_16x16x32_bf16 v[74:77], v[196:199], v[114:117], v[74:77]
  s_waitcnt vmcnt(13)
  v_mfma_f32_16x16x32_bf16 v[74:77], v[216:219], v[122:125], v[74:77]
  s_waitcnt vmcnt(12)
  v_mfma_f32_16x16x32_bf16 v[74:77], v[236:239], v[130:133], v[74:77]
  v_mfma_f32_16x16x32_bf16 v[78:81], v[160:163], v[98:101], 0
  ds_write_b128 v21, v[70:73] offset:256
  s_cmp_lg_u32 s3, 1
  s_cbranch_scc1 L_np_22
  s_load_dwordx16 s[64:79], s[32:33], s31 offset:256 glc
  s_load_dwordx16 s[80:95], s[32:33], s31 offset:320 glc
L_np_22:
  v_mfma_f32_16x16x32_bf16 v[78:81], v[180:183], v[106:109], v[78:81]
  v_mfma_f32_16x16x32_bf16 v[78:81], v[200:203], v[114:117], v[78:81]
  v_mfma_f32_16x16x32_bf16 v[78:81], v[220:223], v[122:125], v[78:81]
  v_mfma_f32_16x16x32_bf16 v[78:81], v[240:243], v[130:133], v[78:81]
  v_mfma_f32_16x16x32_bf16 v[82:85], v[164:167], v[98:101], 0
  ds_write_b128 v21, v[74:77] offset:5632
  v_mfma_f32_16x16x32_bf16 v[82:85], v[184:187], v[106:109], v[82:85]
  v_mfma_f32_16x16x32_bf16 v[82:85], v[204:207], v[114:117], v[82:85]
  v_mfma_f32_16x16x32_bf16 v[82:85], v[224:227], v[122:125], v[82:85]
  v_mfma_f32_16x16x32_bf16 v[82:85], v[244:247], v[130:133], v[82:85]
  v_mfma_f32_16x16x32_bf16 v[86:89], v[168:171], v[98:101], 0
  s_nop 0
  ds_write_b128 v21, v[78:81] offset:5696
  v_mfma_f32_16x16x32_bf16 v[86:89], v[188:191], v[106:109], v[86:89]
  v_mfma_f32_16x16x32_bf16 v[86:89], v[208:211], v[114:117], v[86:89]
  v_mfma_f32_16x16x32_bf16 v[86:89], v[228:231], v[122:125], v[86:89]
  v_mfma_f32_16x16x32_bf16 v[86:89], v[248:251], v[130:133], v[86:89]
  v_mfma_f32_16x16x32_bf16 v[90:93], v[172:175], v[98:101], 0
  ds_write_b128 v21, v[82:85] offset:5760
  v_mfma_f32_16x16x32_bf16 v[90:93], v[192:195], v[106:109], v[90:93]
  v_mfma_f32_16x16x32_bf16 v[90:93], v[212:215], v[114:117], v[90:93]
  v_mfma_f32_16x16x32_bf16 v[90:93], v[232:235], v[122:125], v[90:93]
  v_mfma_f32_16x16x32_bf16 v[90:93], v[252:255], v[130:133], v[90:93]
  s_nop 1
  ds_write_b128 v21, v[86:89] offset:5824
  s_nop 4
  ds_write_b128 v21, v[90:93] offset:5888
  v_lshlrev_b32 v144, 16, v36
  v_and_b32 v145, 0xffff0000, v36
  v_lshlrev_b32 v146, 16, v37
  v_and_b32 v147, 0xffff0000, v37
  v_lshlrev_b32 v148, 16, v38
  v_and_b32 v149, 0xffff0000, v38
  v_lshlrev_b32 v150, 16, v39
  v_and_b32 v151, 0xffff0000, v39
  v_lshlrev_b32 v152, 16, v41
  v_and_b32 v153, 0xffff0000, v41
  s_cmp_lg_u32 s3, 1
  s_cbranch_scc1 L_pdone_25
  s_mov_b32 s99, 0
  s_add_u32 s62, s48, 6
  s_mov_b32 s63, s49
  s_branch L_pchk_24
L_poll_23:
  s_load_dwordx16 s[64:79], s[32:33], s31 offset:256 glc
  s_load_dwordx16 s[80:95], s[32:33], s31 offset:320 glc
  s_add_u32 s99, s99, 1
L_pchk_24:
  s_waitcnt lgkmcnt(0)
  s_xor_b64 s[64:65], s[64:65], s[62:63]
  s_xor_b64 s[66:67], s[66:67], s[62:63]
  s_or_b64 s[64:65], s[64:65], s[66:67]
  s_xor_b64 s[68:69], s[68:69], s[62:63]
  s_or_b64 s[64:65], s[64:65], s[68:69]
  s_xor_b64 s[70:71], s[70:71], s[62:63]
  s_or_b64 s[64:65], s[64:65], s[70:71]
  s_xor_b64 s[72:73], s[72:73], s[62:63]
  s_or_b64 s[64:65], s[64:65], s[72:73]
  s_xor_b64 s[74:75], s[74:75], s[62:63]
  s_or_b64 s[64:65], s[64:65], s[74:75]
  s_xor_b64 s[76:77], s[76:77], s[62:63]
  s_or_b64 s[64:65], s[64:65], s[76:77]
  s_xor_b64 s[78:79], s[78:79], s[62:63]
  s_or_b64 s[64:65], s[64:65], s[78:79]
  s_xor_b64 s[80:81], s[80:81], s[62:63]
  s_or_b64 s[64:65], s[64:65], s[80:81]
  s_xor_b64 s[82:83], s[82:83], s[62:63]
  s_or_b64 s[64:65], s[64:65], s[82:83]
  s_xor_b64 s[84:85], s[84:85], s[62:63]
  s_or_b64 s[64:65], s[64:65], s[84:85]
  s_xor_b64 s[86:87], s[86:87], s[62:63]
  s_or_b64 s[64:65], s[64:65], s[86:87]
  s_xor_b64 s[88:89], s[88:89], s[62:63]
  s_or_b64 s[64:65], s[64:65], s[88:89]
  s_xor_b64 s[90:91], s[90:91], s[62:63]
  s_or_b64 s[64:65], s[64:65], s[90:91]
  s_xor_b64 s[92:93], s[92:93], s[62:63]
  s_or_b64 s[64:65], s[64:65], s[92:93]
  s_xor_b64 s[94:95], s[94:95], s[62:63]
  s_or_b64 s[64:65], s[64:65], s[94:95]
  s_cbranch_scc0 L_pdone_25
  s_cmp_lt_u32 s99, 0x8000
  s_cbranch_scc1 L_poll_23
L_pdone_25:
  s_waitcnt lgkmcnt(0)
  s_barrier
  ds_read_b128 v[54:57], v22 offset:0
  ds_read_b128 v[58:61], v22 offset:32
  ds_read_b64 v[86:87], v23 offset:0
  ds_read_b128 v[62:65], v22 offset:11264
  ds_read_b128 v[66:69], v22 offset:11296
  ds_read_b64 v[88:89], v23 offset:11264
  ds_read_b128 v[70:73], v22 offset:22528
  ds_read_b128 v[74:77], v22 offset:22560
  ds_read_b64 v[90:91], v23 offset:22528
  ds_read_b128 v[78:81], v22 offset:33792
  ds_read_b128 v[82:85], v22 offset:33824
  ds_read_b64 v[92:93], v23 offset:33792
  s_add_u32 m0, s10, 81920
  s_nop 0
  buffer_load_dwordx4 v34, s[32:35], s24 offen sc1 lds
  s_add_u32 m0, s10, 86016
  s_nop 0
  buffer_load_dwordx4 v34, s[32:35], s25 offen sc1 lds
  s_add_u32 m0, s10, 90112
  s_nop 0
  buffer_load_dwordx4 v34, s[32:35], s26 offen sc1 lds
  s_add_u32 m0, s10, 94208
  s_nop 0
  buffer_load_dwordx4 v34, s[32:35], s27 offen sc1 lds
  s_add_u32 m0, s10, 98304
  s_nop 0
  buffer_load_dwordx4 v34, s[32:35], s52 offen sc1 lds
  s_add_u32 m0, s10, 102400
  s_nop 0
  buffer_load_dwordx4 v34, s[32:35], s53 offen sc1 lds
  s_waitcnt lgkmcnt(11)
  v_pk_add_f32 v[144:145], v[144:145], v[54:55]
  v_pk_add_f32 v[146:147], v[146:147], v[56:57]
  s_waitcnt lgkmcnt(10)
  v_pk_add_f32 v[148:149], v[148:149], v[58:59]
  v_pk_add_f32 v[150:151], v[150:151], v[60:61]
  s_waitcnt lgkmcnt(9)
  v_pk_add_f32 v[152:153], v[152:153], v[86:87]
  s_waitcnt lgkmcnt(8)
  v_pk_add_f32 v[144:145], v[144:145], v[62:63]
  v_pk_add_f32 v[146:147], v[146:147], v[64:65]
  s_waitcnt lgkmcnt(7)
  v_pk_add_f32 v[148:149], v[148:149], v[66:67]
  v_pk_add_f32 v[150:151], v[150:151], v[68:69]
  s_waitcnt lgkmcnt(6)
  v_pk_add_f32 v[152:153], v[152:153], v[88:89]
  s_waitcnt lgkmcnt(5)
  v_pk_add_f32 v[144:145], v[144:145], v[70:71]
  v_pk_add_f32 v[146:147], v[146:147], v[72:73]
  s_waitcnt lgkmcnt(4)
  v_pk_add_f32 v[148:149], v[148:149], v[74:75]
  v_pk_add_f32 v[150:151], v[150:151], v[76:77]
  s_waitcnt lgkmcnt(3)
  v_pk_add_f32 v[152:153], v[152:153], v[90:91]
  s_waitcnt lgkmcnt(2)
  v_pk_add_f32 v[134:135], v[144:145], v[78:79]
  v_pk_add_f32 v[136:137], v[146:147], v[80:81]
  s_waitcnt lgkmcnt(1)
  v_pk_add_f32 v[138:139], v[148:149], v[82:83]
  v_pk_add_f32 v[140:141], v[150:151], v[84:85]
  s_waitcnt lgkmcnt(0)
  v_pk_add_f32 v[142:143], v[152:153], v[92:93]
  v_cvt_pk_bf16_f32 v36, v134, v135
  v_cvt_pk_bf16_f32 v37, v136, v137
  v_cvt_pk_bf16_f32 v38, v138, v139
  v_cvt_pk_bf16_f32 v39, v140, v141
  v_cvt_pk_bf16_f32 v41, v142, v143
  buffer_store_dwordx4 v[36:39], v26, s[32:35], s6 offen sc1
  buffer_store_dword v41, v27, s[32:35], s6 offen sc1
  v_pk_mul_f32 v[144:145], v[134:135], v[134:135]
  v_pk_add_f32 v[146:147], v[134:135], v[136:137]
  v_pk_fma_f32 v[144:145], v[136:137], v[136:137], v[144:145]
  v_pk_fma_f32 v[144:145], v[138:139], v[138:139], v[144:145]
  v_pk_add_f32 v[146:147], v[146:147], v[138:139]
  v_pk_fma_f32 v[144:145], v[140:141], v[140:141], v[144:145]
  v_pk_add_f32 v[146:147], v[146:147], v[140:141]
  v_pk_fma_f32 v[144:145], v[142:143], v[142:143], v[144:145]
  v_pk_add_f32 v[146:147], v[146:147], v[142:143]
  v_add_f32 v134, v146, v147
  v_add_f32 v144, v144, v145
  s_nop 1
  v_permlane16_swap_b32 v134, v144
  v_add_f32 v134, v134, v144
  s_nop 1
  v_add_f32_dpp v134, v134, v134 row_ror:8 row_mask:0xf bank_mask:0xf
  v_mov_b32 v144, v134
  s_nop 1
  v_permlane32_swap_b32 v134, v144
  v_add_f32 v134, v134, v144
  s_mov_b64 exec, 0x00ff00ff
  buffer_store_dword v134, v28, s[32:35], s21 offen sc1
  s_mov_b64 exec, -1
  s_mov_b32 s40, 0
  s_mov_b32 s41, -1
  s_add_u32 s4, s13, 98304
  s_add_u32 m0, s10, 106496
  s_nop 0
  buffer_load_dwordx4 v34, s[32:35], s7 offen sc1 lds
  s_add_u32 m0, s10, 110592
  s_nop 0
  buffer_load_dwordx4 v34, s[32:35], s8 offen sc1 lds
  s_add_u32 m0, s10, 114688
  s_nop 0
  buffer_load_dwordx4 v34, s[32:35], s16 offen sc1 lds
  s_add_u32 m0, s10, 118784
  s_nop 0
  buffer_load_dwordx4 v34, s[32:35], s20 offen sc1 lds
  buffer_load_dwordx4 v[182:185], v14, s[32:35], s11 offen offset:0 sc1
  buffer_load_dwordx4 v[186:189], v14, s[32:35], s11 offen offset:1024 sc1
  buffer_load_dwordx4 v[190:193], v14, s[32:35], s9 offen offset:0 sc1
  buffer_load_dwordx4 v[194:197], v14, s[32:35], s9 offen offset:1024 sc1
  v_add_u32 v15, 81920, v20
  v_add_u32 v16, 122880, v20
  v_add_u32 v17, 0, v20
  v_add_u32 v18, 81920, v20
  v_add_u32 v6, s10, v14
  v_add_u32 v6, 16384, v6
  s_waitcnt vmcnt(14)
  s_barrier
  ds_read_b128 v[150:153], v15 offset:0
  ds_read_b128 v[154:157], v15 offset:256
  ds_read_b128 v[158:161], v15 offset:2048
  ds_read_b128 v[162:165], v15 offset:2304
  s_waitcnt lgkmcnt(0)
  v_mfma_f32_16x16x32_bf16 v[54:57], a[0:3], v[150:153], 0
  ds_read_b128 v[166:169], v15 offset:4096
  v_mfma_f32_16x16x32_bf16 v[58:61], a[4:7], v[150:153], 0
  ds_read_b128 v[170:173], v15 offset:4352
  v_mfma_f32_16x16x32_bf16 v[62:65], a[8:11], v[150:153], 0
  ds_read_b128 v[174:177], v15 offset:6144
  v_mfma_f32_16x16x32_bf16 v[66:69], a[0:3], v[154:157], 0
  ds_read_b128 v[178:181], v15 offset:6400
  v_mfma_f32_16x16x32_bf16 v[70:73], a[4:7], v[154:157], 0
  s_add_u32 m0, s10, 122880
  v_mfma_f32_16x16x32_bf16 v[74:77], a[8:11], v[154:157], 0
  buffer_load_dwordx4 v35, s[32:35], s24 offen sc1 lds
  v_mfma_f32_16x16x32_bf16 v[54:57], a[12:15], v[158:161], v[54:57]
  v_mfma_f32_16x16x32_bf16 v[58:61], a[16:19], v[158:161], v[58:61]
  s_add_u32 m0, s10, 126976
  v_mfma_f32_16x16x32_bf16 v[62:65], a[20:23], v[158:161], v[62:65]
  buffer_load_dwordx4 v35, s[32:35], s25 offen sc1 lds
  v_mfma_f32_16x16x32_bf16 v[66:69], a[12:15], v[162:165], v[66:69]
  v_mfma_f32_16x16x32_bf16 v[70:73], a[16:19], v[162:165], v[70:73]
  s_add_u32 m0, s10, 131072
  v_mfma_f32_16x16x32_bf16 v[74:77], a[20:23], v[162:165], v[74:77]
  buffer_load_dwordx4 v35, s[32:35], s26 offen sc1 lds
  s_waitcnt lgkmcnt(0)
  v_mfma_f32_16x16x32_bf16 v[54:57], a[24:27], v[166:169], v[54:57]
  ds_read_b128 v[150:153], v15 offset:8192
  v_add_f32_dpp v42, v42, v42 row_ror:8 row_mask:0xf bank_mask:0xf
  v_add_f32_dpp v43, v43, v43 row_ror:8 row_mask:0xf bank_mask:0xf
  v_mfma_f32_16x16x32_bf16 v[58:61], a[28:31], v[166:169], v[58:61]
  ds_read_b128 v[154:157], v15 offset:8448
  v_add_f32_dpp v44, v44, v44 row_ror:8 row_mask:0xf bank_mask:0xf
  v_add_f32_dpp v45, v45, v45 row_ror:8 row_mask:0xf bank_mask:0xf
  v_mfma_f32_16x16x32_bf16 v[62:65], a[32:35], v[166:169], v[62:65]
  ds_read_b128 v[158:161], v15 offset:10240
  v_add_f32_dpp v46, v46, v46 row_ror:8 row_mask:0xf bank_mask:0xf
  v_add_f32_dpp v47, v47, v47 row_ror:8 row_mask:0xf bank_mask:0xf
  v_mfma_f32_16x16x32_bf16 v[66:69], a[24:27], v[170:173], v[66:69]
  ds_read_b128 v[162:165], v15 offset:10496
  v_add_f32_dpp v48, v48, v48 row_ror:8 row_mask:0xf bank_mask:0xf
  v_add_f32_dpp v49, v49, v49 row_ror:8 row_mask:0xf bank_mask:0xf
  v_mfma_f32_16x16x32_bf16 v[70:73], a[28:31], v[170:173], v[70:73]
  s_add_u32 m0, s10, 135168
  v_add_f32_dpp v50, v50, v50 row_ror:8 row_mask:0xf bank_mask:0xf
  v_mfma_f32_16x16x32_bf16 v[74:77], a[32:35], v[170:173], v[74:77]
  buffer_load_dwordx4 v35, s[32:35], s27 offen sc1 lds
  v_mfma_f32_16x16x32_bf16 v[54:57], a[36:39], v[174:177], v[54:57]
  v_add_f32_dpp v51, v51, v51 row_ror:8 row_mask:0xf bank_mask:0xf
  v_add_f32_dpp v52, v52, v52 row_ror:8 row_mask:0xf bank_mask:0xf
  v_mfma_f32_16x16x32_bf16 v[58:61], a[40:43], v[174:177], v[58:61]
  s_add_u32 m0, s10, 139264
  v_add_f32_dpp v53, v53, v53 row_ror:8 row_mask:0xf bank_mask:0xf
  v_mfma_f32_16x16x32_bf16 v[62:65], a[44:47], v[174:177], v[62:65]
  buffer_load_dwordx4 v35, s[32:35], s52 offen sc1 lds
  v_mfma_f32_16x16x32_bf16 v[66:69], a[36:39], v[178:181], v[66:69]
  v_add_f32_dpp v42, v42, v42 row_ror:4 row_mask:0xf bank_mask:0xf
  v_add_f32_dpp v43, v43, v43 row_ror:4 row_mask:0xf bank_mask:0xf
  v_mfma_f32_16x16x32_bf16 v[70:73], a[40:43], v[178:181], v[70:73]
  s_add_u32 m0, s10, 143360
  v_add_f32_dpp v44, v44, v44 row_ror:4 row_mask:0xf bank_mask:0xf
  v_mfma_f32_16x16x32_bf16 v[74:77], a[44:47], v[178:181], v[74:77]
  buffer_load_dwordx4 v35, s[32:35], s53 offen sc1 lds
  s_waitcnt vmcnt(17)
  s_waitcnt vmcnt(14)
  s_barrier
  s_cmp_lg_u32 s3, 0
  s_cbranch_scc1 L_nf_26
  s_add_u32 s96, s48, 7
  v_mov_b32 v10, s96
  s_mov_b64 exec, 0xffff
  buffer_store_dwordx2 v[10:11], v12, s[32:35], s54 offen offset:384 sc1
  s_mov_b64 exec, -1
L_nf_26:
  s_waitcnt lgkmcnt(0)
  v_mfma_f32_16x16x32_bf16 v[54:57], a[48:51], v[150:153], v[54:57]
  ds_read_b128 v[166:169], v15 offset:12288
  v_add_f32_dpp v45, v45, v45 row_ror:4 row_mask:0xf bank_mask:0xf
  v_add_f32_dpp v46, v46, v46 row_ror:4 row_mask:0xf bank_mask:0xf
  v_mfma_f32_16x16x32_bf16 v[58:61], a[52:55], v[150:153], v[58:61]
  ds_read_b128 v[170:173], v15 offset:12544
  v_add_f32_dpp v47, v47, v47 row_ror:4 row_mask:0xf bank_mask:0xf
  v_add_f32_dpp v48, v48, v48 row_ror:4 row_mask:0xf bank_mask:0xf
  v_mfma_f32_16x16x32_bf16 v[62:65], a[56:59], v[150:153], v[62:65]
  ds_read_b128 v[174:177], v15 offset:14336
  v_add_f32_dpp v49, v49, v49 row_ror:4 row_mask:0xf bank_mask:0xf
  v_add_f32_dpp v50, v50, v50 row_ror:4 row_mask:0xf bank_mask:0xf
  v_mfma_f32_16x16x32_bf16 v[66:69], a[48:51], v[154:157], v[66:69]
  ds_read_b128 v[178:181], v15 offset:14592
  v_add_f32_dpp v51, v51, v51 row_ror:4 row_mask:0xf bank_mask:0xf
  v_add_f32_dpp v52, v52, v52 row_ror:4 row_mask:0xf bank_mask:0xf
  v_mfma_f32_16x16x32_bf16 v[70:73], a[52:55], v[154:157], v[70:73]
  s_add_u32 m0, s10, 147456
  v_add_f32_dpp v53, v53, v53 row_ror:4 row_mask:0xf bank_mask:0xf
  v_mfma_f32_16x16x32_bf16 v[74:77], a[56:59], v[154:157], v[74:77]
  buffer_load_dwordx4 v35, s[32:35], s7 offen sc1 lds
  v_mfma_f32_16x16x32_bf16 v[54:57], a[60:63], v[158:161], v[54:57]
  v_add_f32_dpp v42, v42, v42 row_ror:2 row_mask:0xf bank_mask:0xf
  v_add_f32_dpp v43, v43, v43 row_ror:2 row_mask:0xf bank_mask:0xf
  v_mfma_f32_16x16x32_bf16 v[58:61], a[64:67], v[158:161], v[58:61]
  s_add_u32 m0, s10, 151552
  v_add_f32_dpp v44, v44, v44 row_ror:2 row_mask:0xf bank_mask:0xf
  v_mfma_f32_16x16x32_bf16 v[62:65], a[68:71], v[158:161], v[62:65]
  buffer_load_dwordx4 v35, s[32:35], s8 offen sc1 lds
  v_mfma_f32_16x16x32_bf16 v[66:69], a[60:63], v[162:165], v[66:69]
  v_add_f32_dpp v45, v45, v45 row_ror:2 row_mask:0xf bank_mask:0xf
  v_add_f32_dpp v46, v46, v46 row_ror:2 row_mask:0xf bank_mask:0xf
  v_mfma_f32_16x16x32_bf16 v[70:73], a[64:67], v[162:165], v[70:73]
  s_add_u32 m0, s10, 155648
  v_add_f32_dpp v47, v47, v47 row_ror:2 row_mask:0xf bank_mask:0xf
  v_mfma_f32_16x16x32_bf16 v[74:77], a[68:71], v[162:165], v[74:77]
  buffer_load_dwordx4 v35, s[32:35], s16 offen sc1 lds
  s_waitcnt lgkmcnt(0)
  v_mfma_f32_16x16x32_bf16 v[54:57], a[72:75], v[166:169], v[54:57]
  ds_read_b128 v[150:153], v15 offset:16384
  v_add_f32_dpp v48, v48, v48 row_ror:2 row_mask:0xf bank_mask:0xf
  v_add_f32_dpp v49, v49, v49 row_ror:2 row_mask:0xf bank_mask:0xf
  v_mfma_f32_16x16x32_bf16 v[58:61], a[76:79], v[166:169], v[58:61]
  ds_read_b128 v[154:157], v15 offset:16640
  v_add_f32_dpp v50, v50, v50 row_ror:2 row_mask:0xf bank_mask:0xf
  v_add_f32_dpp v51, v51, v51 row_ror:2 row_mask:0xf bank_mask:0xf
  v_mfma_f32_16x16x32_bf16 v[62:65], a[80:83], v[166:169], v[62:65]
  ds_read_b128 v[158:161], v15 offset:18432
  v_add_f32_dpp v52, v52, v52 row_ror:2 row_mask:0xf bank_mask:0xf
  v_add_f32_dpp v53, v53, v53 row_ror:2 row_mask:0xf bank_mask:0xf
  v_mfma_f32_16x16x32_bf16 v[66:69], a[72:75], v[170:173], v[66:69]
  ds_read_b128 v[162:165], v15 offset:18688
  v_add_f32_dpp v42, v42, v42 row_ror:1 row_mask:0xf bank_mask:0xf
  v_add_f32_dpp v43, v43, v43 row_ror:1 row_mask:0xf bank_mask:0xf
  v_mfma_f32_16x16x32_bf16 v[70:73], a[76:79], v[170:173], v[70:73]
  s_add_u32 m0, s10, 159744
  v_add_f32_dpp v44, v44, v44 row_ror:1 row_mask:0xf bank_mask:0xf
  v_mfma_f32_16x16x32_bf16 v[74:77], a[80:83], v[170:173], v[74:77]
  buffer_load_dwordx4 v35, s[32:35], s20 offen sc1 lds
  v_mfma_f32_16x16x32_bf16 v[54:57], a[84:87], v[174:177], v[54:57]
  v_add_f32_dpp v45, v45, v45 row_ror:1 row_mask:0xf bank_mask:0xf
  v_add_f32_dpp v46, v46, v46 row_ror:1 row_mask:0xf bank_mask:0xf
  v_mfma_f32_16x16x32_bf16 v[58:61], a[88:91], v[174:177], v[58:61]
  s_add_u32 m0, s10, 64512
  v_add_f32_dpp v47, v47, v47 row_ror:1 row_mask:0xf bank_mask:0xf
  v_mfma_f32_16x16x32_bf16 v[62:65], a[92:95], v[174:177], v[62:65]
  buffer_load_dwordx4 v14, s[32:35], s18 offen offset:1024 sc1 lds
  v_mfma_f32_16x16x32_bf16 v[66:69], a[84:87], v[178:181], v[66:69]
  v_add_f32_dpp v48, v48, v48 row_ror:1 row_mask:0xf bank_mask:0xf
  v_add_f32_dpp v49, v49, v49 row_ror:1 row_mask:0xf bank_mask:0xf
  v_mfma_f32_16x16x32_bf16 v[70:73], a[88:91], v[178:181], v[70:73]
  s_add_u32 m0, s10, 67584
  v_add_f32_dpp v50, v50, v50 row_ror:1 row_mask:0xf bank_mask:0xf
  v_mfma_f32_16x16x32_bf16 v[74:77], a[92:95], v[178:181], v[74:77]
  buffer_load_dwordx4 v14, s[32:35], s18 offen offset:2048 sc1 lds
  s_waitcnt lgkmcnt(0)
  v_mfma_f32_16x16x32_bf16 v[54:57], a[96:99], v[150:153], v[54:57]
  ds_read_b128 v[166:169], v15 offset:20480
  v_add_f32_dpp v51, v51, v51 row_ror:1 row_mask:0xf bank_mask:0xf
  v_add_f32_dpp v52, v52, v52 row_ror:1 row_mask:0xf bank_mask:0xf
  v_mfma_f32_16x16x32_bf16 v[58:61], a[100:103], v[150:153], v[58:61]
  ds_read_b128 v[170:173], v15 offset:20736
  v_add_f32_dpp v53, v53, v53 row_ror:1 row_mask:0xf bank_mask:0xf
  v_mfma_f32_16x16x32_bf16 v[62:65], a[104:107], v[150:153], v[62:65]
  ds_read_b128 v[174:177], v15 offset:22528
  v_mfma_f32_16x16x32_bf16 v[66:69], a[96:99], v[154:157], v[66:69]
  ds_read_b128 v[178:181], v15 offset:22784
  v_mfma_f32_16x16x32_bf16 v[70:73], a[100:103], v[154:157], v[70:73]
  s_add_u32 m0, s10, 70656
  v_mfma_f32_16x16x32_bf16 v[74:77], a[104:107], v[154:157], v[74:77]
  buffer_load_dwordx4 v14, s[32:35], s18 offen offset:3072 sc1 lds
  s_add_u32 s18, s18, 4096
  v_mfma_f32_16x16x32_bf16 v[54:57], a[108:111], v[158:161], v[54:57]
  v_mfma_f32_16x16x32_bf16 v[58:61], a[112:115], v[158:161], v[58:61]
  s_add_u32 m0, s10, 77824
  v_mfma_f32_16x16x32_bf16 v[62:65], a[116:119], v[158:161], v[62:65]
  buffer_load_dwordx4 v14, s[32:35], s18 offen offset:0 sc1 lds
  v_mfma_f32_16x16x32_bf16 v[66:69], a[108:111], v[162:165], v[66:69]
  v_mfma_f32_16x16x32_bf16 v[70:73], a[112:115], v[162:165], v[70:73]
  s_add_u32 m0, s10, 39936
  v_mfma_f32_16x16x32_bf16 v[74:77], a[116:119], v[162:165], v[74:77]
  buffer_load_dwordx4 v14, s[32:35], s18 offen offset:1024 sc1 lds
  s_waitcnt vmcnt(19)
  s_barrier
  s_waitcnt lgkmcnt(0)
  v_mfma_f32_16x16x32_bf16 v[54:57], a[120:123], v[166:169], v[54:57]
  ds_read_b128 v[150:153], v15 offset:24576
  s_waitcnt vmcnt(18)
  v_add_f32 v182, v182, v184
  v_add_f32 v183, v183, v185
  v_mfma_f32_16x16x32_bf16 v[58:61], a[124:127], v[166:169], v[58:61]
  ds_read_b128 v[154:157], v15 offset:24832
  s_waitcnt vmcnt(17)
  v_add_f32 v186, v186, v188
  v_add_f32 v187, v187, v189
  v_mfma_f32_16x16x32_bf16 v[62:65], a[128:131], v[166:169], v[62:65]
  ds_read_b128 v[158:161], v15 offset:26624
  s_waitcnt vmcnt(16)
  v_add_f32 v190, v190, v192
  v_add_f32 v191, v191, v193
  v_mfma_f32_16x16x32_bf16 v[66:69], a[120:123], v[170:173], v[66:69]
  ds_read_b128 v[162:165], v15 offset:26880
  s_waitcnt vmcnt(15)
  v_add_f32 v194, v194, v196
  v_add_f32 v195, v195, v197
  v_mfma_f32_16x16x32_bf16 v[70:73], a[124:127], v[170:173], v[70:73]
  v_permlane32_swap_b32 v182, v190
  v_permlane32_swap_b32 v186, v194
  v_mfma_f32_16x16x32_bf16 v[74:77], a[128:131], v[170:173], v[74:77]
  v_permlane32_swap_b32 v183, v191
  v_permlane32_swap_b32 v187, v195
  v_mfma_f32_16x16x32_bf16 v[54:57], a[132:135], v[174:177], v[54:57]
  v_add_f32 v182, v182, v190
  v_add_f32 v186, v186, v194
  v_mfma_f32_16x16x32_bf16 v[58:61], a[136:139], v[174:177], v[58:61]
  v_add_f32 v183, v183, v191
  v_add_f32 v187, v187, v195
  v_mfma_f32_16x16x32_bf16 v[62:65], a[140:143], v[174:177], v[62:65]
  v_permlane16_swap_b32 v182, v186
  v_permlane16_swap_b32 v183, v187
  v_mfma_f32_16x16x32_bf16 v[66:69], a[132:135], v[178:181], v[66:69]
  v_add_f32 v182, v182, v186
  v_add_f32 v183, v183, v187
  v_mfma_f32_16x16x32_bf16 v[70:73], a[136:139], v[178:181], v[70:73]
  v_mul_f32 v198, 0xbacccccd, v182
  v_mul_f32 v183, 0x3acccccd, v183
  v_mfma_f32_16x16x32_bf16 v[74:77], a[140:143], v[178:181], v[74:77]
  v_fma_f32 v183, -v198, v198, v183
  s_waitcnt lgkmcnt(0)
  v_mfma_f32_16x16x32_bf16 v[54:57], a[144:147], v[150:153], v[54:57]
  ds_read_b128 v[166:169], v15 offset:28672
  v_add_f32 v206, 0x3727c5ac, v183
  v_mov_b32 v199, v198
  v_mfma_f32_16x16x32_bf16 v[58:61], a[148:151], v[150:153], v[58:61]
  ds_read_b128 v[170:173], v15 offset:28928
  v_rsq_f32 v182, v206
  v_mfma_f32_16x16x32_bf16 v[62:65], a[152:155], v[150:153], v[62:65]
  ds_read_b128 v[174:177], v15 offset:30720
  v_mov_b32 v200, v198
  v_mov_b32 v201, v198
  v_mfma_f32_16x16x32_bf16 v[66:69], a[144:147], v[154:157], v[66:69]
  ds_read_b128 v[178:181], v15 offset:30976
  v_mov_b32 v207, v206
  v_mov_b32 v208, v206
  v_mfma_f32_16x16x32_bf16 v[70:73], a[148:151], v[154:157], v[70:73]
  v_mov_b32 v209, v206
  v_mul_f32 v202, 0xbfb8aa3b, v182
  v_mfma_f32_16x16x32_bf16 v[74:77], a[152:155], v[154:157], v[74:77]
  v_mul_f32 v203, 0xbfb8aa3b, v182
  v_mul_f32 v204, 0xbfb8aa3b, v182
  v_mfma_f32_16x16x32_bf16 v[54:57], a[156:159], v[158:161], v[54:57]
  v_mul_f32 v205, 0xbfb8aa3b, v182
  v_permlane32_swap_b32 v198, v200
  v_mfma_f32_16x16x32_bf16 v[58:61], a[160:163], v[158:161], v[58:61]
  v_permlane32_swap_b32 v199, v201
  v_permlane32_swap_b32 v206, v208
  v_mfma_f32_16x16x32_bf16 v[62:65], a[164:167], v[158:161], v[62:65]
  v_permlane16_swap_b32 v198, v199
  v_permlane16_swap_b32 v200, v201
  v_mfma_f32_16x16x32_bf16 v[66:69], a[156:159], v[162:165], v[66:69]
  v_permlane32_swap_b32 v207, v209
  v_permlane32_swap_b32 v202, v204
  v_mfma_f32_16x16x32_bf16 v[70:73], a[160:163], v[162:165], v[70:73]
  v_permlane16_swap_b32 v206, v207
  v_permlane16_swap_b32 v208, v209
  v_mfma_f32_16x16x32_bf16 v[74:77], a[164:167], v[162:165], v[74:77]
  v_permlane32_swap_b32 v203, v205
  s_cmp_lg_u32 s3, 1
  s_cbranch_scc1 L_np_27
  v_lshlrev_b32 v8, 3, v7
  buffer_load_dwordx2 v[8:9], v8, s[32:35], s31 offen offset:384 sc1
L_np_27:
  s_waitcnt lgkmcnt(0)
  v_mfma_f32_16x16x32_bf16 v[54:57], a[168:171], v[166:169], v[54:57]
  ds_read_b128 v[150:153], v15 offset:32768
  v_permlane16_swap_b32 v202, v203
  v_permlane16_swap_b32 v204, v205
  v_mfma_f32_16x16x32_bf16 v[58:61], a[172:175], v[166:169], v[58:61]
  ds_read_b128 v[154:157], v15 offset:33024
  v_cndmask_b32 v212, v206, v207, s[40:41]
  v_cndmask_b32 v213, v208, v209, s[40:41]
  v_mfma_f32_16x16x32_bf16 v[62:65], a[176:179], v[166:169], v[62:65]
  ds_read_b128 v[158:161], v15 offset:34816
  v_cndmask_b32 v210, v202, v203, s[40:41]
  v_cndmask_b32 v211, v204, v205, s[40:41]
  v_mfma_f32_16x16x32_bf16 v[66:69], a[168:171], v[170:173], v[66:69]
  ds_read_b128 v[162:165], v15 offset:35072
  v_mfma_f32_16x16x32_bf16 v[70:73], a[172:175], v[170:173], v[70:73]
  v_mfma_f32_16x16x32_bf16 v[74:77], a[176:179], v[170:173], v[74:77]
  v_mfma_f32_16x16x32_bf16 v[54:57], a[180:183], v[174:177], v[54:57]
  v_mfma_f32_16x16x32_bf16 v[58:61], a[184:187], v[174:177], v[58:61]
  v_mfma_f32_16x16x32_bf16 v[62:65], a[188:191], v[174:177], v[62:65]
  v_mfma_f32_16x16x32_bf16 v[66:69], a[180:183], v[178:181], v[66:69]
  v_mfma_f32_16x16x32_bf16 v[70:73], a[184:187], v[178:181], v[70:73]
  v_mfma_f32_16x16x32_bf16 v[74:77], a[188:191], v[178:181], v[74:77]
  s_waitcnt lgkmcnt(0)
  v_mfma_f32_16x16x32_bf16 v[54:57], a[192:195], v[150:153], v[54:57]
  ds_read_b128 v[166:169], v15 offset:36864
  v_mfma_f32_16x16x32_bf16 v[58:61], a[196:199], v[150:153], v[58:61]
  ds_read_b128 v[170:173], v15 offset:37120
  v_mfma_f32_16x16x32_bf16 v[62:65], a[200:203], v[150:153], v[62:65]
  ds_read_b128 v[174:177], v15 offset:38912
  v_mfma_f32_16x16x32_bf16 v[66:69], a[192:195], v[154:157], v[66:69]
  ds_read_b128 v[178:181], v15 offset:39168
  v_mfma_f32_16x16x32_bf16 v[70:73], a[196:199], v[154:157], v[70:73]
  v_mfma_f32_16x16x32_bf16 v[74:77], a[200:203], v[154:157], v[74:77]
  v_mfma_f32_16x16x32_bf16 v[54:57], a[204:207], v[158:161], v[54:57]
  v_mfma_f32_16x16x32_bf16 v[58:61], a[208:211], v[158:161], v[58:61]
  v_mfma_f32_16x16x32_bf16 v[62:65], a[212:215], v[158:161], v[62:65]
  v_mfma_f32_16x16x32_bf16 v[66:69], a[204:207], v[162:165], v[66:69]
  v_mfma_f32_16x16x32_bf16 v[70:73], a[208:211], v[162:165], v[70:73]
  v_mfma_f32_16x16x32_bf16 v[74:77], a[212:215], v[162:165], v[74:77]
  s_waitcnt vmcnt(10)
  s_barrier
  s_or_b32 s55, s2, s3
  s_cbranch_scc1 L_nb3
  s_add_u32 s55, s48, 16
  v_mov_b32 v236, s55
  s_mov_b32 s55, 32768
  s_mov_b64 exec, 1
  buffer_store_dword v236, off, s[32:35], s55 sc1
  s_mov_b64 exec, -1
L_nb3:
  s_waitcnt lgkmcnt(0)
  v_mfma_f32_16x16x32_bf16 v[54:57], a[216:219], v[166:169], v[54:57]
  ds_read_b128 v[150:153], v16 offset:0
  v_mfma_f32_16x16x32_bf16 v[58:61], a[220:223], v[166:169], v[58:61]
  ds_read_b128 v[154:157], v16 offset:256
  v_mfma_f32_16x16x32_bf16 v[62:65], a[224:227], v[166:169], v[62:65]
  ds_read_b128 v[158:161], v16 offset:2048
  v_mfma_f32_16x16x32_bf16 v[66:69], a[216:219], v[170:173], v[66:69]
  ds_read_b128 v[162:165], v16 offset:2304
  v_mfma_f32_16x16x32_bf16 v[70:73], a[220:223], v[170:173], v[70:73]
  v_mfma_f32_16x16x32_bf16 v[74:77], a[224:227], v[170:173], v[74:77]
  v_mfma_f32_16x16x32_bf16 v[54:57], a[228:231], v[174:177], v[54:57]
  v_mfma_f32_16x16x32_bf16 v[58:61], a[232:235], v[174:177], v[58:61]
  v_mfma_f32_16x16x32_bf16 v[62:65], a[236:239], v[174:177], v[62:65]
  v_mfma_f32_16x16x32_bf16 v[66:69], a[228:231], v[178:181], v[66:69]
  v_mfma_f32_16x16x32_bf16 v[70:73], a[232:235], v[178:181], v[70:73]
  v_mfma_f32_16x16x32_bf16 v[74:77], a[236:239], v[178:181], v[74:77]
  s_cmp_lg_u32 s3, 1
  s_cbranch_scc1 L_pdone_30
  s_add_u32 s96, s48, 7
  s_mov_b32 s97, 0
  s_waitcnt vmcnt(0)
  s_branch L_pchk_29
L_poll_28:
  v_lshlrev_b32 v8, 3, v7
  buffer_load_dwordx2 v[8:9], v8, s[32:35], s31 offen offset:384 sc1
  s_add_u32 s97, s97, 1
  s_waitcnt vmcnt(0)
L_pchk_29:
  v_subrev_u32 v8, s96, v8
  v_xor_b32 v9, s49, v9
  v_lshrrev_b32 v8, 4, v8
  v_or_b32 v8, v8, v9
  v_cmp_ne_u32 vcc, 0, v8
  s_nop 0
  s_cbranch_vccz L_pdone_30
  s_cmp_lt_u32 s97, 0x8000
  s_cbranch_scc1 L_poll_28
L_pdone_30:
  s_barrier
  s_waitcnt lgkmcnt(0)
  v_mfma_f32_16x16x32_bf16 v[78:81], a[0:3], v[150:153], 0
  ds_read_b128 v[166:169], v16 offset:4096
  v_fma_f32 v62, v198, v50, v62
  v_fma_f32 v63, v198, v51, v63
  v_mfma_f32_16x16x32_bf16 v[82:85], a[4:7], v[150:153], 0
  ds_read_b128 v[170:173], v16 offset:4352
  v_fma_f32 v64, v198, v52, v64
  v_fma_f32 v65, v198, v53, v65
  v_mfma_f32_16x16x32_bf16 v[86:89], a[8:11], v[150:153], 0
  ds_read_b128 v[174:177], v16 offset:6144
  v_fma_f32 v74, v199, v50, v74
  v_fma_f32 v75, v199, v51, v75
  v_mfma_f32_16x16x32_bf16 v[90:93], a[0:3], v[154:157], 0
  ds_read_b128 v[178:181], v16 offset:6400
  v_fma_f32 v76, v199, v52, v76
  v_fma_f32 v77, v199, v53, v77
  v_mfma_f32_16x16x32_bf16 v[94:97], a[4:7], v[154:157], 0
  s_add_u32 m0, s10, 0
  v_fma_f32 v54, v198, v42, v54
  v_mfma_f32_16x16x32_bf16 v[98:101], a[8:11], v[154:157], 0
  v_add_u32 v34, 40960, v34
  v_add_u32 v35, 40960, v35
  buffer_load_dwordx4 v34, s[32:35], s24 offen sc1 lds
  v_mfma_f32_16x16x32_bf16 v[78:81], a[12:15], v[158:161], v[78:81]
  v_fma_f32 v55, v198, v43, v55
  v_fma_f32 v56, v198, v44, v56
  v_mfma_f32_16x16x32_bf16 v[82:85], a[16:19], v[158:161], v[82:85]
  s_add_u32 m0, s10, 81920
  v_fma_f32 v57, v198, v45, v57
  v_mfma_f32_16x16x32_bf16 v[86:89], a[20:23], v[158:161], v[86:89]
  buffer_load_dwordx4 v35, s[32:35], s24 offen sc1 lds
  v_mfma_f32_16x16x32_bf16 v[90:93], a[12:15], v[162:165], v[90:93]
  v_fma_f32 v58, v198, v46, v58
  v_fma_f32 v59, v198, v47, v59
  v_mfma_f32_16x16x32_bf16 v[94:97], a[16:19], v[162:165], v[94:97]
  s_add_u32 m0, s10, 4096
  v_fma_f32 v60, v198, v48, v60
  v_mfma_f32_16x16x32_bf16 v[98:101], a[20:23], v[162:165], v[98:101]
  buffer_load_dwordx4 v34, s[32:35], s25 offen sc1 lds
  s_waitcnt lgkmcnt(0)
  v_mfma_f32_16x16x32_bf16 v[78:81], a[24:27], v[166:169], v[78:81]
  ds_read_b128 v[150:153], v16 offset:8192
  v_fma_f32 v61, v198, v49, v61
  v_permlane32_swap_b32 v62, v74
  v_mfma_f32_16x16x32_bf16 v[82:85], a[28:31], v[166:169], v[82:85]
  ds_read_b128 v[154:157], v16 offset:8448
  v_permlane32_swap_b32 v63, v75
  v_permlane32_swap_b32 v64, v76
  v_mfma_f32_16x16x32_bf16 v[86:89], a[32:35], v[166:169], v[86:89]
  ds_read_b128 v[158:161], v16 offset:10240
  v_permlane32_swap_b32 v65, v77
  v_mul_f32 v242, v202, v54
  v_mfma_f32_16x16x32_bf16 v[90:93], a[24:27], v[170:173], v[90:93]
  ds_read_b128 v[162:165], v16 offset:10496
  v_mul_f32 v243, v202, v55
  v_mul_f32 v244, v202, v56
  v_mfma_f32_16x16x32_bf16 v[94:97], a[28:31], v[170:173], v[94:97]
  s_add_u32 m0, s10, 86016
  v_mul_f32 v245, v202, v57
  v_mfma_f32_16x16x32_bf16 v[98:101], a[32:35], v[170:173], v[98:101]
  buffer_load_dwordx4 v35, s[32:35], s25 offen sc1 lds
  v_mfma_f32_16x16x32_bf16 v[78:81], a[36:39], v[174:177], v[78:81]
  v_exp_f32 v242, v242
  v_mfma_f32_16x16x32_bf16 v[82:85], a[40:43], v[174:177], v[82:85]
  s_add_u32 m0, s10, 8192
  v_mul_f32 v54, v54, v58
  v_mfma_f32_16x16x32_bf16 v[86:89], a[44:47], v[174:177], v[86:89]
  buffer_load_dwordx4 v34, s[32:35], s26 offen sc1 lds
  v_mfma_f32_16x16x32_bf16 v[90:93], a[36:39], v[178:181], v[90:93]
  v_exp_f32 v243, v243
  v_mfma_f32_16x16x32_bf16 v[94:97], a[40:43], v[178:181], v[94:97]
  s_add_u32 m0, s10, 90112
  v_mul_f32 v55, v55, v59
  v_mfma_f32_16x16x32_bf16 v[98:101], a[44:47], v[178:181], v[98:101]
  buffer_load_dwordx4 v35, s[32:35], s26 offen sc1 lds
  s_waitcnt lgkmcnt(0)
  v_mfma_f32_16x16x32_bf16 v[78:81], a[48:51], v[150:153], v[78:81]
  ds_read_b128 v[166:169], v16 offset:12288
  v_exp_f32 v244, v244
  v_mfma_f32_16x16x32_bf16 v[82:85], a[52:55], v[150:153], v[82:85]
  ds_read_b128 v[170:173], v16 offset:12544
  v_exp_f32 v245, v245
  v_mfma_f32_16x16x32_bf16 v[86:89], a[56:59], v[150:153], v[86:89]
  ds_read_b128 v[174:177], v16 offset:14336
  v_mul_f32 v56, v56, v60
  v_mul_f32 v57, v57, v61
  v_mfma_f32_16x16x32_bf16 v[90:93], a[48:51], v[154:157], v[90:93]
  ds_read_b128 v[178:181], v16 offset:14592
  v_fma_f32 v242, v242, v206, v206
  v_fma_f32 v243, v243, v206, v206
  v_mfma_f32_16x16x32_bf16 v[94:97], a[52:55], v[154:157], v[94:97]
  s_add_u32 m0, s10, 12288
  v_fma_f32 v244, v244, v206, v206
  v_mfma_f32_16x16x32_bf16 v[98:101], a[56:59], v[154:157], v[98:101]
  buffer_load_dwordx4 v34, s[32:35], s27 offen sc1 lds
  v_mfma_f32_16x16x32_bf16 v[78:81], a[60:63], v[158:161], v[78:81]
  v_fma_f32 v245, v245, v206, v206
  v_fma_f32 v66, v199, v42, v66
  v_mfma_f32_16x16x32_bf16 v[82:85], a[64:67], v[158:161], v[82:85]
  v_rcp_f32 v242, v242
  v_mfma_f32_16x16x32_bf16 v[86:89], a[68:71], v[158:161], v[86:89]
  buffer_load_dwordx4 v[182:185], v14, s[32:35], s11 offen offset:2048 sc1
  v_mfma_f32_16x16x32_bf16 v[90:93], a[60:63], v[162:165], v[90:93]
  v_rcp_f32 v243, v243
  v_mfma_f32_16x16x32_bf16 v[94:97], a[64:67], v[162:165], v[94:97]
  v_rcp_f32 v244, v244
  v_mfma_f32_16x16x32_bf16 v[98:101], a[68:71], v[162:165], v[98:101]
  buffer_load_dwordx4 v[186:189], v14, s[32:35], s11 offen offset:3072 sc1
  s_waitcnt lgkmcnt(0)
  v_mfma_f32_16x16x32_bf16 v[78:81], a[72:75], v[166:169], v[78:81]
  ds_read_b128 v[150:153], v16 offset:16384
  v_rcp_f32 v245, v245
  v_mfma_f32_16x16x32_bf16 v[82:85], a[76:79], v[166:169], v[82:85]
  ds_read_b128 v[154:157], v16 offset:16640
  v_mul_f32 v54, v54, v242
  v_mul_f32 v55, v55, v243
  v_mfma_f32_16x16x32_bf16 v[86:89], a[80:83], v[166:169], v[86:89]
  ds_read_b128 v[158:161], v16 offset:18432
  v_mul_f32 v56, v56, v244
  v_mul_f32 v57, v57, v245
  v_mfma_f32_16x16x32_bf16 v[90:93], a[72:75], v[170:173], v[90:93]
  ds_read_b128 v[162:165], v16 offset:18688
  v_cvt_pk_bf16_f32 v230, v54, v55
  v_cvt_pk_bf16_f32 v231, v56, v57
  v_mfma_f32_16x16x32_bf16 v[94:97], a[76:79], v[170:173], v[94:97]
  v_fma_f32 v67, v199, v43, v67
  v_fma_f32 v68, v199, v44, v68
  v_mfma_f32_16x16x32_bf16 v[98:101], a[80:83], v[170:173], v[98:101]
  buffer_load_dwordx4 v[190:193], v14, s[32:35], s9 offen offset:2048 sc1
  v_mfma_f32_16x16x32_bf16 v[78:81], a[84:87], v[174:177], v[78:81]
  v_fma_f32 v69, v199, v45, v69
  v_fma_f32 v70, v199, v46, v70
  v_mfma_f32_16x16x32_bf16 v[82:85], a[88:91], v[174:177], v[82:85]
  v_fma_f32 v71, v199, v47, v71
  v_fma_f32 v72, v199, v48, v72
  v_mfma_f32_16x16x32_bf16 v[86:89], a[92:95], v[174:177], v[86:89]
  buffer_load_dwordx4 v[194:197], v14, s[32:35], s9 offen offset:3072 sc1
  v_mfma_f32_16x16x32_bf16 v[90:93], a[84:87], v[178:181], v[90:93]
  v_fma_f32 v73, v199, v49, v73
  v_mul_f32 v246, v203, v66
  v_mfma_f32_16x16x32_bf16 v[94:97], a[88:91], v[178:181], v[94:97]
  s_add_u32 m0, s10, 94208
  v_mul_f32 v247, v203, v67
  v_mfma_f32_16x16x32_bf16 v[98:101], a[92:95], v[178:181], v[98:101]
  buffer_load_dwordx4 v35, s[32:35], s27 offen sc1 lds
  s_waitcnt vmcnt(17)
  s_barrier
  s_waitcnt lgkmcnt(0)
  v_mfma_f32_16x16x32_bf16 v[78:81], a[96:99], v[150:153], v[78:81]
  ds_read_b128 v[166:169], v16 offset:20480
  v_mul_f32 v248, v203, v68
  v_mul_f32 v249, v203, v69
  v_mfma_f32_16x16x32_bf16 v[82:85], a[100:103], v[150:153], v[82:85]
  ds_read_b128 v[170:173], v16 offset:20736
  v_exp_f32 v246, v246
  v_mfma_f32_16x16x32_bf16 v[86:89], a[104:107], v[150:153], v[86:89]
  ds_read_b128 v[174:177], v16 offset:22528
  v_exp_f32 v247, v247
  v_mfma_f32_16x16x32_bf16 v[90:93], a[96:99], v[154:157], v[90:93]
  ds_read_b128 v[178:181], v16 offset:22784
  v_exp_f32 v248, v248
  v_mfma_f32_16x16x32_bf16 v[94:97], a[100:103], v[154:157], v[94:97]
  s_add_u32 m0, s10, 16384
  v_mul_f32 v66, v66, v70
  v_mfma_f32_16x16x32_bf16 v[98:101], a[104:107], v[154:157], v[98:101]
  buffer_load_dwordx4 v34, s[32:35], s52 offen sc1 lds
  v_mfma_f32_16x16x32_bf16 v[78:81], a[108:111], v[158:161], v[78:81]
  v_exp_f32 v249, v249
  v_mfma_f32_16x16x32_bf16 v[82:85], a[112:115], v[158:161], v[82:85]
  s_add_u32 m0, s10, 98304
  v_mul_f32 v67, v67, v71
  v_mfma_f32_16x16x32_bf16 v[86:89], a[116:119], v[158:161], v[86:89]
  buffer_load_dwordx4 v35, s[32:35], s52 offen sc1 lds
  v_mfma_f32_16x16x32_bf16 v[90:93], a[108:111], v[162:165], v[90:93]
  v_mul_f32 v68, v68, v72
  v_mul_f32 v69, v69, v73
  v_mfma_f32_16x16x32_bf16 v[94:97], a[112:115], v[162:165], v[94:97]
  s_add_u32 m0, s10, 20480
  v_fma_f32 v246, v246, v207, v207
  v_mfma_f32_16x16x32_bf16 v[98:101], a[116:119], v[162:165], v[98:101]
  buffer_load_dwordx4 v34, s[32:35], s53 offen sc1 lds
  s_waitcnt lgkmcnt(0)
  v_mfma_f32_16x16x32_bf16 v[78:81], a[120:123], v[166:169], v[78:81]
  ds_read_b128 v[150:153], v16 offset:24576
  v_fma_f32 v247, v247, v207, v207
  v_fma_f32 v248, v248, v207, v207
  v_mfma_f32_16x16x32_bf16 v[82:85], a[124:127], v[166:169], v[82:85]
  ds_read_b128 v[154:157], v16 offset:24832
  v_fma_f32 v249, v249, v207, v207
  v_mul_f32 v242, v210, v62
  v_mfma_f32_16x16x32_bf16 v[86:89], a[128:131], v[166:169], v[86:89]
  ds_read_b128 v[158:161], v16 offset:26624
  v_rcp_f32 v246, v246
  v_mfma_f32_16x16x32_bf16 v[90:93], a[120:123], v[170:173], v[90:93]
  ds_read_b128 v[162:165], v16 offset:26880
  v_rcp_f32 v247, v247
  v_mfma_f32_16x16x32_bf16 v[94:97], a[124:127], v[170:173], v[94:97]
  s_add_u32 m0, s10, 102400
  v_mul_f32 v66, v66, v246
  v_mfma_f32_16x16x32_bf16 v[98:101], a[128:131], v[170:173], v[98:101]
  buffer_load_dwordx4 v35, s[32:35], s53 offen sc1 lds
  v_mfma_f32_16x16x32_bf16 v[78:81], a[132:135], v[174:177], v[78:81]
  v_rcp_f32 v248, v248
  v_mfma_f32_16x16x32_bf16 v[82:85], a[136:139], v[174:177], v[82:85]
  s_add_u32 m0, s10, 24576
  v_mul_f32 v67, v67, v247
  v_mfma_f32_16x16x32_bf16 v[86:89], a[140:143], v[174:177], v[86:89]
  buffer_load_dwordx4 v34, s[32:35], s7 offen sc1 lds
  v_mfma_f32_16x16x32_bf16 v[90:93], a[132:135], v[178:181], v[90:93]
  v_rcp_f32 v249, v249
  v_mfma_f32_16x16x32_bf16 v[94:97], a[136:139], v[178:181], v[94:97]
  s_add_u32 m0, s10, 106496
  v_mul_f32 v68, v68, v248
  v_mfma_f32_16x16x32_bf16 v[98:101], a[140:143], v[178:181], v[98:101]
  buffer_load_dwordx4 v35, s[32:35], s7 offen sc1 lds
  s_waitcnt lgkmcnt(0)
  v_mfma_f32_16x16x32_bf16 v[78:81], a[144:147], v[150:153], v[78:81]
  ds_read_b128 v[166:169], v16 offset:28672
  v_mul_f32 v69, v69, v249
  v_cvt_pk_bf16_f32 v232, v66, v67
  v_mfma_f32_16x16x32_bf16 v[82:85], a[148:151], v[150:153], v[82:85]
  ds_read_b128 v[170:173], v16 offset:28928
  v_cvt_pk_bf16_f32 v233, v68, v69
  v_mul_f32 v243, v210, v63
  v_mfma_f32_16x16x32_bf16 v[86:89], a[152:155], v[150:153], v[86:89]
  ds_read_b128 v[174:177], v16 offset:30720
  v_mul_f32 v244, v210, v64
  v_mul_f32 v245, v210, v65
  v_mfma_f32_16x16x32_bf16 v[90:93], a[144:147], v[154:157], v[90:93]
  ds_read_b128 v[178:181], v16 offset:30976
  v_permlane16_swap_b32 v230, v232
  v_permlane16_swap_b32 v231, v233
  v_mfma_f32_16x16x32_bf16 v[94:97], a[148:151], v[154:157], v[94:97]
  s_add_u32 m0, s10, 28672
  v_mul_f32 v62, v62, v74
  v_mfma_f32_16x16x32_bf16 v[98:101], a[152:155], v[154:157], v[98:101]
  buffer_load_dwordx4 v34, s[32:35], s8 offen sc1 lds
  v_mfma_f32_16x16x32_bf16 v[78:81], a[156:159], v[158:161], v[78:81]
  v_exp_f32 v242, v242
  v_mfma_f32_16x16x32_bf16 v[82:85], a[160:163], v[158:161], v[82:85]
  s_add_u32 m0, s10, 110592
  v_mul_f32 v63, v63, v75
  v_mfma_f32_16x16x32_bf16 v[86:89], a[164:167], v[158:161], v[86:89]
  buffer_load_dwordx4 v35, s[32:35], s8 offen sc1 lds
  v_mfma_f32_16x16x32_bf16 v[90:93], a[156:159], v[162:165], v[90:93]
  v_exp_f32 v243, v243
  v_mfma_f32_16x16x32_bf16 v[94:97], a[160:163], v[162:165], v[94:97]
  s_add_u32 m0, s10, 32768
  v_mul_f32 v64, v64, v76
  v_mfma_f32_16x16x32_bf16 v[98:101], a[164:167], v[162:165], v[98:101]
  buffer_load_dwordx4 v34, s[32:35], s16 offen sc1 lds
  s_waitcnt lgkmcnt(0)
  v_mfma_f32_16x16x32_bf16 v[78:81], a[168:171], v[166:169], v[78:81]
  ds_read_b128 v[150:153], v16 offset:32768
  v_exp_f32 v244, v244
  v_mfma_f32_16x16x32_bf16 v[82:85], a[172:175], v[166:169], v[82:85]
  ds_read_b128 v[154:157], v16 offset:33024
  v_exp_f32 v245, v245
  v_mfma_f32_16x16x32_bf16 v[86:89], a[176:179], v[166:169], v[86:89]
  ds_read_b128 v[158:161], v16 offset:34816
  v_mul_f32 v65, v65, v77
  v_fma_f32 v242, v242, v212, v212
  v_mfma_f32_16x16x32_bf16 v[90:93], a[168:171], v[170:173], v[90:93]
  ds_read_b128 v[162:165], v16 offset:35072
  v_fma_f32 v243, v243, v212, v212
  v_fma_f32 v244, v244, v212, v212
  v_mfma_f32_16x16x32_bf16 v[94:97], a[172:175], v[170:173], v[94:97]
  s_add_u32 m0, s10, 114688
  v_fma_f32 v245, v245, v212, v212
  v_mfma_f32_16x16x32_bf16 v[98:101], a[176:179], v[170:173], v[98:101]
  buffer_load_dwordx4 v35, s[32:35], s16 offen sc1 lds
  v_mfma_f32_16x16x32_bf16 v[78:81], a[180:183], v[174:177], v[78:81]
  v_rcp_f32 v242, v242
  v_mfma_f32_16x16x32_bf16 v[82:85], a[184:187], v[174:177], v[82:85]
  s_add_u32 m0, s10, 36864
  v_mul_f32 v62, v62, v242
  v_mfma_f32_16x16x32_bf16 v[86:89], a[188:191], v[174:177], v[86:89]
  buffer_load_dwordx4 v34, s[32:35], s20 offen sc1 lds
  v_mfma_f32_16x16x32_bf16 v[90:93], a[180:183], v[178:181], v[90:93]
  v_rcp_f32 v243, v243
  v_mfma_f32_16x16x32_bf16 v[94:97], a[184:187], v[178:181], v[94:97]
  s_add_u32 m0, s10, 118784
  v_mul_f32 v63, v63, v243
  v_mfma_f32_16x16x32_bf16 v[98:101], a[188:191], v[178:181], v[98:101]
  buffer_load_dwordx4 v35, s[32:35], s20 offen sc1 lds
  s_waitcnt lgkmcnt(0)
  v_mfma_f32_16x16x32_bf16 v[78:81], a[192:195], v[150:153], v[78:81]
  ds_read_b128 v[166:169], v16 offset:36864
  v_rcp_f32 v244, v244
  v_mfma_f32_16x16x32_bf16 v[82:85], a[196:199], v[150:153], v[82:85]
  ds_read_b128 v[170:173], v16 offset:37120
  v_rcp_f32 v245, v245
  v_mfma_f32_16x16x32_bf16 v[86:89], a[200:203], v[150:153], v[86:89]
  ds_read_b128 v[174:177], v16 offset:38912
  v_mul_f32 v64, v64, v244
  v_mul_f32 v65, v65, v245
  v_mfma_f32_16x16x32_bf16 v[90:93], a[192:195], v[154:157], v[90:93]
  ds_read_b128 v[178:181], v16 offset:39168
  v_cvt_pk_bf16_f32 v238, v62, v63
  v_cvt_pk_bf16_f32 v239, v64, v65
  v_mfma_f32_16x16x32_bf16 v[94:97], a[196:199], v[154:157], v[94:97]
  buffer_store_dwordx4 v[230:233], v14, s[32:35], s12 offen sc1
  v_mfma_f32_16x16x32_bf16 v[98:101], a[200:203], v[154:157], v[98:101]
  v_mfma_f32_16x16x32_bf16 v[78:81], a[204:207], v[158:161], v[78:81]
  v_mfma_f32_16x16x32_bf16 v[82:85], a[208:211], v[158:161], v[82:85]
  v_mfma_f32_16x16x32_bf16 v[86:89], a[212:215], v[158:161], v[86:89]
  v_mfma_f32_16x16x32_bf16 v[90:93], a[204:207], v[162:165], v[90:93]
  v_mfma_f32_16x16x32_bf16 v[94:97], a[208:211], v[162:165], v[94:97]
  v_mfma_f32_16x16x32_bf16 v[98:101], a[212:215], v[162:165], v[98:101]
  s_waitcnt vmcnt(11)
  s_barrier
  s_waitcnt lgkmcnt(0)
  v_mfma_f32_16x16x32_bf16 v[78:81], a[216:219], v[166:169], v[78:81]
  ds_read_b128 v[150:153], v17 offset:0
  v_mfma_f32_16x16x32_bf16 v[82:85], a[220:223], v[166:169], v[82:85]
  ds_read_b128 v[154:157], v17 offset:256
  v_mfma_f32_16x16x32_bf16 v[86:89], a[224:227], v[166:169], v[86:89]
  ds_read_b128 v[158:161], v18 offset:0
  v_mfma_f32_16x16x32_bf16 v[90:93], a[216:219], v[170:173], v[90:93]
  ds_read_b128 v[162:165], v18 offset:256
  v_mfma_f32_16x16x32_bf16 v[94:97], a[220:223], v[170:173], v[94:97]
  v_mfma_f32_16x16x32_bf16 v[98:101], a[224:227], v[170:173], v[98:101]
  v_mfma_f32_16x16x32_bf16 v[78:81], a[228:231], v[174:177], v[78:81]
  v_mfma_f32_16x16x32_bf16 v[82:85], a[232:235], v[174:177], v[82:85]
  v_mfma_f32_16x16x32_bf16 v[86:89], a[236:239], v[174:177], v[86:89]
  v_mfma_f32_16x16x32_bf16 v[90:93], a[228:231], v[178:181], v[90:93]
  v_mfma_f32_16x16x32_bf16 v[94:97], a[232:235], v[178:181], v[94:97]
  v_mfma_f32_16x16x32_bf16 v[98:101], a[236:239], v[178:181], v[98:101]
  s_waitcnt lgkmcnt(0)
  v_mfma_f32_16x16x32_bf16 v[102:105], a[0:3], v[150:153], 0
  ds_read_b128 v[166:169], v17 offset:2048
  s_nop 1
  v_fma_f32 v86, v200, v50, v86
  v_fma_f32 v87, v200, v51, v87
  v_mfma_f32_16x16x32_bf16 v[106:109], a[4:7], v[150:153], 0
  ds_read_b128 v[170:173], v17 offset:2304
  v_fma_f32 v88, v200, v52, v88
  v_fma_f32 v89, v200, v53, v89
  v_mfma_f32_16x16x32_bf16 v[110:113], a[8:11], v[150:153], 0
  ds_read_b128 v[174:177], v18 offset:2048
  v_fma_f32 v98, v201, v50, v98
  v_fma_f32 v99, v201, v51, v99
  v_mfma_f32_16x16x32_bf16 v[114:117], a[0:3], v[154:157], 0
  ds_read_b128 v[178:181], v18 offset:2304
  v_fma_f32 v100, v201, v52, v100
  v_fma_f32 v101, v201, v53, v101
  v_mfma_f32_16x16x32_bf16 v[118:121], a[4:7], v[154:157], 0
  v_fma_f32 v78, v200, v42, v78
  v_fma_f32 v79, v200, v43, v79
  v_mfma_f32_16x16x32_bf16 v[122:125], a[8:11], v[154:157], 0
  v_fma_f32 v80, v200, v44, v80
  v_fma_f32 v81, v200, v45, v81
  v_mfma_f32_16x16x32_bf16 v[126:129], a[0:3], v[158:161], 0
  v_fma_f32 v82, v200, v46, v82
  v_fma_f32 v83, v200, v47, v83
  v_mfma_f32_16x16x32_bf16 v[130:133], a[4:7], v[158:161], 0
  v_fma_f32 v84, v200, v48, v84
  v_fma_f32 v85, v200, v49, v85
  v_mfma_f32_16x16x32_bf16 v[134:137], a[8:11], v[158:161], 0
  v_permlane32_swap_b32 v86, v98
  v_permlane32_swap_b32 v87, v99
  v_mfma_f32_16x16x32_bf16 v[138:141], a[0:3], v[162:165], 0
  buffer_load_dwordx4 a[0:3], v14, s[32:35], s18 offen offset:2048 sc1
  v_mfma_f32_16x16x32_bf16 v[142:145], a[4:7], v[162:165], 0
  v_permlane32_swap_b32 v88, v100
  v_permlane32_swap_b32 v89, v101
  v_mfma_f32_16x16x32_bf16 v[146:149], a[8:11], v[162:165], 0
  v_mul_f32 v246, v204, v78
  s_waitcnt lgkmcnt(0)
  v_mfma_f32_16x16x32_bf16 v[102:105], a[12:15], v[166:169], v[102:105]
  ds_read_b128 v[150:153], v17 offset:4096
  v_mul_f32 v247, v204, v79
  v_mul_f32 v248, v204, v80
  v_mfma_f32_16x16x32_bf16 v[106:109], a[16:19], v[166:169], v[106:109]
  ds_read_b128 v[154:157], v17 offset:4352
  v_mul_f32 v249, v204, v81
  v_mul_f32 v78, v78, v82
  v_mfma_f32_16x16x32_bf16 v[110:113], a[20:23], v[166:169], v[110:113]
  ds_read_b128 v[158:161], v18 offset:4096
  v_exp_f32 v246, v246
  v_mfma_f32_16x16x32_bf16 v[114:117], a[12:15], v[170:173], v[114:117]
  ds_read_b128 v[162:165], v18 offset:4352
  v_exp_f32 v247, v247
  v_mfma_f32_16x16x32_bf16 v[118:121], a[16:19], v[170:173], v[118:121]
  v_exp_f32 v248, v248
  v_mfma_f32_16x16x32_bf16 v[122:125], a[20:23], v[170:173], v[122:125]
  buffer_load_dwordx4 a[4:7], v14, s[32:35], s18 offen offset:3072 sc1
  s_add_u32 s18, s18, 4096
  v_mfma_f32_16x16x32_bf16 v[126:129], a[12:15], v[174:177], v[126:129]
  v_exp_f32 v249, v249
  v_mfma_f32_16x16x32_bf16 v[130:133], a[16:19], v[174:177], v[130:133]
  v_mul_f32 v79, v79, v83
  v_mul_f32 v80, v80, v84
  v_mfma_f32_16x16x32_bf16 v[134:137], a[20:23], v[174:177], v[134:137]
  v_mul_f32 v81, v81, v85
  v_fma_f32 v246, v246, v208, v208
  v_mfma_f32_16x16x32_bf16 v[138:141], a[12:15], v[178:181], v[138:141]
  buffer_load_dwordx4 a[8:11], v14, s[32:35], s18 offen offset:0 sc1
  v_mfma_f32_16x16x32_bf16 v[142:145], a[16:19], v[178:181], v[142:145]
  v_fma_f32 v247, v247, v208, v208
  v_fma_f32 v248, v248, v208, v208
  v_mfma_f32_16x16x32_bf16 v[146:149], a[20:23], v[178:181], v[146:149]
  v_fma_f32 v249, v249, v208, v208
  s_waitcnt lgkmcnt(0)
  v_mfma_f32_16x16x32_bf16 v[102:105], a[24:27], v[150:153], v[102:105]
  ds_read_b128 v[166:169], v17 offset:6144
  v_rcp_f32 v246, v246
  v_mfma_f32_16x16x32_bf16 v[106:109], a[28:31], v[150:153], v[106:109]
  ds_read_b128 v[170:173], v17 offset:6400
  v_rcp_f32 v247, v247
  v_mfma_f32_16x16x32_bf16 v[110:113], a[32:35], v[150:153], v[110:113]
  ds_read_b128 v[174:177], v18 offset:6144
  v_rcp_f32 v248, v248
  v_mfma_f32_16x16x32_bf16 v[114:117], a[24:27], v[154:157], v[114:117]
  ds_read_b128 v[178:181], v18 offset:6400
  v_rcp_f32 v249, v249
  v_mfma_f32_16x16x32_bf16 v[118:121], a[28:31], v[154:157], v[118:121]
  v_mul_f32 v78, v78, v246
  v_mul_f32 v79, v79, v247
  v_mfma_f32_16x16x32_bf16 v[122:125], a[32:35], v[154:157], v[122:125]
  buffer_load_dwordx4 a[12:15], v14, s[32:35], s18 offen offset:1024 sc1
  v_mfma_f32_16x16x32_bf16 v[126:129], a[24:27], v[158:161], v[126:129]
  v_mul_f32 v80, v80, v248
  v_mul_f32 v81, v81, v249
  v_mfma_f32_16x16x32_bf16 v[130:133], a[28:31], v[158:161], v[130:133]
  v_cvt_pk_bf16_f32 v234, v78, v79
  v_cvt_pk_bf16_f32 v235, v80, v81
  v_mfma_f32_16x16x32_bf16 v[134:137], a[32:35], v[158:161], v[134:137]
  v_fma_f32 v90, v201, v42, v90
  v_fma_f32 v91, v201, v43, v91
  v_mfma_f32_16x16x32_bf16 v[138:141], a[24:27], v[162:165], v[138:141]
  buffer_load_dwordx4 a[16:19], v14, s[32:35], s18 offen offset:2048 sc1
  v_mfma_f32_16x16x32_bf16 v[142:145], a[28:31], v[162:165], v[142:145]
  v_fma_f32 v92, v201, v44, v92
  v_fma_f32 v93, v201, v45, v93
  v_mfma_f32_16x16x32_bf16 v[146:149], a[32:35], v[162:165], v[146:149]
  v_fma_f32 v94, v201, v46, v94
  s_waitcnt lgkmcnt(0)
  v_mfma_f32_16x16x32_bf16 v[102:105], a[36:39], v[166:169], v[102:105]
  ds_read_b128 v[150:153], v17 offset:8192
  v_fma_f32 v95, v201, v47, v95
  v_fma_f32 v96, v201, v48, v96
  v_mfma_f32_16x16x32_bf16 v[106:109], a[40:43], v[166:169], v[106:109]
  ds_read_b128 v[154:157], v17 offset:8448
  v_fma_f32 v97, v201, v49, v97
  v_mul_f32 v242, v205, v90
  v_mfma_f32_16x16x32_bf16 v[110:113], a[44:47], v[166:169], v[110:113]
  ds_read_b128 v[158:161], v18 offset:8192
  v_mul_f32 v243, v205, v91
  v_mul_f32 v244, v205, v92
  v_mfma_f32_16x16x32_bf16 v[114:117], a[36:39], v[170:173], v[114:117]
  ds_read_b128 v[162:165], v18 offset:8448
  v_mul_f32 v245, v205, v93
  v_mul_f32 v90, v90, v94
  v_mfma_f32_16x16x32_bf16 v[118:121], a[40:43], v[170:173], v[118:121]
  v_exp_f32 v242, v242
  v_mfma_f32_16x16x32_bf16 v[122:125], a[44:47], v[170:173], v[122:125]
  buffer_load_dwordx4 a[20:23], v14, s[32:35], s18 offen offset:3072 sc1
  s_add_u32 s18, s18, 4096
  v_mfma_f32_16x16x32_bf16 v[126:129], a[36:39], v[174:177], v[126:129]
  v_exp_f32 v243, v243
  v_mfma_f32_16x16x32_bf16 v[130:133], a[40:43], v[174:177], v[130:133]
  v_exp_f32 v244, v244
  v_mfma_f32_16x16x32_bf16 v[134:137], a[44:47], v[174:177], v[134:137]
  v_exp_f32 v245, v245
  v_mfma_f32_16x16x32_bf16 v[138:141], a[36:39], v[178:181], v[138:141]
  buffer_load_dwordx4 a[24:27], v14, s[32:35], s18 offen offset:0 sc1
  v_mfma_f32_16x16x32_bf16 v[142:145], a[40:43], v[178:181], v[142:145]
  v_mul_f32 v91, v91, v95
  v_mul_f32 v92, v92, v96
  v_mfma_f32_16x16x32_bf16 v[146:149], a[44:47], v[178:181], v[146:149]
  v_mul_f32 v93, v93, v97
  s_waitcnt lgkmcnt(0)
  v_mfma_f32_16x16x32_bf16 v[102:105], a[48:51], v[150:153], v[102:105]
  ds_read_b128 v[166:169], v17 offset:10240
  v_fma_f32 v242, v242, v209, v209
  v_fma_f32 v243, v243, v209, v209
  v_mfma_f32_16x16x32_bf16 v[106:109], a[52:55], v[150:153], v[106:109]
  ds_read_b128 v[170:173], v17 offset:10496
  v_fma_f32 v244, v244, v209, v209
  v_fma_f32 v245, v245, v209, v209
  v_mfma_f32_16x16x32_bf16 v[110:113], a[56:59], v[150:153], v[110:113]
  ds_read_b128 v[174:177], v18 offset:10240
  v_rcp_f32 v242, v242
  v_mfma_f32_16x16x32_bf16 v[114:117], a[48:51], v[154:157], v[114:117]
  ds_read_b128 v[178:181], v18 offset:10496
  v_rcp_f32 v243, v243
  v_mfma_f32_16x16x32_bf16 v[118:121], a[52:55], v[154:157], v[118:121]
  v_rcp_f32 v244, v244
  v_mfma_f32_16x16x32_bf16 v[122:125], a[56:59], v[154:157], v[122:125]
  buffer_load_dwordx4 a[28:31], v14, s[32:35], s18 offen offset:1024 sc1
  v_mfma_f32_16x16x32_bf16 v[126:129], a[48:51], v[158:161], v[126:129]
  v_rcp_f32 v245, v245
  v_mfma_f32_16x16x32_bf16 v[130:133], a[52:55], v[158:161], v[130:133]
  v_mul_f32 v90, v90, v242
  v_mul_f32 v91, v91, v243
  v_mfma_f32_16x16x32_bf16 v[134:137], a[56:59], v[158:161], v[134:137]
  v_mul_f32 v92, v92, v244
  v_mul_f32 v93, v93, v245
  v_mfma_f32_16x16x32_bf16 v[138:141], a[48:51], v[162:165], v[138:141]
  buffer_load_dwordx4 a[32:35], v14, s[32:35], s18 offen offset:2048 sc1
  v_mfma_f32_16x16x32_bf16 v[142:145], a[52:55], v[162:165], v[142:145]
  v_cvt_pk_bf16_f32 v236, v90, v91
  v_cvt_pk_bf16_f32 v237, v92, v93
  v_mfma_f32_16x16x32_bf16 v[146:149], a[56:59], v[162:165], v[146:149]
  v_mul_f32 v246, v211, v86
  s_waitcnt lgkmcnt(0)
  v_mfma_f32_16x16x32_bf16 v[102:105], a[60:63], v[166:169], v[102:105]
  ds_read_b128 v[150:153], v17 offset:12288
  v_mul_f32 v247, v211, v87
  v_mul_f32 v248, v211, v88
  v_mfma_f32_16x16x32_bf16 v[106:109], a[64:67], v[166:169], v[106:109]
  ds_read_b128 v[154:157], v17 offset:12544
  v_mul_f32 v249, v211, v89
  v_permlane16_swap_b32 v234, v236
  v_mfma_f32_16x16x32_bf16 v[110:113], a[68:71], v[166:169], v[110:113]
  ds_read_b128 v[158:161], v18 offset:12288
  v_permlane16_swap_b32 v235, v237
  v_mul_f32 v86, v86, v98
  v_mfma_f32_16x16x32_bf16 v[114:117], a[60:63], v[170:173], v[114:117]
  ds_read_b128 v[162:165], v18 offset:12544
  v_exp_f32 v246, v246
  v_mfma_f32_16x16x32_bf16 v[118:121], a[64:67], v[170:173], v[118:121]
  v_exp_f32 v247, v247
  v_mfma_f32_16x16x32_bf16 v[122:125], a[68:71], v[170:173], v[122:125]
  buffer_load_dwordx4 a[36:39], v14, s[32:35], s18 offen offset:3072 sc1
  s_add_u32 s18, s18, 4096
  v_mfma_f32_16x16x32_bf16 v[126:129], a[60:63], v[174:177], v[126:129]
  v_exp_f32 v248, v248
  v_mfma_f32_16x16x32_bf16 v[130:133], a[64:67], v[174:177], v[130:133]
  v_exp_f32 v249, v249
  v_mfma_f32_16x16x32_bf16 v[134:137], a[68:71], v[174:177], v[134:137]
  v_mul_f32 v87, v87, v99
  v_mul_f32 v88, v88, v100
  v_mfma_f32_16x16x32_bf16 v[138:141], a[60:63], v[178:181], v[138:141]
  buffer_load_dwordx4 a[40:43], v14, s[32:35], s18 offen offset:0 sc1
  v_mfma_f32_16x16x32_bf16 v[142:145], a[64:67], v[178:181], v[142:145]
  v_mul_f32 v89, v89, v101
  v_fma_f32 v246, v246, v213, v213
  v_mfma_f32_16x16x32_bf16 v[146:149], a[68:71], v[178:181], v[146:149]
  v_fma_f32 v247, v247, v213, v213
  s_waitcnt lgkmcnt(0)
  v_mfma_f32_16x16x32_bf16 v[102:105], a[72:75], v[150:153], v[102:105]
  ds_read_b128 v[166:169], v17 offset:14336
  v_fma_f32 v248, v248, v213, v213
  v_fma_f32 v249, v249, v213, v213
  v_mfma_f32_16x16x32_bf16 v[106:109], a[76:79], v[150:153], v[106:109]
  ds_read_b128 v[170:173], v17 offset:14592
  v_rcp_f32 v246, v246
  v_mfma_f32_16x16x32_bf16 v[110:113], a[80:83], v[150:153], v[110:113]
  ds_read_b128 v[174:177], v18 offset:14336
  v_rcp_f32 v247, v247
  v_mfma_f32_16x16x32_bf16 v[114:117], a[72:75], v[154:157], v[114:117]
  ds_read_b128 v[178:181], v18 offset:14592
  v_rcp_f32 v248, v248
  v_mfma_f32_16x16x32_bf16 v[118:121], a[76:79], v[154:157], v[118:121]
  v_rcp_f32 v249, v249
  v_mfma_f32_16x16x32_bf16 v[122:125], a[80:83], v[154:157], v[122:125]
  buffer_load_dwordx4 a[44:47], v14, s[32:35], s18 offen offset:1024 sc1
  v_mfma_f32_16x16x32_bf16 v[126:129], a[72:75], v[158:161], v[126:129]
  v_mul_f32 v86, v86, v246
  v_mul_f32 v87, v87, v247
  v_mfma_f32_16x16x32_bf16 v[130:133], a[76:79], v[158:161], v[130:133]
  v_mul_f32 v88, v88, v248
  v_mul_f32 v89, v89, v249
  v_mfma_f32_16x16x32_bf16 v[134:137], a[80:83], v[158:161], v[134:137]
  v_cvt_pk_bf16_f32 v240, v86, v87
  v_cvt_pk_bf16_f32 v241, v88, v89
  v_mfma_f32_16x16x32_bf16 v[138:141], a[72:75], v[162:165], v[138:141]
  buffer_load_dwordx4 a[48:51], v14, s[32:35], s18 offen offset:2048 sc1
  v_mfma_f32_16x16x32_bf16 v[142:145], a[76:79], v[162:165], v[142:145]
  v_permlane16_swap_b32 v238, v240
  v_permlane16_swap_b32 v239, v241
  v_mfma_f32_16x16x32_bf16 v[146:149], a[80:83], v[162:165], v[146:149]
  v_add_f32 v182, v182, v184
  s_waitcnt lgkmcnt(0)
  v_mfma_f32_16x16x32_bf16 v[102:105], a[84:87], v[166:169], v[102:105]
  ds_read_b128 v[150:153], v17 offset:16384
  v_add_f32 v183, v183, v185
  v_add_f32 v186, v186, v188
  v_mfma_f32_16x16x32_bf16 v[106:109], a[88:91], v[166:169], v[106:109]
  ds_read_b128 v[154:157], v17 offset:16640
  v_add_f32 v187, v187, v189
  v_add_f32 v190, v190, v192
  v_mfma_f32_16x16x32_bf16 v[110:113], a[92:95], v[166:169], v[110:113]
  ds_read_b128 v[158:161], v18 offset:16384
  v_add_f32 v191, v191, v193
  v_add_f32 v194, v194, v196
  v_mfma_f32_16x16x32_bf16 v[114:117], a[84:87], v[170:173], v[114:117]
  ds_read_b128 v[162:165], v18 offset:16640
  v_add_f32 v195, v195, v197
  v_permlane32_swap_b32 v182, v190
  v_mfma_f32_16x16x32_bf16 v[118:121], a[88:91], v[170:173], v[118:121]
  v_permlane32_swap_b32 v186, v194
  v_permlane32_swap_b32 v183, v191
  v_mfma_f32_16x16x32_bf16 v[122:125], a[92:95], v[170:173], v[122:125]
  buffer_load_dwordx4 a[52:55], v14, s[32:35], s18 offen offset:3072 sc1
  s_add_u32 s18, s18, 4096
  v_mfma_f32_16x16x32_bf16 v[126:129], a[84:87], v[174:177], v[126:129]
  v_permlane32_swap_b32 v187, v195
  v_add_f32 v182, v182, v190
  v_mfma_f32_16x16x32_bf16 v[130:133], a[88:91], v[174:177], v[130:133]
  v_add_f32 v186, v186, v194
  v_add_f32 v183, v183, v191
  v_mfma_f32_16x16x32_bf16 v[134:137], a[92:95], v[174:177], v[134:137]
  v_add_f32 v187, v187, v195
  v_permlane16_swap_b32 v182, v186
  v_mfma_f32_16x16x32_bf16 v[138:141], a[84:87], v[178:181], v[138:141]
  buffer_load_dwordx4 a[56:59], v14, s[32:35], s18 offen offset:0 sc1
  v_mfma_f32_16x16x32_bf16 v[142:145], a[88:91], v[178:181], v[142:145]
  v_permlane16_swap_b32 v183, v187
  v_add_f32 v182, v182, v186
  v_mfma_f32_16x16x32_bf16 v[146:149], a[92:95], v[178:181], v[146:149]
  v_add_f32 v183, v183, v187
  s_waitcnt lgkmcnt(0)
  v_mfma_f32_16x16x32_bf16 v[102:105], a[96:99], v[150:153], v[102:105]
  ds_read_b128 v[166:169], v17 offset:18432
  v_mul_f32 v214, 0xbacccccd, v182
  v_mul_f32 v183, 0x3acccccd, v183
  v_mfma_f32_16x16x32_bf16 v[106:109], a[100:103], v[150:153], v[106:109]
  ds_read_b128 v[170:173], v17 offset:18688
  v_fma_f32 v183, -v214, v214, v183
  v_mov_b32 v215, v214
  v_mfma_f32_16x16x32_bf16 v[110:113], a[104:107], v[150:153], v[110:113]
  ds_read_b128 v[174:177], v18 offset:18432
  v_add_f32 v222, 0x3727c5ac, v183
  v_mov_b32 v216, v214
  v_mfma_f32_16x16x32_bf16 v[114:117], a[96:99], v[154:157], v[114:117]
  ds_read_b128 v[178:181], v18 offset:18688
  v_rsq_f32 v182, v222
  v_mfma_f32_16x16x32_bf16 v[118:121], a[100:103], v[154:157], v[118:121]
  v_mov_b32 v217, v214
  v_mov_b32 v223, v222
  v_mfma_f32_16x16x32_bf16 v[122:125], a[104:107], v[154:157], v[122:125]
  buffer_load_dwordx4 a[60:63], v14, s[32:35], s18 offen offset:1024 sc1
  v_mfma_f32_16x16x32_bf16 v[126:129], a[96:99], v[158:161], v[126:129]
  v_mov_b32 v224, v222
  v_mov_b32 v225, v222
  v_mfma_f32_16x16x32_bf16 v[130:133], a[100:103], v[158:161], v[130:133]
  v_mul_f32 v218, 0xbfb8aa3b, v182
  v_mul_f32 v219, 0xbfb8aa3b, v182
  v_mfma_f32_16x16x32_bf16 v[134:137], a[104:107], v[158:161], v[134:137]
  v_mul_f32 v220, 0xbfb8aa3b, v182
  v_mul_f32 v221, 0xbfb8aa3b, v182
  v_mfma_f32_16x16x32_bf16 v[138:141], a[96:99], v[162:165], v[138:141]
  buffer_load_dwordx4 a[64:67], v14, s[32:35], s18 offen offset:2048 sc1
  v_mfma_f32_16x16x32_bf16 v[142:145], a[100:103], v[162:165], v[142:145]
  v_permlane32_swap_b32 v214, v216
  v_permlane32_swap_b32 v215, v217
  v_mfma_f32_16x16x32_bf16 v[146:149], a[104:107], v[162:165], v[146:149]
  v_permlane32_swap_b32 v222, v224
  s_waitcnt vmcnt(18)
  s_barrier
  s_waitcnt lgkmcnt(0)
  v_mfma_f32_16x16x32_bf16 v[102:105], a[108:111], v[166:169], v[102:105]
  ds_read_b128 v[150:153], v17 offset:20480
  v_permlane16_swap_b32 v214, v215
  v_permlane16_swap_b32 v216, v217
  v_mfma_f32_16x16x32_bf16 v[106:109], a[112:115], v[166:169], v[106:109]
  ds_read_b128 v[154:157], v17 offset:20736
  v_permlane32_swap_b32 v223, v225
  v_permlane32_swap_b32 v218, v220
  v_mfma_f32_16x16x32_bf16 v[110:113], a[116:119], v[166:169], v[110:113]
  ds_read_b128 v[158:161], v17 offset:22528
  v_permlane16_swap_b32 v222, v223
  v_permlane16_swap_b32 v224, v225
  v_mfma_f32_16x16x32_bf16 v[114:117], a[108:111], v[170:173], v[114:117]
  ds_read_b128 v[162:165], v17 offset:22784
  v_permlane32_swap_b32 v219, v221
  v_cndmask_b32 v228, v222, v223, s[40:41]
  v_mfma_f32_16x16x32_bf16 v[118:121], a[112:115], v[170:173], v[118:121]
  v_permlane16_swap_b32 v218, v219
  v_permlane16_swap_b32 v220, v221
  v_mfma_f32_16x16x32_bf16 v[122:125], a[116:119], v[170:173], v[122:125]
  buffer_load_dwordx4 a[68:71], v14, s[32:35], s18 offen offset:3072 sc1
  s_add_u32 s18, s18, 4096
  v_mfma_f32_16x16x32_bf16 v[126:129], a[108:111], v[174:177], v[126:129]
  v_cndmask_b32 v229, v224, v225, s[40:41]
  v_cndmask_b32 v226, v218, v219, s[40:41]
  v_mfma_f32_16x16x32_bf16 v[130:133], a[112:115], v[174:177], v[130:133]
  v_cndmask_b32 v227, v220, v221, s[40:41]
  v_mfma_f32_16x16x32_bf16 v[134:137], a[116:119], v[174:177], v[134:137]
  s_add_u32 s55, s12, 196608
  buffer_store_dwordx4 v[234:237], v14, s[32:35], s55 offen sc1
  v_mfma_f32_16x16x32_bf16 v[138:141], a[108:111], v[178:181], v[138:141]
  buffer_load_dwordx4 a[72:75], v14, s[32:35], s18 offen offset:0 sc1
  v_mfma_f32_16x16x32_bf16 v[142:145], a[112:115], v[178:181], v[142:145]
  buffer_store_dwordx4 v[238:241], v29, s[32:35], s12 offen offset:1024 sc1
  s_add_u32 s12, s12, 98304
  v_mfma_f32_16x16x32_bf16 v[146:149], a[116:119], v[178:181], v[146:149]
  s_waitcnt lgkmcnt(0)
  v_mfma_f32_16x16x32_bf16 v[102:105], a[120:123], v[150:153], v[102:105]
  ds_read_b128 v[166:169], v17 offset:24576
  v_mfma_f32_16x16x32_bf16 v[106:109], a[124:127], v[150:153], v[106:109]
  ds_read_b128 v[170:173], v17 offset:24832
  v_mfma_f32_16x16x32_bf16 v[110:113], a[128:131], v[150:153], v[110:113]
  ds_read_b128 v[174:177], v17 offset:26624
  v_mfma_f32_16x16x32_bf16 v[114:117], a[120:123], v[154:157], v[114:117]
  ds_read_b128 v[178:181], v17 offset:26880
  v_mfma_f32_16x16x32_bf16 v[118:121], a[124:127], v[154:157], v[118:121]
  v_mfma_f32_16x16x32_bf16 v[122:125], a[128:131], v[154:157], v[122:125]
  buffer_load_dwordx4 a[76:79], v14, s[32:35], s18 offen offset:1024 sc1
  v_mfma_f32_16x16x32_bf16 v[102:105], a[132:135], v[158:161], v[102:105]
  v_mfma_f32_16x16x32_bf16 v[106:109], a[136:139], v[158:161], v[106:109]
  v_mfma_f32_16x16x32_bf16 v[110:113], a[140:143], v[158:161], v[110:113]
  v_mfma_f32_16x16x32_bf16 v[114:117], a[132:135], v[162:165], v[114:117]
  buffer_load_dwordx4 a[80:83], v14, s[32:35], s18 offen offset:2048 sc1
  v_mfma_f32_16x16x32_bf16 v[118:121], a[136:139], v[162:165], v[118:121]
  v_mfma_f32_16x16x32_bf16 v[122:125], a[140:143], v[162:165], v[122:125]
  s_waitcnt lgkmcnt(0)
  v_mfma_f32_16x16x32_bf16 v[102:105], a[144:147], v[166:169], v[102:105]
  ds_read_b128 v[150:153], v17 offset:28672
  v_mfma_f32_16x16x32_bf16 v[106:109], a[148:151], v[166:169], v[106:109]
  ds_read_b128 v[154:157], v17 offset:28928
  v_mfma_f32_16x16x32_bf16 v[110:113], a[152:155], v[166:169], v[110:113]
  ds_read_b128 v[158:161], v17 offset:30720
  v_mfma_f32_16x16x32_bf16 v[114:117], a[144:147], v[170:173], v[114:117]
  ds_read_b128 v[162:165], v17 offset:30976
  v_mfma_f32_16x16x32_bf16 v[118:121], a[148:151], v[170:173], v[118:121]
  v_mfma_f32_16x16x32_bf16 v[122:125], a[152:155], v[170:173], v[122:125]
  buffer_load_dwordx4 a[84:87], v14, s[32:35], s18 offen offset:3072 sc1
  s_add_u32 s18, s18, 4096
  v_mfma_f32_16x16x32_bf16 v[102:105], a[156:159], v[174:177], v[102:105]
  v_mfma_f32_16x16x32_bf16 v[106:109], a[160:163], v[174:177], v[106:109]
  v_mfma_f32_16x16x32_bf16 v[110:113], a[164:167], v[174:177], v[110:113]
  v_mfma_f32_16x16x32_bf16 v[114:117], a[156:159], v[178:181], v[114:117]
  buffer_load_dwordx4 a[88:91], v14, s[32:35], s18 offen offset:0 sc1
  v_mfma_f32_16x16x32_bf16 v[118:121], a[160:163], v[178:181], v[118:121]
  v_mfma_f32_16x16x32_bf16 v[122:125], a[164:167], v[178:181], v[122:125]
  s_waitcnt lgkmcnt(0)
  v_mfma_f32_16x16x32_bf16 v[102:105], a[168:171], v[150:153], v[102:105]
  ds_read_b128 v[166:169], v17 offset:32768
  v_mfma_f32_16x16x32_bf16 v[106:109], a[172:175], v[150:153], v[106:109]
  ds_read_b128 v[170:173], v17 offset:33024
  v_mfma_f32_16x16x32_bf16 v[110:113], a[176:179], v[150:153], v[110:113]
  ds_read_b128 v[174:177], v17 offset:34816
  v_mfma_f32_16x16x32_bf16 v[114:117], a[168:171], v[154:157], v[114:117]
  ds_read_b128 v[178:181], v17 offset:35072
  v_mfma_f32_16x16x32_bf16 v[118:121], a[172:175], v[154:157], v[118:121]
  v_mfma_f32_16x16x32_bf16 v[122:125], a[176:179], v[154:157], v[122:125]
  buffer_load_dwordx4 a[92:95], v14, s[32:35], s18 offen offset:1024 sc1
  v_mfma_f32_16x16x32_bf16 v[102:105], a[180:183], v[158:161], v[102:105]
  v_mfma_f32_16x16x32_bf16 v[106:109], a[184:187], v[158:161], v[106:109]
  v_mfma_f32_16x16x32_bf16 v[110:113], a[188:191], v[158:161], v[110:113]
  v_mfma_f32_16x16x32_bf16 v[114:117], a[180:183], v[162:165], v[114:117]
  buffer_load_dwordx4 a[96:99], v14, s[32:35], s18 offen offset:2048 sc1
  v_mfma_f32_16x16x32_bf16 v[118:121], a[184:187], v[162:165], v[118:121]
  v_mfma_f32_16x16x32_bf16 v[122:125], a[188:191], v[162:165], v[122:125]
  s_waitcnt lgkmcnt(0)
  v_mfma_f32_16x16x32_bf16 v[102:105], a[192:195], v[166:169], v[102:105]
  ds_read_b128 v[150:153], v17 offset:36864
  v_mfma_f32_16x16x32_bf16 v[106:109], a[196:199], v[166:169], v[106:109]
  ds_read_b128 v[154:157], v17 offset:37120
  v_mfma_f32_16x16x32_bf16 v[110:113], a[200:203], v[166:169], v[110:113]
  ds_read_b128 v[158:161], v17 offset:38912
  v_mfma_f32_16x16x32_bf16 v[114:117], a[192:195], v[170:173], v[114:117]
  ds_read_b128 v[162:165], v17 offset:39168
  v_mfma_f32_16x16x32_bf16 v[118:121], a[196:199], v[170:173], v[118:121]
  v_mfma_f32_16x16x32_bf16 v[122:125], a[200:203], v[170:173], v[122:125]
  buffer_load_dwordx4 a[100:103], v14, s[32:35], s18 offen offset:3072 sc1
  s_add_u32 s18, s18, 4096
  v_mfma_f32_16x16x32_bf16 v[102:105], a[204:207], v[174:177], v[102:105]
  v_mfma_f32_16x16x32_bf16 v[106:109], a[208:211], v[174:177], v[106:109]
  v_mfma_f32_16x16x32_bf16 v[110:113], a[212:215], v[174:177], v[110:113]
  v_mfma_f32_16x16x32_bf16 v[114:117], a[204:207], v[178:181], v[114:117]
  buffer_load_dwordx4 a[104:107], v14, s[32:35], s18 offen offset:0 sc1
  v_mfma_f32_16x16x32_bf16 v[118:121], a[208:211], v[178:181], v[118:121]
  v_mfma_f32_16x16x32_bf16 v[122:125], a[212:215], v[178:181], v[122:125]
  s_waitcnt lgkmcnt(0)
  v_mfma_f32_16x16x32_bf16 v[102:105], a[216:219], v[150:153], v[102:105]
  ds_read_b128 v[166:169], v18 offset:20480
  v_mfma_f32_16x16x32_bf16 v[106:109], a[220:223], v[150:153], v[106:109]
  s_waitcnt vmcnt(8)
  s_barrier
  s_cmp_lg_u32 s3, 0
  s_cbranch_scc1 L_nf_31
  s_add_u32 s96, s48, 8
  v_mov_b32 v10, s96
  s_mov_b64 exec, 0xffff
  buffer_store_dwordx2 v[10:11], v12, s[32:35], s30 offen offset:0 sc1
  s_mov_b64 exec, -1
L_nf_31:
  ds_read_b128 v[170:173], v18 offset:20736
  v_mfma_f32_16x16x32_bf16 v[110:113], a[224:227], v[150:153], v[110:113]
  ds_read_b128 v[174:177], v18 offset:22528
  v_mfma_f32_16x16x32_bf16 v[114:117], a[216:219], v[154:157], v[114:117]
  ds_read_b128 v[178:181], v18 offset:22784
  v_mfma_f32_16x16x32_bf16 v[118:121], a[220:223], v[154:157], v[118:121]
  v_mfma_f32_16x16x32_bf16 v[122:125], a[224:227], v[154:157], v[122:125]
  buffer_load_dwordx4 a[108:111], v14, s[32:35], s18 offen offset:1024 sc1
  v_mfma_f32_16x16x32_bf16 v[102:105], a[228:231], v[158:161], v[102:105]
  v_mfma_f32_16x16x32_bf16 v[106:109], a[232:235], v[158:161], v[106:109]
  v_mfma_f32_16x16x32_bf16 v[110:113], a[236:239], v[158:161], v[110:113]
  v_mfma_f32_16x16x32_bf16 v[114:117], a[228:231], v[162:165], v[114:117]
  buffer_load_dwordx4 a[112:115], v14, s[32:35], s18 offen offset:2048 sc1
  v_mfma_f32_16x16x32_bf16 v[118:121], a[232:235], v[162:165], v[118:121]
  v_mfma_f32_16x16x32_bf16 v[122:125], a[236:239], v[162:165], v[122:125]
  s_waitcnt lgkmcnt(0)
  v_mfma_f32_16x16x32_bf16 v[126:129], a[120:123], v[166:169], v[126:129]
  ds_read_b128 v[150:153], v18 offset:24576
  s_nop 0
  v_fma_f32 v110, v214, v50, v110
  v_fma_f32 v111, v214, v51, v111
  v_mfma_f32_16x16x32_bf16 v[130:133], a[124:127], v[166:169], v[130:133]
  ds_read_b128 v[154:157], v18 offset:24832
  v_fma_f32 v112, v214, v52, v112
  v_fma_f32 v113, v214, v53, v113
  v_mfma_f32_16x16x32_bf16 v[134:137], a[128:131], v[166:169], v[134:137]
  ds_read_b128 v[158:161], v18 offset:26624
  v_fma_f32 v122, v215, v50, v122
  v_fma_f32 v123, v215, v51, v123
  v_mfma_f32_16x16x32_bf16 v[138:141], a[120:123], v[170:173], v[138:141]
  ds_read_b128 v[162:165], v18 offset:26880
  v_fma_f32 v124, v215, v52, v124
  v_fma_f32 v125, v215, v53, v125
  v_mfma_f32_16x16x32_bf16 v[142:145], a[124:127], v[170:173], v[142:145]
  v_fma_f32 v102, v214, v42, v102
  v_fma_f32 v103, v214, v43, v103
  v_mfma_f32_16x16x32_bf16 v[146:149], a[128:131], v[170:173], v[146:149]
  buffer_load_dwordx4 a[116:119], v14, s[32:35], s18 offen offset:3072 sc1
  s_add_u32 s18, s18, 4096
  v_mfma_f32_16x16x32_bf16 v[126:129], a[132:135], v[174:177], v[126:129]
  v_fma_f32 v104, v214, v44, v104
  v_fma_f32 v105, v214, v45, v105
  v_mfma_f32_16x16x32_bf16 v[130:133], a[136:139], v[174:177], v[130:133]
  v_fma_f32 v106, v214, v46, v106
  v_fma_f32 v107, v214, v47, v107
  v_mfma_f32_16x16x32_bf16 v[134:137], a[140:143], v[174:177], v[134:137]
  v_fma_f32 v108, v214, v48, v108
  v_fma_f32 v109, v214, v49, v109
  v_mfma_f32_16x16x32_bf16 v[138:141], a[132:135], v[178:181], v[138:141]
  buffer_load_dwordx4 a[120:123], v14, s[32:35], s18 offen offset:0 sc1
  v_mfma_f32_16x16x32_bf16 v[142:145], a[136:139], v[178:181], v[142:145]
  v_permlane32_swap_b32 v110, v122
  v_permlane32_swap_b32 v111, v123
  v_mfma_f32_16x16x32_bf16 v[146:149], a[140:143], v[178:181], v[146:149]
  v_permlane32_swap_b32 v112, v124
  s_waitcnt lgkmcnt(0)
  v_mfma_f32_16x16x32_bf16 v[126:129], a[144:147], v[150:153], v[126:129]
  ds_read_b128 v[166:169], v18 offset:28672
  v_permlane32_swap_b32 v113, v125
  v_mul_f32 v242, v218, v102
  v_mfma_f32_16x16x32_bf16 v[130:133], a[148:151], v[150:153], v[130:133]
  ds_read_b128 v[170:173], v18 offset:28928
  v_mul_f32 v243, v218, v103
  v_mul_f32 v244, v218, v104
  v_mfma_f32_16x16x32_bf16 v[134:137], a[152:155], v[150:153], v[134:137]
  ds_read_b128 v[174:177], v18 offset:30720
  v_mul_f32 v245, v218, v105
  v_mul_f32 v102, v102, v106
  v_mfma_f32_16x16x32_bf16 v[138:141], a[144:147], v[154:157], v[138:141]
  ds_read_b128 v[178:181], v18 offset:30976
  v_exp_f32 v242, v242
  v_mfma_f32_16x16x32_bf16 v[142:145], a[148:151], v[154:157], v[142:145]
  v_exp_f32 v243, v243
  v_mfma_f32_16x16x32_bf16 v[146:149], a[152:155], v[154:157], v[146:149]
  buffer_load_dwordx4 a[124:127], v14, s[32:35], s18 offen offset:1024 sc1
  v_mfma_f32_16x16x32_bf16 v[126:129], a[156:159], v[158:161], v[126:129]
  v_exp_f32 v244, v244
  v_mfma_f32_16x16x32_bf16 v[130:133], a[160:163], v[158:161], v[130:133]
  v_exp_f32 v245, v245
  v_mfma_f32_16x16x32_bf16 v[134:137], a[164:167], v[158:161], v[134:137]
  v_mul_f32 v103, v103, v107
  v_mul_f32 v104, v104, v108
  v_mfma_f32_16x16x32_bf16 v[138:141], a[156:159], v[162:165], v[138:141]
  buffer_load_dwordx4 a[128:131], v14, s[32:35], s18 offen offset:2048 sc1
  v_mfma_f32_16x16x32_bf16 v[142:145], a[160:163], v[162:165], v[142:145]
  v_mul_f32 v105, v105, v109
  v_fma_f32 v242, v242, v222, v222
  v_mfma_f32_16x16x32_bf16 v[146:149], a[164:167], v[162:165], v[146:149]
  v_fma_f32 v243, v243, v222, v222
  s_waitcnt lgkmcnt(0)
  v_mfma_f32_16x16x32_bf16 v[126:129], a[168:171], v[166:169], v[126:129]
  ds_read_b128 v[150:153], v18 offset:32768
  v_fma_f32 v244, v244, v222, v222
  v_fma_f32 v245, v245, v222, v222
  v_mfma_f32_16x16x32_bf16 v[130:133], a[172:175], v[166:169], v[130:133]
  ds_read_b128 v[154:157], v18 offset:33024
  v_rcp_f32 v242, v242
  v_mfma_f32_16x16x32_bf16 v[134:137], a[176:179], v[166:169], v[134:137]
  ds_read_b128 v[158:161], v18 offset:34816
  v_rcp_f32 v243, v243
  v_mfma_f32_16x16x32_bf16 v[138:141], a[168:171], v[170:173], v[138:141]
  ds_read_b128 v[162:165], v18 offset:35072
  v_rcp_f32 v244, v244
  v_mfma_f32_16x16x32_bf16 v[142:145], a[172:175], v[170:173], v[142:145]
  v_rcp_f32 v245, v245
  v_mfma_f32_16x16x32_bf16 v[146:149], a[176:179], v[170:173], v[146:149]
  buffer_load_dwordx4 a[132:135], v14, s[32:35], s18 offen offset:3072 sc1
  s_add_u32 s18, s18, 4096
  v_mfma_f32_16x16x32_bf16 v[126:129], a[180:183], v[174:177], v[126:129]
  v_mul_f32 v102, v102, v242
  v_mul_f32 v103, v103, v243
  v_mfma_f32_16x16x32_bf16 v[130:133], a[184:187], v[174:177], v[130:133]
  v_mul_f32 v104, v104, v244
  v_mul_f32 v105, v105, v245
  v_mfma_f32_16x16x32_bf16 v[134:137], a[188:191], v[174:177], v[134:137]
  v_cvt_pk_bf16_f32 v230, v102, v103
  v_cvt_pk_bf16_f32 v231, v104, v105
  v_mfma_f32_16x16x32_bf16 v[138:141], a[180:183], v[178:181], v[138:141]
  buffer_load_dwordx4 a[136:139], v14, s[32:35], s18 offen offset:0 sc1
  v_mfma_f32_16x16x32_bf16 v[142:145], a[184:187], v[178:181], v[142:145]
  v_fma_f32 v114, v215, v42, v114
  v_fma_f32 v115, v215, v43, v115
  v_mfma_f32_16x16x32_bf16 v[146:149], a[188:191], v[178:181], v[146:149]
  v_fma_f32 v116, v215, v44, v116
  s_waitcnt lgkmcnt(0)
  v_mfma_f32_16x16x32_bf16 v[126:129], a[192:195], v[150:153], v[126:129]
  ds_read_b128 v[166:169], v18 offset:36864
  v_fma_f32 v117, v215, v45, v117
  v_fma_f32 v118, v215, v46, v118
  v_mfma_f32_16x16x32_bf16 v[130:133], a[196:199], v[150:153], v[130:133]
  ds_read_b128 v[170:173], v18 offset:37120
  v_fma_f32 v119, v215, v47, v119
  v_fma_f32 v120, v215, v48, v120
  v_mfma_f32_16x16x32_bf16 v[134:137], a[200:203], v[150:153], v[134:137]
  ds_read_b128 v[174:177], v18 offset:38912
  v_fma_f32 v121, v215, v49, v121
  v_mul_f32 v246, v219, v114
  v_mfma_f32_16x16x32_bf16 v[138:141], a[192:195], v[154:157], v[138:141]
  ds_read_b128 v[178:181], v18 offset:39168
  v_mul_f32 v247, v219, v115
  v_mul_f32 v248, v219, v116
  v_mfma_f32_16x16x32_bf16 v[142:145], a[196:199], v[154:157], v[142:145]
  ds_read_b128 a[184:187], v6 offset:28672
  v_mul_f32 v249, v219, v117
  v_mul_f32 v114, v114, v118
  v_mfma_f32_16x16x32_bf16 v[146:149], a[200:203], v[154:157], v[146:149]
  ds_read_b128 a[188:191], v6 offset:32768
  buffer_load_dwordx4 a[140:143], v14, s[32:35], s18 offen offset:1024 sc1
  v_mfma_f32_16x16x32_bf16 v[126:129], a[204:207], v[158:161], v[126:129]
  ds_read_b128 a[192:195], v6 offset:36864
  v_exp_f32 v246, v246
  v_mfma_f32_16x16x32_bf16 v[130:133], a[208:211], v[158:161], v[130:133]
  ds_read_b128 a[196:199], v6 offset:40960
  v_exp_f32 v247, v247
  v_mfma_f32_16x16x32_bf16 v[134:137], a[212:215], v[158:161], v[134:137]
  v_exp_f32 v248, v248
  v_mfma_f32_16x16x32_bf16 v[138:141], a[204:207], v[162:165], v[138:141]
  buffer_load_dwordx4 a[144:147], v14, s[32:35], s18 offen offset:2048 sc1
  v_mfma_f32_16x16x32_bf16 v[142:145], a[208:211], v[162:165], v[142:145]
  v_exp_f32 v249, v249
  v_mfma_f32_16x16x32_bf16 v[146:149], a[212:215], v[162:165], v[146:149]
  v_mul_f32 v115, v115, v119
  s_waitcnt lgkmcnt(0)
  v_mfma_f32_16x16x32_bf16 v[126:129], a[216:219], v[166:169], v[126:129]
  ds_read_b128 a[200:203], v6 offset:45056
  v_mul_f32 v116, v116, v120
  v_mul_f32 v117, v117, v121
  v_mfma_f32_16x16x32_bf16 v[130:133], a[220:223], v[166:169], v[130:133]
  ds_read_b128 a[204:207], v6 offset:49152
  v_fma_f32 v246, v246, v223, v223
  v_fma_f32 v247, v247, v223, v223
  v_mfma_f32_16x16x32_bf16 v[134:137], a[224:227], v[166:169], v[134:137]
  ds_read_b128 a[208:211], v6 offset:53248
  v_fma_f32 v248, v248, v223, v223
  v_fma_f32 v249, v249, v223, v223
  v_mfma_f32_16x16x32_bf16 v[138:141], a[216:219], v[170:173], v[138:141]
  ds_read_b128 a[212:215], v6 offset:57344
  v_rcp_f32 v246, v246
  v_mfma_f32_16x16x32_bf16 v[142:145], a[220:223], v[170:173], v[142:145]
  ds_read_b128 a[216:219], v6 offset:61440
  v_rcp_f32 v247, v247
  v_mfma_f32_16x16x32_bf16 v[146:149], a[224:227], v[170:173], v[146:149]
  ds_read_b128 a[220:223], v6 offset:24576
  buffer_load_dwordx4 a[148:151], v14, s[32:35], s18 offen offset:3072 sc1
  s_add_u32 s18, s18, 4096
  v_mfma_f32_16x16x32_bf16 v[126:129], a[228:231], v[174:177], v[126:129]
  v_rcp_f32 v248, v248
  v_mfma_f32_16x16x32_bf16 v[130:133], a[232:235], v[174:177], v[130:133]
  v_rcp_f32 v249, v249
  v_mfma_f32_16x16x32_bf16 v[134:137], a[236:239], v[174:177], v[134:137]
  v_mul_f32 v114, v114, v246
  v_mul_f32 v115, v115, v247
  v_mfma_f32_16x16x32_bf16 v[138:141], a[228:231], v[178:181], v[138:141]
  buffer_load_dwordx4 a[152:155], v14, s[32:35], s18 offen offset:0 sc1
  v_mfma_f32_16x16x32_bf16 v[142:145], a[232:235], v[178:181], v[142:145]
  v_mul_f32 v116, v116, v248
  v_mul_f32 v117, v117, v249
  v_mfma_f32_16x16x32_bf16 v[146:149], a[236:239], v[178:181], v[146:149]
  v_cvt_pk_bf16_f32 v232, v114, v115
  v_cvt_pk_bf16_f32 v233, v116, v117
  v_mul_f32 v242, v226, v110
  v_mul_f32 v243, v226, v111
  v_mul_f32 v244, v226, v112
  v_mul_f32 v245, v226, v113
  v_permlane16_swap_b32 v230, v232
  v_permlane16_swap_b32 v231, v233
  buffer_store_dwordx4 v[230:233], v14, s[32:35], s12 offen sc1
  v_exp_f32 v242, v242
  v_exp_f32 v243, v243
  v_exp_f32 v244, v244
  v_exp_f32 v245, v245
  v_mul_f32 v110, v110, v122
  v_mul_f32 v111, v111, v123
  v_mul_f32 v112, v112, v124
  v_mul_f32 v113, v113, v125
  v_fma_f32 v242, v242, v228, v228
  v_fma_f32 v243, v243, v228, v228
  v_fma_f32 v244, v244, v228, v228
  v_fma_f32 v245, v245, v228, v228
  v_rcp_f32 v242, v242
  v_rcp_f32 v243, v243
  v_rcp_f32 v244, v244
  v_rcp_f32 v245, v245
  v_mul_f32 v110, v110, v242
  v_mul_f32 v111, v111, v243
  v_mul_f32 v112, v112, v244
  v_mul_f32 v113, v113, v245
  v_cvt_pk_bf16_f32 v238, v110, v111
  v_cvt_pk_bf16_f32 v239, v112, v113
  v_pk_fma_f32 v[134:135], v[50:51], v[216:217], v[134:135] op_sel_hi:[1,0,1]
  s_cmp_lg_u32 s3, 1
  s_cbranch_scc1 L_np_32
  s_load_dwordx16 s[64:79], s[32:33], s98 offset:0 glc
  s_load_dwordx16 s[80:95], s[32:33], s98 offset:64 glc
L_np_32:
  buffer_load_dwordx4 a[156:159], v14, s[32:35], s18 offen offset:1024 sc1
  v_pk_fma_f32 v[136:137], v[52:53], v[216:217], v[136:137] op_sel_hi:[1,0,1]
  v_pk_fma_f32 v[146:147], v[50:51], v[216:217], v[146:147] op_sel:[0,1,0] op_sel_hi:[1,1,1]
  v_pk_fma_f32 v[148:149], v[52:53], v[216:217], v[148:149] op_sel:[0,1,0] op_sel_hi:[1,1,1]
  v_pk_fma_f32 v[126:127], v[42:43], v[216:217], v[126:127] op_sel_hi:[1,0,1]
  v_pk_fma_f32 v[128:129], v[44:45], v[216:217], v[128:129] op_sel_hi:[1,0,1]
  v_pk_fma_f32 v[130:131], v[46:47], v[216:217], v[130:131] op_sel_hi:[1,0,1]
  v_pk_fma_f32 v[132:133], v[48:49], v[216:217], v[132:133] op_sel_hi:[1,0,1]
  v_permlane32_swap_b32 v134, v146
  v_permlane32_swap_b32 v135, v147
  v_permlane32_swap_b32 v136, v148
  v_permlane32_swap_b32 v137, v149
  v_pk_mul_f32 v[246:247], v[126:127], v[220:221] op_sel_hi:[1,0]
  v_pk_mul_f32 v[248:249], v[128:129], v[220:221] op_sel_hi:[1,0]
  v_exp_f32 v246, v246
  v_exp_f32 v247, v247
  buffer_load_dwordx4 a[160:163], v14, s[32:35], s18 offen offset:2048 sc1
  v_exp_f32 v248, v248
  v_exp_f32 v249, v249
  v_pk_mul_f32 v[126:127], v[126:127], v[130:131]
  v_pk_mul_f32 v[128:129], v[128:129], v[132:133]
  v_pk_fma_f32 v[246:247], v[246:247], v[224:225], v[224:225] op_sel_hi:[1,0,0]
  v_pk_fma_f32 v[248:249], v[248:249], v[224:225], v[224:225] op_sel_hi:[1,0,0]
  v_rcp_f32 v246, v246
  v_rcp_f32 v247, v247
  v_rcp_f32 v248, v248
  v_rcp_f32 v249, v249
  v_pk_mul_f32 v[126:127], v[126:127], v[246:247]
  v_pk_mul_f32 v[128:129], v[128:129], v[248:249]
  v_cvt_pk_bf16_f32 v234, v126, v127
  v_cvt_pk_bf16_f32 v235, v128, v129
  v_pk_fma_f32 v[138:139], v[42:43], v[216:217], v[138:139] op_sel:[0,1,0] op_sel_hi:[1,1,1]
  v_pk_fma_f32 v[140:141], v[44:45], v[216:217], v[140:141] op_sel:[0,1,0] op_sel_hi:[1,1,1]
  buffer_load_dwordx4 a[164:167], v14, s[32:35], s18 offen offset:3072 sc1
  s_add_u32 s18, s18, 4096
  v_pk_fma_f32 v[142:143], v[46:47], v[216:217], v[142:143] op_sel:[0,1,0] op_sel_hi:[1,1,1]
  v_pk_fma_f32 v[144:145], v[48:49], v[216:217], v[144:145] op_sel:[0,1,0] op_sel_hi:[1,1,1]
  v_pk_mul_f32 v[242:243], v[138:139], v[220:221] op_sel:[0,1]
  v_pk_mul_f32 v[244:245], v[140:141], v[220:221] op_sel:[0,1]
  v_exp_f32 v242, v242
  v_exp_f32 v243, v243
  v_exp_f32 v244, v244
  v_exp_f32 v245, v245
  v_pk_mul_f32 v[138:139], v[138:139], v[142:143]
  v_pk_mul_f32 v[140:141], v[140:141], v[144:145]
  v_pk_fma_f32 v[242:243], v[242:243], v[224:225], v[224:225] op_sel:[0,1,1]
  v_pk_fma_f32 v[244:245], v[244:245], v[224:225], v[224:225] op_sel:[0,1,1]
  v_rcp_f32 v242, v242
  v_rcp_f32 v243, v243
  v_rcp_f32 v244, v244
  s_add_u32 s62, s48, 8
  s_mov_b32 s63, s49
  s_waitcnt lgkmcnt(0)
  s_xor_b64 s[64:65], s[64:65], s[62:63]
  v_rcp_f32 v245, v245
  s_xor_b64 s[66:67], s[66:67], s[62:63]
  s_or_b64 s[64:65], s[64:65], s[66:67]
  v_pk_mul_f32 v[138:139], v[138:139], v[242:243]
  v_pk_mul_f32 v[140:141], v[140:141], v[244:245]
  s_xor_b64 s[68:69], s[68:69], s[62:63]
  s_or_b64 s[64:65], s[64:65], s[68:69]
  v_cvt_pk_bf16_f32 v236, v138, v139
  v_cvt_pk_bf16_f32 v237, v140, v141
  s_xor_b64 s[70:71], s[70:71], s[62:63]
  s_or_b64 s[64:65], s[64:65], s[70:71]
  v_pk_mul_f32 v[246:247], v[134:135], v[226:227] op_sel:[0,1]
  v_pk_mul_f32 v[248:249], v[136:137], v[226:227] op_sel:[0,1]
  s_xor_b64 s[72:73], s[72:73], s[62:63]
  s_or_b64 s[64:65], s[64:65], s[72:73]
  v_exp_f32 v246, v246
  s_xor_b64 s[74:75], s[74:75], s[62:63]
  s_or_b64 s[64:65], s[64:65], s[74:75]
  v_exp_f32 v247, v247
  s_xor_b64 s[76:77], s[76:77], s[62:63]
  s_or_b64 s[64:65], s[64:65], s[76:77]
  v_permlane16_swap_b32 v234, v236
  v_permlane16_swap_b32 v235, v237
  s_xor_b64 s[78:79], s[78:79], s[62:63]
  s_or_b64 s[64:65], s[64:65], s[78:79]
  s_add_u32 s55, s12, 196608
  buffer_store_dwordx4 v[234:237], v14, s[32:35], s55 offen sc1
  v_exp_f32 v248, v248
  s_xor_b64 s[80:81], s[80:81], s[62:63]
  s_or_b64 s[64:65], s[64:65], s[80:81]
  s_xor_b64 s[82:83], s[82:83], s[62:63]
  s_or_b64 s[64:65], s[64:65], s[82:83]
  v_exp_f32 v249, v249
  s_xor_b64 s[84:85], s[84:85], s[62:63]
  s_or_b64 s[64:65], s[64:65], s[84:85]
  v_pk_mul_f32 v[134:135], v[134:135], v[146:147]
  v_pk_mul_f32 v[136:137], v[136:137], v[148:149]
  s_xor_b64 s[86:87], s[86:87], s[62:63]
  s_or_b64 s[64:65], s[64:65], s[86:87]
  v_pk_fma_f32 v[246:247], v[246:247], v[228:229], v[228:229] op_sel:[0,1,1]
  v_pk_fma_f32 v[248:249], v[248:249], v[228:229], v[228:229] op_sel:[0,1,1]
  s_xor_b64 s[88:89], s[88:89], s[62:63]
  s_or_b64 s[64:65], s[64:65], s[88:89]
  v_rcp_f32 v246, v246
  s_xor_b64 s[90:91], s[90:91], s[62:63]
  s_or_b64 s[64:65], s[64:65], s[90:91]
  v_rcp_f32 v247, v247
  s_xor_b64 s[92:93], s[92:93], s[62:63]
  s_or_b64 s[64:65], s[64:65], s[92:93]
  v_rcp_f32 v248, v248
  s_xor_b64 s[94:95], s[94:95], s[62:63]
  s_or_b64 s[64:65], s[64:65], s[94:95]
  v_rcp_f32 v249, v249
  buffer_load_dwordx4 a[168:171], v14, s[32:35], s18 offen offset:0 sc1
  v_pk_mul_f32 v[134:135], v[134:135], v[246:247]
  v_pk_mul_f32 v[136:137], v[136:137], v[248:249]
  v_cvt_pk_bf16_f32 v240, v134, v135
  v_cvt_pk_bf16_f32 v241, v136, v137
  s_nop 0
  v_permlane16_swap_b32 v238, v240
  v_permlane16_swap_b32 v239, v241
  buffer_store_dwordx4 v[238:241], v29, s[32:35], s12 offen offset:1024 sc1
  s_cmp_lg_u32 s3, 1
  s_cbranch_scc1 L_pdone_35
  s_mov_b32 s99, 0
  s_cmp_eq_u64 s[64:65], 0
  s_cbranch_scc1 L_pdone_35
L_poll_33:
  s_load_dwordx16 s[64:79], s[32:33], s98 offset:0 glc
  s_load_dwordx16 s[80:95], s[32:33], s98 offset:64 glc
  s_add_u32 s99, s99, 1
L_pchk_34:
  s_waitcnt lgkmcnt(0)
  s_xor_b64 s[64:65], s[64:65], s[62:63]
  s_xor_b64 s[66:67], s[66:67], s[62:63]
  s_or_b64 s[64:65], s[64:65], s[66:67]
  s_xor_b64 s[68:69], s[68:69], s[62:63]
  s_or_b64 s[64:65], s[64:65], s[68:69]
  s_xor_b64 s[70:71], s[70:71], s[62:63]
  s_or_b64 s[64:65], s[64:65], s[70:71]
  s_xor_b64 s[72:73], s[72:73], s[62:63]
  s_or_b64 s[64:65], s[64:65], s[72:73]
  s_xor_b64 s[74:75], s[74:75], s[62:63]
  s_or_b64 s[64:65], s[64:65], s[74:75]
  s_xor_b64 s[76:77], s[76:77], s[62:63]
  s_or_b64 s[64:65], s[64:65], s[76:77]
  s_xor_b64 s[78:79], s[78:79], s[62:63]
  s_or_b64 s[64:65], s[64:65], s[78:79]
  s_xor_b64 s[80:81], s[80:81], s[62:63]
  s_or_b64 s[64:65], s[64:65], s[80:81]
  s_xor_b64 s[82:83], s[82:83], s[62:63]
  s_or_b64 s[64:65], s[64:65], s[82:83]
  s_xor_b64 s[84:85], s[84:85], s[62:63]
  s_or_b64 s[64:65], s[64:65], s[84:85]
  s_xor_b64 s[86:87], s[86:87], s[62:63]
  s_or_b64 s[64:65], s[64:65], s[86:87]
  s_xor_b64 s[88:89], s[88:89], s[62:63]
  s_or_b64 s[64:65], s[64:65], s[88:89]
  s_xor_b64 s[90:91], s[90:91], s[62:63]
  s_or_b64 s[64:65], s[64:65], s[90:91]
  s_xor_b64 s[92:93], s[92:93], s[62:63]
  s_or_b64 s[64:65], s[64:65], s[92:93]
  s_xor_b64 s[94:95], s[94:95], s[62:63]
  s_or_b64 s[64:65], s[64:65], s[94:95]
  s_cbranch_scc0 L_pdone_35
  s_cmp_lt_u32 s99, 0x8000
  s_cbranch_scc1 L_poll_33
L_pdone_35:
  s_barrier
  v_add_u32 v21, 0x14000, v21
  v_add_u32 v22, 0x14000, v22
  v_add_u32 v23, 0x14000, v23
  buffer_load_dwordx4 v[54:57], v20, s[32:35], s13 offen offset:0 sc1
  buffer_load_dwordx4 v[58:61], v20, s[32:35], s13 offen offset:256 sc1
  buffer_load_dwordx4 v[62:65], v20, s[32:35], s13 offen offset:2048 sc1
  buffer_load_dwordx4 v[66:69], v20, s[32:35], s13 offen offset:2304 sc1
  s_add_u32 s13, s13, 4096
  buffer_load_dwordx4 v[70:73], v20, s[32:35], s13 offen offset:0 sc1
  buffer_load_dwordx4 v[74:77], v20, s[32:35], s13 offen offset:256 sc1
  buffer_load_dwordx4 v[78:81], v20, s[32:35], s13 offen offset:2048 sc1
  buffer_load_dwordx4 v[82:85], v20, s[32:35], s13 offen offset:2304 sc1
  s_add_u32 s13, s13, 4096
  buffer_load_dwordx4 v[86:89], v20, s[32:35], s13 offen offset:0 sc1
  buffer_load_dwordx4 v[90:93], v20, s[32:35], s13 offen offset:256 sc1
  buffer_load_dwordx4 v[94:97], v20, s[32:35], s13 offen offset:2048 sc1
  buffer_load_dwordx4 v[98:101], v20, s[32:35], s13 offen offset:2304 sc1
  s_add_u32 s13, s13, 4096
  s_waitcnt vmcnt(12)
  s_barrier
  s_cmp_lg_u32 s3, 0
  s_cbranch_scc1 L_nf_36
  s_add_u32 s96, s48, 9
  v_mov_b32 v10, s96
  s_mov_b64 exec, 0xffff
  buffer_store_dwordx2 v[10:11], v12, s[32:35], s30 offen offset:128 sc1
  s_mov_b64 exec, -1
L_nf_36:
  s_waitcnt vmcnt(11)
  v_mfma_f32_16x16x32_bf16 v[102:105], a[240:243], v[54:57], 0
  buffer_load_dwordx4 v[150:153], v20, s[32:35], s13 offen offset:0 sc1
  v_mfma_f32_16x16x32_bf16 v[106:109], a[244:247], v[54:57], 0
  v_mfma_f32_16x16x32_bf16 v[110:113], a[248:251], v[54:57], 0
  v_mfma_f32_16x16x32_bf16 v[114:117], a[252:255], v[54:57], 0
  buffer_load_dwordx4 v[154:157], v20, s[32:35], s13 offen offset:256 sc1
  v_mfma_f32_16x16x32_bf16 v[118:121], a[184:187], v[54:57], 0
  s_waitcnt vmcnt(12)
  v_mfma_f32_16x16x32_bf16 v[122:125], a[240:243], v[58:61], 0
  v_mfma_f32_16x16x32_bf16 v[126:129], a[244:247], v[58:61], 0
  v_mfma_f32_16x16x32_bf16 v[130:133], a[248:251], v[58:61], 0
  buffer_load_dwordx4 v[158:161], v20, s[32:35], s13 offen offset:2048 sc1
  v_mfma_f32_16x16x32_bf16 v[134:137], a[252:255], v[58:61], 0
  v_mfma_f32_16x16x32_bf16 v[138:141], a[184:187], v[58:61], 0
  s_waitcnt vmcnt(12)
  v_mfma_f32_16x16x32_bf16 v[102:105], a[188:191], v[62:65], v[102:105]
  buffer_load_dwordx4 v[162:165], v20, s[32:35], s13 offen offset:2304 sc1
  s_add_u32 s13, s13, 4096
  v_mfma_f32_16x16x32_bf16 v[106:109], a[192:195], v[62:65], v[106:109]
  v_mfma_f32_16x16x32_bf16 v[110:113], a[196:199], v[62:65], v[110:113]
  v_mfma_f32_16x16x32_bf16 v[114:117], a[200:203], v[62:65], v[114:117]
  v_mfma_f32_16x16x32_bf16 v[118:121], a[204:207], v[62:65], v[118:121]
  buffer_load_dwordx4 v[166:169], v20, s[32:35], s13 offen offset:0 sc1
  s_waitcnt vmcnt(13)
  v_mfma_f32_16x16x32_bf16 v[122:125], a[188:191], v[66:69], v[122:125]
  v_mfma_f32_16x16x32_bf16 v[126:129], a[192:195], v[66:69], v[126:129]
  v_mfma_f32_16x16x32_bf16 v[130:133], a[196:199], v[66:69], v[130:133]
  buffer_load_dwordx4 v[170:173], v20, s[32:35], s13 offen offset:256 sc1
  v_mfma_f32_16x16x32_bf16 v[134:137], a[200:203], v[66:69], v[134:137]
  v_mfma_f32_16x16x32_bf16 v[138:141], a[204:207], v[66:69], v[138:141]
  s_waitcnt vmcnt(13)
  v_mfma_f32_16x16x32_bf16 v[102:105], a[208:211], v[70:73], v[102:105]
  v_mfma_f32_16x16x32_bf16 v[106:109], a[212:215], v[70:73], v[106:109]
  buffer_load_dwordx4 v[174:177], v20, s[32:35], s13 offen offset:2048 sc1
  v_mfma_f32_16x16x32_bf16 v[110:113], a[216:219], v[70:73], v[110:113]
  v_mfma_f32_16x16x32_bf16 v[114:117], a[220:223], v[70:73], v[114:117]
  v_mfma_f32_16x16x32_bf16 v[118:121], a[0:3], v[70:73], v[118:121]
  buffer_load_dwordx4 v[178:181], v20, s[32:35], s13 offen offset:2304 sc1
  s_add_u32 s13, s13, 4096
  s_waitcnt vmcnt(14)
  v_mfma_f32_16x16x32_bf16 v[122:125], a[208:211], v[74:77], v[122:125]
  v_mfma_f32_16x16x32_bf16 v[126:129], a[212:215], v[74:77], v[126:129]
  v_mfma_f32_16x16x32_bf16 v[130:133], a[216:219], v[74:77], v[130:133]
  v_mfma_f32_16x16x32_bf16 v[134:137], a[220:223], v[74:77], v[134:137]
  buffer_load_dwordx4 v[198:201], v20, s[32:35], s13 offen offset:0 sc1
  v_mfma_f32_16x16x32_bf16 v[138:141], a[0:3], v[74:77], v[138:141]
  s_waitcnt vmcnt(14)
  v_mfma_f32_16x16x32_bf16 v[102:105], a[4:7], v[78:81], v[102:105]
  v_mfma_f32_16x16x32_bf16 v[106:109], a[8:11], v[78:81], v[106:109]
  buffer_load_dwordx4 v[202:205], v20, s[32:35], s13 offen offset:256 sc1
  v_mfma_f32_16x16x32_bf16 v[110:113], a[12:15], v[78:81], v[110:113]
  v_mfma_f32_16x16x32_bf16 v[114:117], a[16:19], v[78:81], v[114:117]
  v_mfma_f32_16x16x32_bf16 v[118:121], a[20:23], v[78:81], v[118:121]
  s_waitcnt vmcnt(14)
  v_mfma_f32_16x16x32_bf16 v[122:125], a[4:7], v[82:85], v[122:125]
  buffer_load_dwordx4 v[206:209], v20, s[32:35], s13 offen offset:2048 sc1
  v_mfma_f32_16x16x32_bf16 v[126:129], a[8:11], v[82:85], v[126:129]
  v_mfma_f32_16x16x32_bf16 v[130:133], a[12:15], v[82:85], v[130:133]
  v_mfma_f32_16x16x32_bf16 v[134:137], a[16:19], v[82:85], v[134:137]
  buffer_load_dwordx4 v[210:213], v20, s[32:35], s13 offen offset:2304 sc1
  s_add_u32 s13, s13, 4096
  v_mfma_f32_16x16x32_bf16 v[138:141], a[20:23], v[82:85], v[138:141]
  s_waitcnt vmcnt(15)
  v_mfma_f32_16x16x32_bf16 v[102:105], a[24:27], v[86:89], v[102:105]
  v_mfma_f32_16x16x32_bf16 v[106:109], a[28:31], v[86:89], v[106:109]
  v_mfma_f32_16x16x32_bf16 v[110:113], a[32:35], v[86:89], v[110:113]
  buffer_load_dwordx4 a[172:175], v14, s[32:35], s18 offen offset:1024 sc1
  v_mfma_f32_16x16x32_bf16 v[114:117], a[36:39], v[86:89], v[114:117]
  v_mfma_f32_16x16x32_bf16 v[118:121], a[40:43], v[86:89], v[118:121]
  s_waitcnt vmcnt(15)
  v_mfma_f32_16x16x32_bf16 v[122:125], a[24:27], v[90:93], v[122:125]
  s_cmp_lg_u32 s3, 1
  s_cbranch_scc1 L_np_37
  s_load_dwordx16 s[64:79], s[32:33], s98 offset:128 glc
  s_load_dwordx16 s[80:95], s[32:33], s98 offset:192 glc
L_np_37:
  buffer_load_dwordx4 a[176:179], v14, s[32:35], s18 offen offset:2048 sc1
  v_mfma_f32_16x16x32_bf16 v[126:129], a[28:31], v[90:93], v[126:129]
  v_mfma_f32_16x16x32_bf16 v[130:133], a[32:35], v[90:93], v[130:133]
  v_mfma_f32_16x16x32_bf16 v[134:137], a[36:39], v[90:93], v[134:137]
  buffer_load_dwordx4 a[180:183], v14, s[32:35], s18 offen offset:3072 sc1
  s_add_u32 s18, s18, 4096
  v_mfma_f32_16x16x32_bf16 v[138:141], a[40:43], v[90:93], v[138:141]
  s_waitcnt vmcnt(16)
  v_mfma_f32_16x16x32_bf16 v[102:105], a[44:47], v[94:97], v[102:105]
  v_mfma_f32_16x16x32_bf16 v[106:109], a[48:51], v[94:97], v[106:109]
  v_mfma_f32_16x16x32_bf16 v[110:113], a[52:55], v[94:97], v[110:113]
  v_mfma_f32_16x16x32_bf16 v[114:117], a[56:59], v[94:97], v[114:117]
  v_mfma_f32_16x16x32_bf16 v[118:121], a[60:63], v[94:97], v[118:121]
  s_waitcnt vmcnt(15)
  v_mfma_f32_16x16x32_bf16 v[122:125], a[44:47], v[98:101], v[122:125]
  v_mfma_f32_16x16x32_bf16 v[126:129], a[48:51], v[98:101], v[126:129]
  v_mfma_f32_16x16x32_bf16 v[130:133], a[52:55], v[98:101], v[130:133]
  v_mfma_f32_16x16x32_bf16 v[134:137], a[56:59], v[98:101], v[134:137]
  v_mfma_f32_16x16x32_bf16 v[138:141], a[60:63], v[98:101], v[138:141]
  s_waitcnt vmcnt(14)
  v_mfma_f32_16x16x32_bf16 v[102:105], a[64:67], v[150:153], v[102:105]
  v_mfma_f32_16x16x32_bf16 v[106:109], a[68:71], v[150:153], v[106:109]
  v_mfma_f32_16x16x32_bf16 v[110:113], a[72:75], v[150:153], v[110:113]
  v_mfma_f32_16x16x32_bf16 v[114:117], a[76:79], v[150:153], v[114:117]
  v_mfma_f32_16x16x32_bf16 v[118:121], a[80:83], v[150:153], v[118:121]
  s_waitcnt vmcnt(13)
  v_mfma_f32_16x16x32_bf16 v[122:125], a[64:67], v[154:157], v[122:125]
  s_add_u32 s62, s48, 9
  s_mov_b32 s63, s49
  v_mfma_f32_16x16x32_bf16 v[126:129], a[68:71], v[154:157], v[126:129]
  s_waitcnt lgkmcnt(0)
  s_xor_b64 s[64:65], s[64:65], s[62:63]
  v_mfma_f32_16x16x32_bf16 v[130:133], a[72:75], v[154:157], v[130:133]
  s_xor_b64 s[66:67], s[66:67], s[62:63]
  s_or_b64 s[64:65], s[64:65], s[66:67]
  v_mfma_f32_16x16x32_bf16 v[134:137], a[76:79], v[154:157], v[134:137]
  s_xor_b64 s[68:69], s[68:69], s[62:63]
  s_or_b64 s[64:65], s[64:65], s[68:69]
  v_mfma_f32_16x16x32_bf16 v[138:141], a[80:83], v[154:157], v[138:141]
  s_xor_b64 s[70:71], s[70:71], s[62:63]
  s_or_b64 s[64:65], s[64:65], s[70:71]
  s_waitcnt vmcnt(12)
  v_mfma_f32_16x16x32_bf16 v[102:105], a[84:87], v[158:161], v[102:105]
  s_xor_b64 s[72:73], s[72:73], s[62:63]
  s_or_b64 s[64:65], s[64:65], s[72:73]
  v_mfma_f32_16x16x32_bf16 v[106:109], a[88:91], v[158:161], v[106:109]
  s_xor_b64 s[74:75], s[74:75], s[62:63]
  s_or_b64 s[64:65], s[64:65], s[74:75]
  v_mfma_f32_16x16x32_bf16 v[110:113], a[92:95], v[158:161], v[110:113]
  s_xor_b64 s[76:77], s[76:77], s[62:63]
  s_or_b64 s[64:65], s[64:65], s[76:77]
  v_mfma_f32_16x16x32_bf16 v[114:117], a[96:99], v[158:161], v[114:117]
  s_xor_b64 s[78:79], s[78:79], s[62:63]
  s_or_b64 s[64:65], s[64:65], s[78:79]
  v_mfma_f32_16x16x32_bf16 v[118:121], a[100:103], v[158:161], v[118:121]
  s_xor_b64 s[80:81], s[80:81], s[62:63]
  s_or_b64 s[64:65], s[64:65], s[80:81]
  s_waitcnt vmcnt(11)
  v_mfma_f32_16x16x32_bf16 v[122:125], a[84:87], v[162:165], v[122:125]
  s_xor_b64 s[82:83], s[82:83], s[62:63]
  s_or_b64 s[64:65], s[64:65], s[82:83]
  v_mfma_f32_16x16x32_bf16 v[126:129], a[88:91], v[162:165], v[126:129]
  s_xor_b64 s[84:85], s[84:85], s[62:63]
  s_or_b64 s[64:65], s[64:65], s[84:85]
  v_mfma_f32_16x16x32_bf16 v[130:133], a[92:95], v[162:165], v[130:133]
  s_xor_b64 s[86:87], s[86:87], s[62:63]
  s_or_b64 s[64:65], s[64:65], s[86:87]
  v_mfma_f32_16x16x32_bf16 v[134:137], a[96:99], v[162:165], v[134:137]
  s_xor_b64 s[88:89], s[88:89], s[62:63]
  s_or_b64 s[64:65], s[64:65], s[88:89]
  v_mfma_f32_16x16x32_bf16 v[138:141], a[100:103], v[162:165], v[138:141]
  s_xor_b64 s[90:91], s[90:91], s[62:63]
  s_or_b64 s[64:65], s[64:65], s[90:91]
  s_waitcnt vmcnt(10)
  v_mfma_f32_16x16x32_bf16 v[102:105], a[104:107], v[166:169], v[102:105]
  s_xor_b64 s[92:93], s[92:93], s[62:63]
  s_or_b64 s[64:65], s[64:65], s[92:93]
  v_mfma_f32_16x16x32_bf16 v[106:109], a[108:111], v[166:169], v[106:109]
  s_xor_b64 s[94:95], s[94:95], s[62:63]
  s_or_b64 s[64:65], s[64:65], s[94:95]
  s_waitcnt vmcnt(8)
  v_mfma_f32_16x16x32_bf16 v[102:105], a[124:127], v[174:177], v[102:105]
  v_mfma_f32_16x16x32_bf16 v[106:109], a[128:131], v[174:177], v[106:109]
  s_waitcnt vmcnt(6)
  v_mfma_f32_16x16x32_bf16 v[102:105], a[144:147], v[198:201], v[102:105]
  s_cmp_lg_u32 s3, 1
  s_cbranch_scc1 L_pdone_40
  s_mov_b32 s99, 0
  s_cmp_eq_u64 s[64:65], 0
  s_cbranch_scc1 L_pdone_40
L_poll_38:
  s_load_dwordx16 s[64:79], s[32:33], s98 offset:128 glc
  s_load_dwordx16 s[80:95], s[32:33], s98 offset:192 glc
  s_add_u32 s99, s99, 1
L_pchk_39:
  s_waitcnt lgkmcnt(0)
  s_xor_b64 s[64:65], s[64:65], s[62:63]
  s_xor_b64 s[66:67], s[66:67], s[62:63]
  s_or_b64 s[64:65], s[64:65], s[66:67]
  s_xor_b64 s[68:69], s[68:69], s[62:63]
  s_or_b64 s[64:65], s[64:65], s[68:69]
  s_xor_b64 s[70:71], s[70:71], s[62:63]
  s_or_b64 s[64:65], s[64:65], s[70:71]
  s_xor_b64 s[72:73], s[72:73], s[62:63]
  s_or_b64 s[64:65], s[64:65], s[72:73]
  s_xor_b64 s[74:75], s[74:75], s[62:63]
  s_or_b64 s[64:65], s[64:65], s[74:75]
  s_xor_b64 s[76:77], s[76:77], s[62:63]
  s_or_b64 s[64:65], s[64:65], s[76:77]
  s_xor_b64 s[78:79], s[78:79], s[62:63]
  s_or_b64 s[64:65], s[64:65], s[78:79]
  s_xor_b64 s[80:81], s[80:81], s[62:63]
  s_or_b64 s[64:65], s[64:65], s[80:81]
  s_xor_b64 s[82:83], s[82:83], s[62:63]
  s_or_b64 s[64:65], s[64:65], s[82:83]
  s_xor_b64 s[84:85], s[84:85], s[62:63]
  s_or_b64 s[64:65], s[64:65], s[84:85]
  s_xor_b64 s[86:87], s[86:87], s[62:63]
  s_or_b64 s[64:65], s[64:65], s[86:87]
  s_xor_b64 s[88:89], s[88:89], s[62:63]
  s_or_b64 s[64:65], s[64:65], s[88:89]
  s_xor_b64 s[90:91], s[90:91], s[62:63]
  s_or_b64 s[64:65], s[64:65], s[90:91]
  s_xor_b64 s[92:93], s[92:93], s[62:63]
  s_or_b64 s[64:65], s[64:65], s[92:93]
  s_xor_b64 s[94:95], s[94:95], s[62:63]
  s_or_b64 s[64:65], s[64:65], s[94:95]
  s_cbranch_scc0 L_pdone_40
  s_cmp_lt_u32 s99, 0x8000
  s_cbranch_scc1 L_poll_38
L_pdone_40:
  s_barrier
  buffer_load_dwordx4 v[54:57], v20, s[32:35], s4 offen offset:0 sc1
  buffer_load_dwordx4 v[58:61], v20, s[32:35], s4 offen offset:256 sc1
  v_mfma_f32_16x16x32_bf16 v[106:109], a[148:151], v[198:201], v[106:109]
  s_waitcnt vmcnt(6)
  v_mfma_f32_16x16x32_bf16 v[102:105], a[164:167], v[206:209], v[102:105]
  v_mfma_f32_16x16x32_bf16 v[106:109], a[168:171], v[206:209], v[106:109]
  buffer_load_dwordx4 v[62:65], v20, s[32:35], s4 offen offset:2048 sc1
  v_mfma_f32_16x16x32_bf16 v[110:113], a[112:115], v[166:169], v[110:113]
  v_mfma_f32_16x16x32_bf16 v[114:117], a[116:119], v[166:169], v[114:117]
  v_mfma_f32_16x16x32_bf16 v[110:113], a[132:135], v[174:177], v[110:113]
  v_mfma_f32_16x16x32_bf16 v[114:117], a[136:139], v[174:177], v[114:117]
  buffer_load_dwordx4 v[66:69], v20, s[32:35], s4 offen offset:2304 sc1
  s_add_u32 s4, s4, 4096
  v_mfma_f32_16x16x32_bf16 v[110:113], a[152:155], v[198:201], v[110:113]
  ds_write_b128 v21, v[102:105] offset:0
  v_mfma_f32_16x16x32_bf16 v[114:117], a[156:159], v[198:201], v[114:117]
  ds_write_b128 v21, v[106:109] offset:64
  s_waitcnt vmcnt(6)
  v_mfma_f32_16x16x32_bf16 v[110:113], a[172:175], v[206:209], v[110:113]
  buffer_load_dwordx4 v[70:73], v20, s[32:35], s4 offen offset:0 sc1
  s_waitcnt vmcnt(6)
  v_mfma_f32_16x16x32_bf16 v[114:117], a[176:179], v[206:209], v[114:117]
  v_mfma_f32_16x16x32_bf16 v[118:121], a[120:123], v[166:169], v[118:121]
  v_mfma_f32_16x16x32_bf16 v[122:125], a[104:107], v[170:173], v[122:125]
  v_mfma_f32_16x16x32_bf16 v[118:121], a[140:143], v[174:177], v[118:121]
  buffer_load_dwordx4 v[74:77], v20, s[32:35], s4 offen offset:256 sc1
  v_mfma_f32_16x16x32_bf16 v[122:125], a[124:127], v[178:181], v[122:125]
  v_mfma_f32_16x16x32_bf16 v[118:121], a[160:163], v[198:201], v[118:121]
  ds_write_b128 v21, v[110:113] offset:128
  v_mfma_f32_16x16x32_bf16 v[122:125], a[144:147], v[202:205], v[122:125]
  buffer_load_dwordx4 v[78:81], v20, s[32:35], s4 offen offset:2048 sc1
  ds_write_b128 v21, v[114:117] offset:192
  s_waitcnt vmcnt(7)
  v_mfma_f32_16x16x32_bf16 v[118:121], a[180:183], v[206:209], v[118:121]
  v_mfma_f32_16x16x32_bf16 v[122:125], a[164:167], v[210:213], v[122:125]
  v_mfma_f32_16x16x32_bf16 v[126:129], a[108:111], v[170:173], v[126:129]
  v_mfma_f32_16x16x32_bf16 v[130:133], a[112:115], v[170:173], v[130:133]
  buffer_load_dwordx4 v[82:85], v20, s[32:35], s4 offen offset:2304 sc1
  s_add_u32 s4, s4, 4096
  v_mfma_f32_16x16x32_bf16 v[126:129], a[128:131], v[178:181], v[126:129]
  v_mfma_f32_16x16x32_bf16 v[130:133], a[132:135], v[178:181], v[130:133]
  v_mfma_f32_16x16x32_bf16 v[126:129], a[148:151], v[202:205], v[126:129]
  buffer_load_dwordx4 v[86:89], v20, s[32:35], s4 offen offset:0 sc1
  ds_write_b128 v21, v[118:121] offset:256
  v_mfma_f32_16x16x32_bf16 v[130:133], a[152:155], v[202:205], v[130:133]
  ds_write_b128 v21, v[122:125] offset:5632
  v_mfma_f32_16x16x32_bf16 v[126:129], a[168:171], v[210:213], v[126:129]
  v_mfma_f32_16x16x32_bf16 v[130:133], a[172:175], v[210:213], v[130:133]
  buffer_load_dwordx4 v[90:93], v20, s[32:35], s4 offen offset:256 sc1
  v_mfma_f32_16x16x32_bf16 v[134:137], a[116:119], v[170:173], v[134:137]
  v_mfma_f32_16x16x32_bf16 v[138:141], a[120:123], v[170:173], v[138:141]
  v_mfma_f32_16x16x32_bf16 v[134:137], a[136:139], v[178:181], v[134:137]
  v_mfma_f32_16x16x32_bf16 v[138:141], a[140:143], v[178:181], v[138:141]
  buffer_load_dwordx4 v[94:97], v20, s[32:35], s4 offen offset:2048 sc1
  v_mfma_f32_16x16x32_bf16 v[134:137], a[156:159], v[202:205], v[134:137]
  ds_write_b128 v21, v[126:129] offset:5696
  v_mfma_f32_16x16x32_bf16 v[138:141], a[160:163], v[202:205], v[138:141]
  ds_write_b128 v21, v[130:133] offset:5760
  v_mfma_f32_16x16x32_bf16 v[134:137], a[176:179], v[210:213], v[134:137]
  buffer_load_dwordx4 v[98:101], v20, s[32:35], s4 offen offset:2304 sc1
  s_add_u32 s4, s4, 4096
  v_mfma_f32_16x16x32_bf16 v[138:141], a[180:183], v[210:213], v[138:141]
  s_nop 4
  ds_write_b128 v21, v[134:137] offset:5824
  s_nop 1
  ds_write_b128 v21, v[138:141] offset:5888
  buffer_load_dwordx4 v[150:153], v20, s[32:35], s4 offen offset:0 sc1
  buffer_load_dwordx4 v[154:157], v20, s[32:35], s4 offen offset:256 sc1
  buffer_load_dwordx4 v[158:161], v20, s[32:35], s4 offen offset:2048 sc1
  buffer_load_dwordx4 v[162:165], v20, s[32:35], s4 offen offset:2304 sc1
  s_add_u32 s4, s4, 4096
  s_waitcnt vmcnt(15)
  v_mfma_f32_16x16x32_bf16 v[214:217], a[240:243], v[54:57], 0
  buffer_load_dwordx4 v[166:169], v20, s[32:35], s4 offen offset:0 sc1
  v_mfma_f32_16x16x32_bf16 v[218:221], a[244:247], v[54:57], 0
  v_lshlrev_b32 v182, 16, v30
  v_and_b32 v183, 0xffff0000, v30
  v_mfma_f32_16x16x32_bf16 v[222:225], a[248:251], v[54:57], 0
  v_lshlrev_b32 v184, 16, v31
  v_and_b32 v185, 0xffff0000, v31
  v_mfma_f32_16x16x32_bf16 v[226:229], a[252:255], v[54:57], 0
  v_lshlrev_b32 v186, 16, v32
  v_and_b32 v187, 0xffff0000, v32
  buffer_load_dwordx4 v[170:173], v20, s[32:35], s4 offen offset:256 sc1
  v_mfma_f32_16x16x32_bf16 v[230:233], a[184:187], v[54:57], 0
  v_lshlrev_b32 v188, 16, v33
  v_and_b32 v189, 0xffff0000, v33
  s_waitcnt vmcnt(16)
  v_mfma_f32_16x16x32_bf16 v[234:237], a[240:243], v[58:61], 0
  v_lshlrev_b32 v190, 16, v40
  v_and_b32 v191, 0xffff0000, v40
  v_mfma_f32_16x16x32_bf16 v[238:241], a[244:247], v[58:61], 0
  v_add_u32 v21, 0xfffec000, v21
  v_mfma_f32_16x16x32_bf16 v[242:245], a[248:251], v[58:61], 0
  buffer_load_dwordx4 v[174:177], v20, s[32:35], s4 offen offset:2048 sc1
  v_mfma_f32_16x16x32_bf16 v[246:249], a[252:255], v[58:61], 0
  v_mfma_f32_16x16x32_bf16 v[250:253], a[184:187], v[58:61], 0
  s_waitcnt vmcnt(16)
  v_mfma_f32_16x16x32_bf16 v[214:217], a[188:191], v[62:65], v[214:217]
  v_mfma_f32_16x16x32_bf16 v[218:221], a[192:195], v[62:65], v[218:221]
  buffer_load_dwordx4 v[178:181], v20, s[32:35], s4 offen offset:2304 sc1
  s_add_u32 s4, s4, 4096
  v_mfma_f32_16x16x32_bf16 v[222:225], a[196:199], v[62:65], v[222:225]
  s_waitcnt lgkmcnt(0)
  s_barrier
  v_mfma_f32_16x16x32_bf16 v[226:229], a[200:203], v[62:65], v[226:229]
  ds_read_b128 v[102:105], v22 offset:0
  ds_read_b128 v[106:109], v22 offset:32
  v_mfma_f32_16x16x32_bf16 v[230:233], a[204:207], v[62:65], v[230:233]
  ds_read_b64 v[134:135], v23 offset:0
  ds_read_b128 v[110:113], v22 offset:11264
  s_waitcnt vmcnt(16)
  v_mfma_f32_16x16x32_bf16 v[234:237], a[188:191], v[66:69], v[234:237]
  buffer_load_dwordx4 v[198:201], v20, s[32:35], s4 offen offset:0 sc1
  v_mfma_f32_16x16x32_bf16 v[238:241], a[192:195], v[66:69], v[238:241]
  ds_read_b128 v[114:117], v22 offset:11296
  ds_read_b64 v[136:137], v23 offset:11264
  v_mfma_f32_16x16x32_bf16 v[242:245], a[196:199], v[66:69], v[242:245]
  ds_read_b128 v[118:121], v22 offset:22528
  ds_read_b128 v[122:125], v22 offset:22560
  v_mfma_f32_16x16x32_bf16 v[246:249], a[200:203], v[66:69], v[246:249]
  ds_read_b64 v[138:139], v23 offset:22528
  ds_read_b128 v[126:129], v22 offset:33792
  v_mfma_f32_16x16x32_bf16 v[250:253], a[204:207], v[66:69], v[250:253]
  buffer_load_dwordx4 v[202:205], v20, s[32:35], s4 offen offset:256 sc1
  s_waitcnt vmcnt(17)
  v_mfma_f32_16x16x32_bf16 v[214:217], a[208:211], v[70:73], v[214:217]
  ds_read_b128 v[130:133], v22 offset:33824
  ds_read_b64 v[140:141], v23 offset:33792
  v_mfma_f32_16x16x32_bf16 v[218:221], a[212:215], v[70:73], v[218:221]
  v_add_u32 v22, 0xfffec000, v22
  v_add_u32 v23, 0xfffec000, v23
  v_mfma_f32_16x16x32_bf16 v[222:225], a[216:219], v[70:73], v[222:225]
  v_mfma_f32_16x16x32_bf16 v[226:229], a[220:223], v[70:73], v[226:229]
  buffer_load_dwordx4 v[206:209], v20, s[32:35], s4 offen offset:2048 sc1
  v_mfma_f32_16x16x32_bf16 v[230:233], a[0:3], v[70:73], v[230:233]
  s_waitcnt vmcnt(17)
  v_mfma_f32_16x16x32_bf16 v[234:237], a[208:211], v[74:77], v[234:237]
  v_mfma_f32_16x16x32_bf16 v[238:241], a[212:215], v[74:77], v[238:241]
  v_mfma_f32_16x16x32_bf16 v[242:245], a[216:219], v[74:77], v[242:245]
  buffer_load_dwordx4 v[210:213], v20, s[32:35], s4 offen offset:2304 sc1
  s_add_u32 s4, s4, 4096
  v_mfma_f32_16x16x32_bf16 v[246:249], a[220:223], v[74:77], v[246:249]
  v_mfma_f32_16x16x32_bf16 v[250:253], a[0:3], v[74:77], v[250:253]
  s_waitcnt vmcnt(17)
  v_mfma_f32_16x16x32_bf16 v[214:217], a[4:7], v[78:81], v[214:217]
  s_waitcnt lgkmcnt(11)
  v_add_f32 v182, v182, v102
  v_add_f32 v183, v183, v103
  v_mfma_f32_16x16x32_bf16 v[218:221], a[8:11], v[78:81], v[218:221]
  v_add_f32 v184, v184, v104
  v_add_f32 v185, v185, v105
  v_mfma_f32_16x16x32_bf16 v[222:225], a[12:15], v[78:81], v[222:225]
  s_waitcnt lgkmcnt(10)
  v_add_f32 v186, v186, v106
  v_add_f32 v187, v187, v107
  v_mfma_f32_16x16x32_bf16 v[226:229], a[16:19], v[78:81], v[226:229]
  v_add_f32 v188, v188, v108
  v_add_f32 v189, v189, v109
  v_mfma_f32_16x16x32_bf16 v[230:233], a[20:23], v[78:81], v[230:233]
  s_waitcnt lgkmcnt(9)
  v_add_f32 v190, v190, v134
  v_add_f32 v191, v191, v135
  s_waitcnt vmcnt(16)
  v_mfma_f32_16x16x32_bf16 v[234:237], a[4:7], v[82:85], v[234:237]
  s_waitcnt lgkmcnt(8)
  v_add_f32 v182, v182, v110
  v_add_f32 v183, v183, v111
  v_mfma_f32_16x16x32_bf16 v[238:241], a[8:11], v[82:85], v[238:241]
  v_add_f32 v184, v184, v112
  v_add_f32 v185, v185, v113
  v_mfma_f32_16x16x32_bf16 v[242:245], a[12:15], v[82:85], v[242:245]
  s_waitcnt lgkmcnt(7)
  v_add_f32 v186, v186, v114
  v_add_f32 v187, v187, v115
  v_mfma_f32_16x16x32_bf16 v[246:249], a[16:19], v[82:85], v[246:249]
  v_add_f32 v188, v188, v116
  v_add_f32 v189, v189, v117
  v_mfma_f32_16x16x32_bf16 v[250:253], a[20:23], v[82:85], v[250:253]
  s_waitcnt lgkmcnt(6)
  v_add_f32 v190, v190, v136
  v_add_f32 v191, v191, v137
  s_waitcnt vmcnt(15)
  v_mfma_f32_16x16x32_bf16 v[214:217], a[24:27], v[86:89], v[214:217]
  s_waitcnt lgkmcnt(5)
  v_add_f32 v182, v182, v118
  v_add_f32 v183, v183, v119
  v_mfma_f32_16x16x32_bf16 v[218:221], a[28:31], v[86:89], v[218:221]
  v_add_f32 v184, v184, v120
  v_add_f32 v185, v185, v121
  v_mfma_f32_16x16x32_bf16 v[222:225], a[32:35], v[86:89], v[222:225]
  s_waitcnt lgkmcnt(4)
  v_add_f32 v186, v186, v122
  v_add_f32 v187, v187, v123
  v_mfma_f32_16x16x32_bf16 v[226:229], a[36:39], v[86:89], v[226:229]
  v_add_f32 v188, v188, v124
  v_add_f32 v189, v189, v125
  v_mfma_f32_16x16x32_bf16 v[230:233], a[40:43], v[86:89], v[230:233]
  s_waitcnt lgkmcnt(3)
  v_add_f32 v190, v190, v138
  v_add_f32 v191, v191, v139
  s_waitcnt vmcnt(14)
  v_mfma_f32_16x16x32_bf16 v[234:237], a[24:27], v[90:93], v[234:237]
  s_waitcnt lgkmcnt(2)
  v_add_f32 v182, v182, v126
  v_add_f32 v183, v183, v127
  v_mfma_f32_16x16x32_bf16 v[238:241], a[28:31], v[90:93], v[238:241]
  v_add_f32 v184, v184, v128
  v_add_f32 v185, v185, v129
  v_mfma_f32_16x16x32_bf16 v[242:245], a[32:35], v[90:93], v[242:245]
  s_waitcnt lgkmcnt(1)
  v_add_f32 v186, v186, v130
  v_add_f32 v187, v187, v131
  v_mfma_f32_16x16x32_bf16 v[246:249], a[36:39], v[90:93], v[246:249]
  v_add_f32 v188, v188, v132
  v_add_f32 v189, v189, v133
  v_mfma_f32_16x16x32_bf16 v[250:253], a[40:43], v[90:93], v[250:253]
  s_waitcnt lgkmcnt(0)
  v_add_f32 v190, v190, v140
  v_add_f32 v191, v191, v141
  s_waitcnt vmcnt(13)
  v_mfma_f32_16x16x32_bf16 v[214:217], a[44:47], v[94:97], v[214:217]
  v_cvt_pk_bf16_f32 v42, v182, v183
  v_cvt_pk_bf16_f32 v43, v184, v185
  v_mfma_f32_16x16x32_bf16 v[218:221], a[48:51], v[94:97], v[218:221]
  v_cvt_pk_bf16_f32 v44, v186, v187
  v_cvt_pk_bf16_f32 v45, v188, v189
  v_mfma_f32_16x16x32_bf16 v[222:225], a[52:55], v[94:97], v[222:225]
  v_cvt_pk_bf16_f32 v46, v190, v191
  v_mfma_f32_16x16x32_bf16 v[226:229], a[56:59], v[94:97], v[226:229]
  buffer_store_dwordx4 v[42:45], v24, s[36:39], s19 offen nt
  v_mfma_f32_16x16x32_bf16 v[230:233], a[60:63], v[94:97], v[230:233]
  buffer_store_dword v46, v25, s[36:39], s19 offen nt
  s_waitcnt vmcnt(14)
  v_mfma_f32_16x16x32_bf16 v[234:237], a[44:47], v[98:101], v[234:237]
  v_mfma_f32_16x16x32_bf16 v[238:241], a[48:51], v[98:101], v[238:241]
  v_mfma_f32_16x16x32_bf16 v[242:245], a[52:55], v[98:101], v[242:245]
  v_mfma_f32_16x16x32_bf16 v[246:249], a[56:59], v[98:101], v[246:249]
  v_mfma_f32_16x16x32_bf16 v[250:253], a[60:63], v[98:101], v[250:253]
  s_waitcnt vmcnt(13)
  v_mfma_f32_16x16x32_bf16 v[214:217], a[64:67], v[150:153], v[214:217]
  v_mfma_f32_16x16x32_bf16 v[218:221], a[68:71], v[150:153], v[218:221]
  v_mfma_f32_16x16x32_bf16 v[222:225], a[72:75], v[150:153], v[222:225]
  v_mfma_f32_16x16x32_bf16 v[226:229], a[76:79], v[150:153], v[226:229]
  v_mfma_f32_16x16x32_bf16 v[230:233], a[80:83], v[150:153], v[230:233]
  s_waitcnt vmcnt(12)
  v_mfma_f32_16x16x32_bf16 v[234:237], a[64:67], v[154:157], v[234:237]
  v_mfma_f32_16x16x32_bf16 v[238:241], a[68:71], v[154:157], v[238:241]
  v_mfma_f32_16x16x32_bf16 v[242:245], a[72:75], v[154:157], v[242:245]
  v_mfma_f32_16x16x32_bf16 v[246:249], a[76:79], v[154:157], v[246:249]
  v_mfma_f32_16x16x32_bf16 v[250:253], a[80:83], v[154:157], v[250:253]
  s_waitcnt vmcnt(11)
  v_mfma_f32_16x16x32_bf16 v[214:217], a[84:87], v[158:161], v[214:217]
  v_mfma_f32_16x16x32_bf16 v[218:221], a[88:91], v[158:161], v[218:221]
  v_mfma_f32_16x16x32_bf16 v[222:225], a[92:95], v[158:161], v[222:225]
  v_mfma_f32_16x16x32_bf16 v[226:229], a[96:99], v[158:161], v[226:229]
  v_mfma_f32_16x16x32_bf16 v[230:233], a[100:103], v[158:161], v[230:233]
  s_waitcnt vmcnt(10)
  v_mfma_f32_16x16x32_bf16 v[234:237], a[84:87], v[162:165], v[234:237]
  v_mfma_f32_16x16x32_bf16 v[238:241], a[88:91], v[162:165], v[238:241]
  v_mfma_f32_16x16x32_bf16 v[242:245], a[92:95], v[162:165], v[242:245]
  v_mfma_f32_16x16x32_bf16 v[246:249], a[96:99], v[162:165], v[246:249]
  v_mfma_f32_16x16x32_bf16 v[250:253], a[100:103], v[162:165], v[250:253]
  s_waitcnt vmcnt(9)
  v_mfma_f32_16x16x32_bf16 v[214:217], a[104:107], v[166:169], v[214:217]
  v_mfma_f32_16x16x32_bf16 v[218:221], a[108:111], v[166:169], v[218:221]
  s_waitcnt vmcnt(7)
  v_mfma_f32_16x16x32_bf16 v[214:217], a[124:127], v[174:177], v[214:217]
  v_mfma_f32_16x16x32_bf16 v[218:221], a[128:131], v[174:177], v[218:221]
  s_waitcnt vmcnt(5)
  v_mfma_f32_16x16x32_bf16 v[214:217], a[144:147], v[198:201], v[214:217]
  v_mfma_f32_16x16x32_bf16 v[218:221], a[148:151], v[198:201], v[218:221]
  s_waitcnt vmcnt(3)
  v_mfma_f32_16x16x32_bf16 v[214:217], a[164:167], v[206:209], v[214:217]
  v_mfma_f32_16x16x32_bf16 v[218:221], a[168:171], v[206:209], v[218:221]
  v_mfma_f32_16x16x32_bf16 v[222:225], a[112:115], v[166:169], v[222:225]
  v_mfma_f32_16x16x32_bf16 v[226:229], a[116:119], v[166:169], v[226:229]
  v_mfma_f32_16x16x32_bf16 v[222:225], a[132:135], v[174:177], v[222:225]
  v_mfma_f32_16x16x32_bf16 v[226:229], a[136:139], v[174:177], v[226:229]
  v_mfma_f32_16x16x32_bf16 v[222:225], a[152:155], v[198:201], v[222:225]
  s_nop 1
  ds_write_b128 v21, v[214:217] offset:0
  v_mfma_f32_16x16x32_bf16 v[226:229], a[156:159], v[198:201], v[226:229]
  ds_write_b128 v21, v[218:221] offset:64
  v_mfma_f32_16x16x32_bf16 v[222:225], a[172:175], v[206:209], v[222:225]
  v_mfma_f32_16x16x32_bf16 v[226:229], a[176:179], v[206:209], v[226:229]
  v_mfma_f32_16x16x32_bf16 v[230:233], a[120:123], v[166:169], v[230:233]
  v_mfma_f32_16x16x32_bf16 v[234:237], a[104:107], v[170:173], v[234:237]
  v_mfma_f32_16x16x32_bf16 v[230:233], a[140:143], v[174:177], v[230:233]
  v_mfma_f32_16x16x32_bf16 v[234:237], a[124:127], v[178:181], v[234:237]
  v_mfma_f32_16x16x32_bf16 v[230:233], a[160:163], v[198:201], v[230:233]
  s_nop 1
  ds_write_b128 v21, v[222:225] offset:128
  v_mfma_f32_16x16x32_bf16 v[234:237], a[144:147], v[202:205], v[234:237]
  ds_write_b128 v21, v[226:229] offset:192
  v_mfma_f32_16x16x32_bf16 v[230:233], a[180:183], v[206:209], v[230:233]
  s_waitcnt vmcnt(2)
  v_mfma_f32_16x16x32_bf16 v[234:237], a[164:167], v[210:213], v[234:237]
  v_mfma_f32_16x16x32_bf16 v[238:241], a[108:111], v[170:173], v[238:241]
  v_mfma_f32_16x16x32_bf16 v[242:245], a[112:115], v[170:173], v[242:245]
  v_mfma_f32_16x16x32_bf16 v[238:241], a[128:131], v[178:181], v[238:241]
  v_mfma_f32_16x16x32_bf16 v[242:245], a[132:135], v[178:181], v[242:245]
  v_mfma_f32_16x16x32_bf16 v[238:241], a[148:151], v[202:205], v[238:241]
  s_nop 0
  ds_write_b128 v21, v[230:233] offset:256
  v_mfma_f32_16x16x32_bf16 v[242:245], a[152:155], v[202:205], v[242:245]
  ds_write_b128 v21, v[234:237] offset:5632
  v_mfma_f32_16x16x32_bf16 v[238:241], a[168:171], v[210:213], v[238:241]
  v_mfma_f32_16x16x32_bf16 v[242:245], a[172:175], v[210:213], v[242:245]
  v_mfma_f32_16x16x32_bf16 v[246:249], a[116:119], v[170:173], v[246:249]
  v_mfma_f32_16x16x32_bf16 v[250:253], a[120:123], v[170:173], v[250:253]
  v_mfma_f32_16x16x32_bf16 v[246:249], a[136:139], v[178:181], v[246:249]
  v_mfma_f32_16x16x32_bf16 v[250:253], a[140:143], v[178:181], v[250:253]
  v_mfma_f32_16x16x32_bf16 v[246:249], a[156:159], v[202:205], v[246:249]
  s_nop 1
  ds_write_b128 v21, v[238:241] offset:5696
  v_mfma_f32_16x16x32_bf16 v[250:253], a[160:163], v[202:205], v[250:253]
  ds_write_b128 v21, v[242:245] offset:5760
  v_mfma_f32_16x16x32_bf16 v[246:249], a[176:179], v[210:213], v[246:249]
  v_mfma_f32_16x16x32_bf16 v[250:253], a[180:183], v[210:213], v[250:253]
  s_nop 6
  ds_write_b128 v21, v[246:249] offset:5824
  ds_write_b128 v21, v[250:253] offset:5888
  v_lshlrev_b32 v182, 16, v36
  v_and_b32 v183, 0xffff0000, v36
  v_lshlrev_b32 v184, 16, v37
  v_and_b32 v185, 0xffff0000, v37
  v_lshlrev_b32 v186, 16, v38
  v_and_b32 v187, 0xffff0000, v38
  v_lshlrev_b32 v188, 16, v39
  v_and_b32 v189, 0xffff0000, v39
  v_lshlrev_b32 v190, 16, v41
  v_and_b32 v191, 0xffff0000, v41
  s_waitcnt lgkmcnt(0)
  s_barrier
  ds_read_b128 v[214:217], v22 offset:0
  ds_read_b128 v[218:221], v22 offset:32
  ds_read_b64 v[246:247], v23 offset:0
  ds_read_b128 v[222:225], v22 offset:11264
  ds_read_b128 v[226:229], v22 offset:11296
  ds_read_b64 v[248:249], v23 offset:11264
  ds_read_b128 v[230:233], v22 offset:22528
  ds_read_b128 v[234:237], v22 offset:22560
  ds_read_b64 v[250:251], v23 offset:22528
  ds_read_b128 v[238:241], v22 offset:33792
  ds_read_b128 v[242:245], v22 offset:33824
  ds_read_b64 v[252:253], v23 offset:33792
  s_waitcnt lgkmcnt(11)
  v_pk_add_f32 v[182:183], v[182:183], v[214:215]
  v_pk_add_f32 v[184:185], v[184:185], v[216:217]
  s_waitcnt lgkmcnt(10)
  v_pk_add_f32 v[186:187], v[186:187], v[218:219]
  v_pk_add_f32 v[188:189], v[188:189], v[220:221]
  s_waitcnt lgkmcnt(9)
  v_pk_add_f32 v[190:191], v[190:191], v[246:247]
  s_waitcnt lgkmcnt(8)
  v_pk_add_f32 v[182:183], v[182:183], v[222:223]
  v_pk_add_f32 v[184:185], v[184:185], v[224:225]
  s_waitcnt lgkmcnt(7)
  v_pk_add_f32 v[186:187], v[186:187], v[226:227]
  v_pk_add_f32 v[188:189], v[188:189], v[228:229]
  s_waitcnt lgkmcnt(6)
  v_pk_add_f32 v[190:191], v[190:191], v[248:249]
  s_waitcnt lgkmcnt(5)
  v_pk_add_f32 v[182:183], v[182:183], v[230:231]
  v_pk_add_f32 v[184:185], v[184:185], v[232:233]
  s_waitcnt lgkmcnt(4)
  v_pk_add_f32 v[186:187], v[186:187], v[234:235]
  v_pk_add_f32 v[188:189], v[188:189], v[236:237]
  s_waitcnt lgkmcnt(3)
  v_pk_add_f32 v[190:191], v[190:191], v[250:251]
  s_waitcnt lgkmcnt(2)
  v_pk_add_f32 v[42:43], v[182:183], v[238:239]
  v_pk_add_f32 v[44:45], v[184:185], v[240:241]
  s_waitcnt lgkmcnt(1)
  v_pk_add_f32 v[46:47], v[186:187], v[242:243]
  v_pk_add_f32 v[48:49], v[188:189], v[244:245]
  s_waitcnt lgkmcnt(0)
  v_pk_add_f32 v[50:51], v[190:191], v[252:253]
  v_cvt_pk_bf16_f32 v182, v42, v43
  v_cvt_pk_bf16_f32 v183, v44, v45
  v_cvt_pk_bf16_f32 v184, v46, v47
  v_cvt_pk_bf16_f32 v185, v48, v49
  v_cvt_pk_bf16_f32 v186, v50, v51
  s_add_u32 s55, s19, 40960
  buffer_store_dwordx4 v[182:185], v24, s[36:39], s55 offen nt
  buffer_store_dword v186, v25, s[36:39], s55 offen nt
L_finish:
L_end:
  s_endpgm
L_codeend:
.section .rodata,"a"
.p2align 6
.amdhsa_kernel sequential_preLN__sliding_block__glu_gated_swiglu__prompt_kernel
  .amdhsa_next_free_vgpr 512
  .amdhsa_next_free_sgpr 102
  .amdhsa_accum_offset 256
  .amdhsa_group_segment_fixed_size 0
  .amdhsa_kernarg_size 80
  .amdhsa_user_sgpr_count 2
  .amdhsa_user_sgpr_kernarg_segment_ptr 1
  .amdhsa_system_sgpr_workgroup_id_x 1
.end_amdhsa_kernel
```
